```python
import torch

def _softmax(x, axis=-1):
    return torch.softmax(x, dim=axis)

def _gelu(x):
    return torch.nn.functional.gelu(x, approximate='tanh')

def _silu(x):
    return torch.nn.functional.silu(x)

def _sigmoid(x):
    return torch.sigmoid(x)

def _layernorm(x, axis=-1, eps=1e-05):
    m = x.mean(dim=axis, keepdim=True)
    v = x.var(dim=axis, keepdim=True, unbiased=False)
    return (x - m) / torch.sqrt(v + eps)

def _scatter_add(tgt, idx, src, axis=0):
    return tgt.clone().index_add_(axis, idx, src)

def _segment_sum(src, seg, n):
    out = torch.zeros((n,) + src.shape[1:], dtype=src.dtype)
    return out.index_add_(0, seg, src)

def _pad(x, pw):
    flat = tuple((v for pair in reversed(pw) for v in pair))
    return torch.nn.functional.pad(x, flat)
kernel_name = 'interleave_layers__memory_aug_recurrent_mem_tr__glu_gated_geglu__prompt'

def setup_inputs():

    _w = lambda a: (lambda t: t.to(torch.bfloat16) if t.is_floating_point() else t)(torch.as_tensor(a))

    def _A_setup():
        B, S, Dm = (1, 2048, 576)
        H, Dh = (32, 128)
        M, seg = (8, 32)
        seg = min(seg, S)
        S = S // seg * seg
        return {'x': _w((lambda *s: torch.randn(*s, dtype=torch.bfloat16) * 0.05)(B, S, Dm)), 'mem0': _w((lambda *s: torch.randn(*s, dtype=torch.bfloat16) * 0.2)(B, M, Dm)), 'Wq': _w((lambda *s: torch.randn(*s, dtype=torch.bfloat16) * 1.6)(Dm, H, Dh) * Dm ** (-0.5)), 'Wk': _w((lambda *s: torch.randn(*s, dtype=torch.bfloat16) * 1.6)(Dm, H, Dh) * Dm ** (-0.5)), 'Wv': _w((lambda *s: torch.randn(*s, dtype=torch.bfloat16) * 0.2)(Dm, H, Dh) * Dm ** (-0.5)), 'Wo': _w((lambda *s: torch.randn(*s, dtype=torch.bfloat16) * 0.2)(H, Dh, Dm) * (H * Dh) ** (-0.5)), 'seg_len': seg}
    _A_in = _A_setup()

    def _B_setup():
        B, S, Dm, Df = (1, 2048, 576, 4608)
        return {'x': _w((lambda *s: torch.randn(*s, dtype=torch.bfloat16) * 0.05)(B, S, Dm)), 'w_gate': _w((lambda *s: torch.randn(*s, dtype=torch.bfloat16) * 0.4)(Dm, Df) * Dm ** (-0.5)), 'w_up': _w((lambda *s: torch.randn(*s, dtype=torch.bfloat16) * 0.4)(Dm, Df) * Dm ** (-0.5)), 'w_down': _w((lambda *s: torch.randn(*s, dtype=torch.bfloat16) * 0.4)(Df, Dm) * Df ** (-0.5))}
    _B_in = _B_setup()
    return {'A_x': _A_in['x'], 'A_mem0': _A_in['mem0'], 'A_Wq': _A_in['Wq'], 'A_Wk': _A_in['Wk'], 'A_Wv': _A_in['Wv'], 'A_Wo': _A_in['Wo'], 'A_seg_len': _A_in['seg_len'], 'B_x': _B_in['x'], 'B_w_gate': _B_in['w_gate'], 'B_w_up': _B_in['w_up'], 'B_w_down': _B_in['w_down']}

def reference(A_x, A_mem0, A_Wq, A_Wk, A_Wv, A_Wo, A_seg_len, B_x, B_w_gate, B_w_up, B_w_down):

    def _A_ref(x, mem0, Wq, Wk, Wv, Wo, seg_len):
        B, S, Dm = x.shape
        H, Dh = (Wq.shape[1], Wq.shape[2])
        M = mem0.shape[1]
        scale = Dh ** (-0.5)
        n_seg = S // seg_len
        L = M + seg_len
        idx = torch.arange(L)
        mask = (idx[:, None] < M) | (idx[:, None] >= idx[None, :])
        mem = mem0
        outs = []
        for s in range(n_seg):
            xs = x[:, s * seg_len:(s + 1) * seg_len, :].clone()
            h = torch.concatenate([mem, xs], axis=1)
            q = torch.einsum('btd,dhe->bhte', h, Wq)
            k = torch.einsum('btd,dhe->bhte', h, Wk)
            v = torch.einsum('btd,dhe->bhte', h, Wv)
            scores = torch.einsum('bhqe,bhke->bhqk', q, k) * scale
            scores = torch.where(mask[None, None], scores, -1000000000.0)
            p = _softmax(scores, axis=-1)
            o = torch.einsum('bhqk,bhke->bhqe', p, v)
            o = torch.einsum('bhte,hed->btd', o, Wo)
            mem = o[:, :M, :].clone()
            outs.append(o[:, M:, :])
        return torch.concatenate(outs, axis=1)

    def _B_ref(x, w_gate, w_up, w_down):
        g = torch.einsum('bsd,df->bsf', x, w_gate)
        u = torch.einsum('bsd,df->bsf', x, w_up)
        h = _gelu(g) * u
        return torch.einsum('bsf,fd->bsd', h, w_down)
    x = A_x
    x = x + _A_ref(_layernorm(x, axis=-1), A_mem0, A_Wq, A_Wk, A_Wv, A_Wo, A_seg_len)
    x = x + _B_ref(_layernorm(x, axis=-1), B_w_gate, B_w_up, B_w_down)
    x = x + _A_ref(_layernorm(x, axis=-1), A_mem0, A_Wq, A_Wk, A_Wv, A_Wo, A_seg_len)
    x = x + _B_ref(_layernorm(x, axis=-1), B_w_gate, B_w_up, B_w_down)
    return x
```

```asm
; @launch grid=(256,1,1) block=(256,1,1) lds=163840
.amdgcn_target "amdgcn-amd-amdhsa--gfx950"
.text
.globl interleave_layers__memory_aug_recurrent_mem_tr__glu_gated_geglu__prompt_kernel
.p2align 8
.type interleave_layers__memory_aug_recurrent_mem_tr__glu_gated_geglu__prompt_kernel,@function
interleave_layers__memory_aug_recurrent_mem_tr__glu_gated_geglu__prompt_kernel:
    s_load_dwordx2 s[4:5], s[0:1], 104
    s_load_dwordx2 s[16:17], s[0:1], 96
    s_load_dwordx2 s[8:9], s[0:1], 16
    s_load_dwordx2 s[12:13], s[0:1], 0
    s_getreg_b32 s25, hwreg(HW_REG_XCC_ID)
    s_and_b32 s25, s25, 7
    v_lshrrev_b32 v1, 6, v0
    s_nop 0
    v_readfirstlane_b32 s20, v1
    s_mov_b32 s6, 268435456
    s_mov_b32 s7, 0x20000
    s_mov_b32 s10, 0
    s_mov_b32 s11, 0x20000
    s_mov_b32 s14, 0
    s_mov_b32 s15, 0x20000
    s_mov_b32 s18, 256
    s_mov_b32 s19, 0x20000
    v_lshlrev_b32 v4, 3, v0
    v_and_b32 v0, 63, v0
    v_mov_b32 v2, 1
    s_lshl_b32 s26, s25, 5
    v_mov_b32 v3, s26
    v_mov_b32 v5, 0
    s_waitcnt lgkmcnt(0)
    s_cmp_lg_u32 s20, 0
    s_cbranch_scc1 L_tick_done
    s_mov_b64 exec, 1
    buffer_atomic_add v2, v3, s[16:19], 0 offen sc0 sc1
    s_waitcnt vmcnt(0)
    ds_write_b32 v5, v2
    s_mov_b64 exec, -1
L_tick_done:
    s_waitcnt vmcnt(0) lgkmcnt(0)
    s_barrier
    ds_read_b32 v2, v5
    s_waitcnt lgkmcnt(0)
    v_readfirstlane_b32 s27, v2
    s_nop 0
    s_cmp_ge_u32 s27, 32
    s_nop 1
    s_cbranch_scc1 L_exit
    s_add_u32 s22, s26, s27
    s_barrier
    v_mov_b32 v6, 0
    v_mov_b32 v7, 0
    s_lshl_b32 s28, s22, 11
    buffer_store_dwordx2 v[6:7], v4, s[4:7], s28 offen sc1
    s_and_b32 s24, s25, 1
    s_lshr_b32 s25, s25, 1
    s_mov_b32 s21, s27
    s_cmp_eq_u32 s25, 0
    s_cbranch_scc1 L_chain
    s_lshl_b32 s28, s25, 5
    s_add_u32 s28, s28, s27
    s_cmp_eq_u32 s28, 33
    s_cselect_b32 s29, 64, 0
    s_cmp_eq_u32 s28, 97
    s_cselect_b32 s29, 64, s29
    s_xor_b32 s28, s28, s29
    s_lshr_b32 s25, s28, 5
    s_and_b32 s27, s28, 31
    s_lshl_b32 s28, s25, 5
    s_add_u32 s28, s28, s27
    s_cmp_eq_u32 s28, 37
    s_cselect_b32 s29, 64, 0
    s_cmp_eq_u32 s28, 101
    s_cselect_b32 s29, 64, s29
    s_xor_b32 s28, s28, s29
    s_lshr_b32 s25, s28, 5
    s_and_b32 s27, s28, 31
    s_lshl_b32 s28, s25, 5
    s_add_u32 s28, s28, s27
    s_cmp_eq_u32 s28, 41
    s_cselect_b32 s29, 64, 0
    s_cmp_eq_u32 s28, 105
    s_cselect_b32 s29, 64, s29
    s_xor_b32 s28, s28, s29
    s_lshr_b32 s25, s28, 5
    s_and_b32 s27, s28, 31
    s_lshl_b32 s28, s25, 5
    s_add_u32 s28, s28, s27
    s_cmp_eq_u32 s28, 45
    s_cselect_b32 s29, 64, 0
    s_cmp_eq_u32 s28, 109
    s_cselect_b32 s29, 64, s29
    s_xor_b32 s28, s28, s29
    s_lshr_b32 s25, s28, 5
    s_and_b32 s27, s28, 31
    s_lshl_b32 s28, s25, 5
    s_add_u32 s28, s28, s27
    s_cmp_eq_u32 s28, 49
    s_cselect_b32 s29, 64, 0
    s_cmp_eq_u32 s28, 113
    s_cselect_b32 s29, 64, s29
    s_xor_b32 s28, s28, s29
    s_lshr_b32 s25, s28, 5
    s_and_b32 s27, s28, 31
    s_lshl_b32 s28, s25, 5
    s_add_u32 s28, s28, s27
    s_cmp_eq_u32 s28, 53
    s_cselect_b32 s29, 64, 0
    s_cmp_eq_u32 s28, 117
    s_cselect_b32 s29, 64, s29
    s_xor_b32 s28, s28, s29
    s_lshr_b32 s25, s28, 5
    s_and_b32 s27, s28, 31
    s_lshl_b32 s28, s25, 5
    s_add_u32 s28, s28, s27
    s_cmp_eq_u32 s28, 57
    s_cselect_b32 s29, 64, 0
    s_cmp_eq_u32 s28, 121
    s_cselect_b32 s29, 64, s29
    s_xor_b32 s28, s28, s29
    s_lshr_b32 s25, s28, 5
    s_and_b32 s27, s28, 31
    s_lshl_b32 s28, s25, 5
    s_add_u32 s28, s28, s27
    s_cmp_eq_u32 s28, 61
    s_cselect_b32 s29, 64, 0
    s_cmp_eq_u32 s28, 125
    s_cselect_b32 s29, 64, s29
    s_xor_b32 s28, s28, s29
    s_lshr_b32 s25, s28, 5
    s_and_b32 s27, s28, 31
    s_lshl_b32 s28, s25, 5
    s_add_u32 s28, s28, s27
    s_cmp_eq_u32 s28, 65
    s_cselect_b32 s29, 35, 0
    s_cmp_eq_u32 s28, 98
    s_cselect_b32 s29, 35, s29
    s_xor_b32 s28, s28, s29
    s_lshr_b32 s25, s28, 5
    s_and_b32 s27, s28, 31
    s_lshl_b32 s28, s25, 5
    s_add_u32 s28, s28, s27
    s_cmp_eq_u32 s28, 69
    s_cselect_b32 s29, 35, 0
    s_cmp_eq_u32 s28, 102
    s_cselect_b32 s29, 35, s29
    s_xor_b32 s28, s28, s29
    s_lshr_b32 s25, s28, 5
    s_and_b32 s27, s28, 31
    s_lshl_b32 s28, s25, 5
    s_add_u32 s28, s28, s27
    s_cmp_eq_u32 s28, 73
    s_cselect_b32 s29, 35, 0
    s_cmp_eq_u32 s28, 106
    s_cselect_b32 s29, 35, s29
    s_xor_b32 s28, s28, s29
    s_lshr_b32 s25, s28, 5
    s_and_b32 s27, s28, 31
    s_lshl_b32 s28, s25, 5
    s_add_u32 s28, s28, s27
    s_cmp_eq_u32 s28, 77
    s_cselect_b32 s29, 35, 0
    s_cmp_eq_u32 s28, 110
    s_cselect_b32 s29, 35, s29
    s_xor_b32 s28, s28, s29
    s_lshr_b32 s25, s28, 5
    s_and_b32 s27, s28, 31
    s_lshl_b32 s28, s25, 5
    s_add_u32 s28, s28, s27
    s_cmp_eq_u32 s28, 81
    s_cselect_b32 s29, 35, 0
    s_cmp_eq_u32 s28, 114
    s_cselect_b32 s29, 35, s29
    s_xor_b32 s28, s28, s29
    s_lshr_b32 s25, s28, 5
    s_and_b32 s27, s28, 31
    s_cmp_eq_u32 s25, 3
    s_cbranch_scc1 L_disp3
    s_lshr_b32 s21, s27, 1
    s_bitcmp1_b32 s27, 0
    s_cbranch_scc1 L_disp_odd
    s_cmp_eq_u32 s25, 1
    s_cbranch_scc1 L_oproj
    s_branch L_down
L_disp_odd:
    s_lshl_b32 s28, s25, 4
    s_add_u32 s21, s21, s28
    s_sub_u32 s21, s21, 16
    s_branch L_proj
L_disp3:
    s_lshr_b32 s21, s27, 2
    s_and_b32 s28, s27, 3
    s_cbranch_scc0 L_atn
    s_sub_u32 s21, s27, s21
    s_sub_u32 s21, s21, 1
    s_branch L_up
L_spare:
    s_waitcnt vmcnt(0)
    s_barrier
    s_cmp_lg_u32 s20, 0
    s_cbranch_scc1 L_arr_1
    s_mov_b64 exec, 1
    v_mov_b32 v2, 1
    buffer_atomic_add v2, off, s[16:19], 0 offset:16 sc1
    s_mov_b64 exec, -1
L_arr_1:
L_exit:
    s_endpgm
L_abort:
    s_mov_b64 exec, 1
    s_lshl_b32 s28, s22, 8
    s_or_b32 s29, s29, s28
    s_lshl_b32 s28, s20, 16
    s_or_b32 s29, s29, s28
    s_or_b32 s29, s29, 0x40000000
    v_mov_b32 v2, s29
    buffer_store_dword v2, off, s[16:19], 0 offset:20 sc1
    s_endpgm
L_chain:
    s_lshl_b32 s52, s21, 8
    s_lshl_b32 s53, s20, 10
    s_lshl_b32 s54, s20, 8
    s_lshl_b32 s31, s20, 5
    s_add_u32 s31, s31, s21
    s_mov_b32 s46, 0x00ff00ff
    s_mov_b32 s47, 0x00ff00ff
    s_mov_b32 s48, 0
    s_mov_b32 s49, -1
    s_mov_b32 s39, 0x3e0293ee
    s_mul_i32 s32, s24, 294912
    s_add_u32 s36, s32, 19922944
    s_lshl_b32 s28, s31, 12
    s_add_u32 s32, s36, s28
    s_cmp_ge_u32 s31, 72
    s_cselect_b32 s32, 1073741824, s32
    s_mul_i32 s33, s24, 32768
    s_add_u32 s33, s33, 20971520
    s_add_u32 s34, s33, 9216
    s_add_u32 s35, s33, 18432
    v_lshlrev_b32 v10, 4, v0
    v_lshrrev_b32 v4, 0, v0
    v_and_b32 v4, 7, v4
    v_lshlrev_b32 v4, 4, v4
    v_lshrrev_b32 v12, 4, v0
    v_and_b32 v12, 1, v12
    v_lshl_or_b32 v4, v12, 3, v4
    s_load_dwordx2 s[12:13], s[0:1], 8
    s_mov_b32 s14, 9216
    s_mov_b32 s15, 0x20000
    s_waitcnt lgkmcnt(0)
    s_cmp_ge_u32 s31, 72
    s_cbranch_scc1 L_ch_noinit
    v_mov_b32 v16, 1
    v_mov_b32 v17, 1
    v_mov_b32 v18, 1
    v_mov_b32 v19, 1
    v_mov_b32 v20, -1
    v_mov_b32 v21, -1
    buffer_store_dwordx4 v[16:19], v10, s[4:7], s32 offen offset:0
    buffer_store_dwordx4 v[16:19], v10, s[4:7], s32 offen offset:1024
    buffer_store_dwordx4 v[16:19], v10, s[4:7], s32 offen offset:2048
    buffer_store_dwordx4 v[16:19], v10, s[4:7], s32 offen offset:3072
    s_lshl_b32 s60, s31, 7
    s_add_u32 s28, s60, s34
    buffer_store_dwordx2 v[20:21], v4, s[4:7], s28 offen
    s_add_u32 s28, s60, s35
    buffer_store_dwordx2 v[20:21], v4, s[4:7], s28 offen
    v_and_b32 v12, 7, v0
    v_mul_u32_u24 v12, 1152, v12
    v_bfe_u32 v13, v0, 4, 1
    v_lshl_add_u32 v12, v13, 5, v12
    s_lshr_b32 s28, s31, 2
    s_lshl_b32 s28, s28, 6
    s_and_b32 s61, s31, 3
    s_lshl_b32 s61, s61, 3
    s_add_u32 s28, s28, s61
    buffer_load_dwordx2 v[22:23], v12, s[12:15], s28 offen
    s_waitcnt vmcnt(0)
    v_min_u32 v22, -2, v22
    v_min_u32 v23, -2, v23
    s_add_u32 s28, s60, s33
    buffer_store_dwordx2 v[22:23], v4, s[4:7], s28 offen
L_ch_noinit:
    s_waitcnt vmcnt(0)
    s_barrier
    s_cmp_lg_u32 s20, 0
    s_cbranch_scc1 L_arr_2
    s_mov_b64 exec, 1
    v_mov_b32 v2, 1
    buffer_atomic_add v2, off, s[16:19], 0 offset:16 sc1
    s_mov_b64 exec, -1
L_arr_2:
    s_cmp_eq_u32 s24, 0
    s_cbranch_scc1 L_hold_3
    s_mov_b32 s23, 32768
    s_mov_b32 s29, 1
L_spin_4:
    s_sub_u32 s23, s23, 1
    s_cbranch_scc1 L_abort
    s_sleep 2
    s_sleep 4
    buffer_load_dword v2, off, s[16:19], 0 offset:16 sc1
    s_waitcnt vmcnt(0)
    v_cmp_gt_u32 vcc, 256, v2
    s_nop 3
    s_cbranch_vccnz L_spin_4
    s_lshl_b32 s60, s24, 9
    s_add_u32 s60, s60, 114688
    s_mov_b32 s23, 32768
    s_mov_b32 s29, 30
L_spin_5:
    s_sub_u32 s23, s23, 1
    s_cbranch_scc1 L_abort
    s_sleep 2
    s_sleep 16
    buffer_load_dword v2, off, s[4:7], s60 sc1
    s_waitcnt vmcnt(0)
    v_cmp_eq_u32 vcc, 0, v2
    s_nop 3
    s_cbranch_vccnz L_spin_5
L_hold_3:
    v_lshrrev_b32 v40, 4, v0
    s_mul_i32 s28, s20, 4
    v_add_u32 v40, s28, v40
    v_lshrrev_b32 v16, 0, v40
    v_and_b32 v16, 1, v16
    v_lshlrev_b32 v16, 1, v16
    v_lshrrev_b32 v41, 2, v40
    v_and_b32 v41, 1, v41
    v_lshl_or_b32 v16, v41, 2, v16
    v_and_b32 v41, 15, v0
    v_xor_b32 v16, v16, v41
    v_lshlrev_b32 v16, 4, v16
    v_mul_u32_u24 v40, 8192, v40
    v_add_u32 v16, v16, v40
    s_lshl_b32 s28, s20, 3
    v_add_u32 v42, 0, v0
    v_mul_u32_u24 v40, 911, v42
    v_lshrrev_b32 v40, 16, v40
    v_mul_u32_u24 v41, 72, v40
    v_sub_u32 v42, v42, v41
    v_add_u32 v40, s28, v40
    v_lshrrev_b32 v17, 1, v40
    v_and_b32 v17, 3, v17
    v_lshlrev_b32 v17, 1, v17
    v_xor_b32 v17, v17, v42
    v_lshlrev_b32 v17, 4, v17
    v_mul_u32_u24 v40, 1152, v40
    v_add_u32 v17, v17, v40
    v_add_u32 v42, 64, v0
    v_mul_u32_u24 v40, 911, v42
    v_lshrrev_b32 v40, 16, v40
    v_mul_u32_u24 v41, 72, v40
    v_sub_u32 v42, v42, v41
    v_add_u32 v40, s28, v40
    v_lshrrev_b32 v18, 1, v40
    v_and_b32 v18, 3, v18
    v_lshlrev_b32 v18, 1, v18
    v_xor_b32 v18, v18, v42
    v_lshlrev_b32 v18, 4, v18
    v_mul_u32_u24 v40, 1152, v40
    v_add_u32 v18, v18, v40
    v_add_u32 v42, 128, v0
    v_mul_u32_u24 v40, 911, v42
    v_lshrrev_b32 v40, 16, v40
    v_mul_u32_u24 v41, 72, v40
    v_sub_u32 v42, v42, v41
    v_add_u32 v40, s28, v40
    v_lshrrev_b32 v19, 1, v40
    v_and_b32 v19, 3, v19
    v_lshlrev_b32 v19, 1, v19
    v_xor_b32 v19, v19, v42
    v_lshlrev_b32 v19, 4, v19
    v_mul_u32_u24 v40, 1152, v40
    v_add_u32 v19, v19, v40
    v_add_u32 v42, 192, v0
    v_mul_u32_u24 v40, 911, v42
    v_lshrrev_b32 v40, 16, v40
    v_mul_u32_u24 v41, 72, v40
    v_sub_u32 v42, v42, v41
    v_add_u32 v40, s28, v40
    v_lshrrev_b32 v20, 1, v40
    v_and_b32 v20, 3, v20
    v_lshlrev_b32 v20, 1, v20
    v_xor_b32 v20, v20, v42
    v_lshlrev_b32 v20, 4, v20
    v_mul_u32_u24 v40, 1152, v40
    v_add_u32 v20, v20, v40
    v_add_u32 v42, 256, v0
    v_mul_u32_u24 v40, 911, v42
    v_lshrrev_b32 v40, 16, v40
    v_mul_u32_u24 v41, 72, v40
    v_sub_u32 v42, v42, v41
    v_add_u32 v40, s28, v40
    v_lshrrev_b32 v21, 1, v40
    v_and_b32 v21, 3, v21
    v_lshlrev_b32 v21, 1, v21
    v_xor_b32 v21, v21, v42
    v_lshlrev_b32 v21, 4, v21
    v_mul_u32_u24 v40, 1152, v40
    v_add_u32 v21, v21, v40
    v_add_u32 v42, 320, v0
    v_mul_u32_u24 v40, 911, v42
    v_lshrrev_b32 v40, 16, v40
    v_mul_u32_u24 v41, 72, v40
    v_sub_u32 v42, v42, v41
    v_add_u32 v40, s28, v40
    v_lshrrev_b32 v22, 1, v40
    v_and_b32 v22, 3, v22
    v_lshlrev_b32 v22, 1, v22
    v_xor_b32 v22, v22, v42
    v_lshlrev_b32 v22, 4, v22
    v_mul_u32_u24 v40, 1152, v40
    v_add_u32 v22, v22, v40
    v_add_u32 v42, 384, v0
    v_mul_u32_u24 v40, 911, v42
    v_lshrrev_b32 v40, 16, v40
    v_mul_u32_u24 v41, 72, v40
    v_sub_u32 v42, v42, v41
    v_add_u32 v40, s28, v40
    v_lshrrev_b32 v23, 1, v40
    v_and_b32 v23, 3, v23
    v_lshlrev_b32 v23, 1, v23
    v_xor_b32 v23, v23, v42
    v_lshlrev_b32 v23, 4, v23
    v_mul_u32_u24 v40, 1152, v40
    v_add_u32 v23, v23, v40
    v_add_u32 v42, 448, v0
    v_mul_u32_u24 v40, 911, v42
    v_lshrrev_b32 v40, 16, v40
    v_mul_u32_u24 v41, 72, v40
    v_sub_u32 v42, v42, v41
    v_add_u32 v40, s28, v40
    v_lshrrev_b32 v24, 1, v40
    v_and_b32 v24, 3, v24
    v_lshlrev_b32 v24, 1, v24
    v_xor_b32 v24, v24, v42
    v_lshlrev_b32 v24, 4, v24
    v_mul_u32_u24 v40, 1152, v40
    v_add_u32 v24, v24, v40
    v_add_u32 v42, 512, v0
    v_mul_u32_u24 v40, 911, v42
    v_lshrrev_b32 v40, 16, v40
    v_mul_u32_u24 v41, 72, v40
    v_sub_u32 v42, v42, v41
    v_add_u32 v40, s28, v40
    v_lshrrev_b32 v25, 1, v40
    v_and_b32 v25, 3, v25
    v_lshlrev_b32 v25, 1, v25
    v_xor_b32 v25, v25, v42
    v_lshlrev_b32 v25, 4, v25
    v_mul_u32_u24 v40, 1152, v40
    v_add_u32 v25, v25, v40
    s_lshl_b32 s62, s20, 2
    s_lshl_b32 s63, s20, 1
    v_lshrrev_b32 v40, 2, v0
    v_and_b32 v40, 1, v40
    v_lshrrev_b32 v41, 3, v0
    v_and_b32 v41, 1, v41
    v_lshl_or_b32 v40, v41, 2, v40
    v_lshrrev_b32 v41, 5, v0
    v_and_b32 v41, 1, v41
    v_lshl_or_b32 v40, v41, 3, v40
    v_lshrrev_b32 v41, 4, v0
    v_and_b32 v41, 1, v41
    v_lshl_or_b32 v40, v41, 4, v40
    v_lshrrev_b32 v27, 0, v40
    v_and_b32 v27, 1, v27
    v_lshlrev_b32 v27, 1, v27
    v_lshrrev_b32 v41, 2, v40
    v_and_b32 v41, 1, v41
    v_lshl_or_b32 v27, v41, 2, v27
    v_bfe_u32 v41, v0, 1, 1
    v_add_u32 v41, s62, v41
    v_xor_b32 v27, v27, v41
    v_lshlrev_b32 v27, 4, v27
    v_mul_u32_u24 v40, 256, v40
    v_add_u32 v27, v27, v40
    v_and_b32 v41, 1, v0
    v_lshlrev_b32 v41, 3, v41
    v_add_u32 v27, v27, v41
    v_lshrrev_b32 v40, 2, v0
    v_and_b32 v40, 1, v40
    v_lshrrev_b32 v41, 3, v0
    v_and_b32 v41, 1, v41
    v_lshl_or_b32 v40, v41, 2, v40
    v_lshrrev_b32 v41, 5, v0
    v_and_b32 v41, 1, v41
    v_lshl_or_b32 v40, v41, 3, v40
    v_lshrrev_b32 v41, 4, v0
    v_and_b32 v41, 1, v41
    v_lshl_or_b32 v40, v41, 4, v40
    v_lshrrev_b32 v28, 0, v40
    v_and_b32 v28, 1, v28
    v_lshlrev_b32 v28, 1, v28
    v_lshrrev_b32 v41, 2, v40
    v_and_b32 v41, 1, v41
    v_lshl_or_b32 v28, v41, 2, v28
    v_bfe_u32 v41, v0, 1, 1
    v_add_u32 v41, s62, v41
    v_add_u32 v41, 2, v41
    v_xor_b32 v28, v28, v41
    v_lshlrev_b32 v28, 4, v28
    v_mul_u32_u24 v40, 256, v40
    v_add_u32 v28, v28, v40
    v_and_b32 v41, 1, v0
    v_lshlrev_b32 v41, 3, v41
    v_add_u32 v28, v28, v41
    v_lshrrev_b32 v40, 2, v0
    v_lshrrev_b32 v29, 1, v40
    v_and_b32 v29, 3, v29
    v_lshlrev_b32 v29, 1, v29
    v_bfe_u32 v41, v0, 1, 1
    v_add_u32 v41, s62, v41
    v_xor_b32 v29, v29, v41
    v_lshlrev_b32 v29, 4, v29
    v_mul_u32_u24 v40, 1152, v40
    v_add_u32 v29, v29, v40
    v_and_b32 v41, 1, v0
    v_lshlrev_b32 v41, 3, v41
    v_add_u32 v29, v29, v41
    v_lshrrev_b32 v40, 2, v0
    v_lshrrev_b32 v30, 1, v40
    v_and_b32 v30, 3, v30
    v_lshlrev_b32 v30, 1, v30
    v_bfe_u32 v41, v0, 1, 1
    v_add_u32 v41, s62, v41
    v_add_u32 v41, 2, v41
    v_xor_b32 v30, v30, v41
    v_lshlrev_b32 v30, 4, v30
    v_mul_u32_u24 v40, 1152, v40
    v_add_u32 v30, v30, v40
    v_and_b32 v41, 1, v0
    v_lshlrev_b32 v41, 3, v41
    v_add_u32 v30, v30, v41
    v_lshrrev_b32 v40, 2, v0
    v_lshrrev_b32 v31, 1, v40
    v_and_b32 v31, 3, v31
    v_lshlrev_b32 v31, 1, v31
    v_bfe_u32 v41, v0, 1, 1
    v_add_u32 v41, s63, v41
    v_add_u32 v41, 64, v41
    v_xor_b32 v31, v31, v41
    v_lshlrev_b32 v31, 4, v31
    v_mul_u32_u24 v40, 1152, v40
    v_add_u32 v31, v31, v40
    v_and_b32 v41, 1, v0
    v_lshlrev_b32 v41, 3, v41
    v_add_u32 v31, v31, v41
    s_mul_i32 s60, s20, 9216
    s_mul_i32 s61, s21, 147456
    s_load_dwordx2 s[8:9], s[0:1], 24
    s_mov_b32 s10, 4718592
    s_mov_b32 s11, 0x20000
    s_waitcnt lgkmcnt(0)
    s_add_u32 m0, s53, 0
    s_add_u32 s28, s52, 0
    buffer_load_dwordx4 v16, s[8:11], s28 offen lds
    s_add_u32 m0, s53, 4096
    s_add_u32 s28, s52, 131072
    buffer_load_dwordx4 v16, s[8:11], s28 offen lds
    s_add_u32 m0, s53, 8192
    s_add_u32 s28, s52, 262144
    buffer_load_dwordx4 v16, s[8:11], s28 offen lds
    s_add_u32 m0, s53, 12288
    s_add_u32 s28, s52, 393216
    buffer_load_dwordx4 v16, s[8:11], s28 offen lds
    s_add_u32 m0, s53, 16384
    s_add_u32 s28, s52, 524288
    buffer_load_dwordx4 v16, s[8:11], s28 offen lds
    s_add_u32 m0, s53, 20480
    s_add_u32 s28, s52, 655360
    buffer_load_dwordx4 v16, s[8:11], s28 offen lds
    s_add_u32 m0, s53, 24576
    s_add_u32 s28, s52, 786432
    buffer_load_dwordx4 v16, s[8:11], s28 offen lds
    s_add_u32 m0, s53, 28672
    s_add_u32 s28, s52, 917504
    buffer_load_dwordx4 v16, s[8:11], s28 offen lds
    s_add_u32 m0, s53, 32768
    s_add_u32 s28, s52, 1048576
    buffer_load_dwordx4 v16, s[8:11], s28 offen lds
    s_add_u32 m0, s53, 36864
    s_add_u32 s28, s52, 1179648
    buffer_load_dwordx4 v16, s[8:11], s28 offen lds
    s_add_u32 m0, s53, 40960
    s_add_u32 s28, s52, 1310720
    buffer_load_dwordx4 v16, s[8:11], s28 offen lds
    s_add_u32 m0, s53, 45056
    s_add_u32 s28, s52, 1441792
    buffer_load_dwordx4 v16, s[8:11], s28 offen lds
    s_add_u32 m0, s53, 49152
    s_add_u32 s28, s52, 1572864
    buffer_load_dwordx4 v16, s[8:11], s28 offen lds
    s_add_u32 m0, s53, 53248
    s_add_u32 s28, s52, 1703936
    buffer_load_dwordx4 v16, s[8:11], s28 offen lds
    s_add_u32 m0, s53, 57344
    s_add_u32 s28, s52, 1835008
    buffer_load_dwordx4 v16, s[8:11], s28 offen lds
    s_add_u32 m0, s53, 61440
    s_add_u32 s28, s52, 1966080
    buffer_load_dwordx4 v16, s[8:11], s28 offen lds
    s_add_u32 m0, s53, 65536
    s_add_u32 s28, s52, 2097152
    buffer_load_dwordx4 v16, s[8:11], s28 offen lds
    s_add_u32 m0, s53, 69632
    s_add_u32 s28, s52, 2228224
    buffer_load_dwordx4 v16, s[8:11], s28 offen lds
    s_load_dwordx2 s[8:9], s[0:1], 24
    s_mov_b32 s10, 4718592
    s_mov_b32 s11, 0x20000
    s_waitcnt lgkmcnt(0)
    s_add_u32 m0, s53, 73728
    s_add_u32 s28, s52, 2359296
    buffer_load_dwordx4 v16, s[8:11], s28 offen lds
    s_add_u32 m0, s53, 77824
    s_add_u32 s28, s52, 2490368
    buffer_load_dwordx4 v16, s[8:11], s28 offen lds
    s_add_u32 m0, s53, 81920
    s_add_u32 s28, s52, 2621440
    buffer_load_dwordx4 v16, s[8:11], s28 offen lds
    s_add_u32 m0, s53, 86016
    s_add_u32 s28, s52, 2752512
    buffer_load_dwordx4 v16, s[8:11], s28 offen lds
    s_add_u32 m0, s53, 90112
    s_add_u32 s28, s52, 2883584
    buffer_load_dwordx4 v16, s[8:11], s28 offen lds
    s_add_u32 m0, s53, 94208
    s_add_u32 s28, s52, 3014656
    buffer_load_dwordx4 v16, s[8:11], s28 offen lds
    s_add_u32 m0, s53, 98304
    s_add_u32 s28, s52, 3145728
    buffer_load_dwordx4 v16, s[8:11], s28 offen lds
    s_add_u32 m0, s53, 102400
    s_add_u32 s28, s52, 3276800
    buffer_load_dwordx4 v16, s[8:11], s28 offen lds
    s_add_u32 m0, s53, 106496
    s_add_u32 s28, s52, 3407872
    buffer_load_dwordx4 v16, s[8:11], s28 offen lds
    s_add_u32 m0, s53, 110592
    s_add_u32 s28, s52, 3538944
    buffer_load_dwordx4 v16, s[8:11], s28 offen lds
    s_add_u32 m0, s53, 114688
    s_add_u32 s28, s52, 3670016
    buffer_load_dwordx4 v16, s[8:11], s28 offen lds
    s_add_u32 m0, s53, 118784
    s_add_u32 s28, s52, 3801088
    buffer_load_dwordx4 v16, s[8:11], s28 offen lds
    s_add_u32 m0, s53, 122880
    s_add_u32 s28, s52, 3932160
    buffer_load_dwordx4 v16, s[8:11], s28 offen lds
    s_add_u32 m0, s53, 126976
    s_add_u32 s28, s52, 4063232
    buffer_load_dwordx4 v16, s[8:11], s28 offen lds
    s_add_u32 m0, s53, 131072
    s_add_u32 s28, s52, 4194304
    buffer_load_dwordx4 v16, s[8:11], s28 offen lds
    s_add_u32 m0, s53, 135168
    s_add_u32 s28, s52, 4325376
    buffer_load_dwordx4 v16, s[8:11], s28 offen lds
    s_add_u32 m0, s53, 139264
    s_add_u32 s28, s52, 4456448
    buffer_load_dwordx4 v16, s[8:11], s28 offen lds
    s_add_u32 m0, s53, 143360
    s_add_u32 s28, s52, 4587520
    buffer_load_dwordx4 v16, s[8:11], s28 offen lds
    s_waitcnt vmcnt(18)
    s_barrier
    ds_read_b64_tr_b16 v[88:89], v27 offset:0
    ds_read_b64_tr_b16 v[90:91], v27 offset:512
    ds_read_b64_tr_b16 v[96:97], v28 offset:0
    ds_read_b64_tr_b16 v[98:99], v28 offset:512
    ds_read_b64_tr_b16 v[92:93], v27 offset:8192
    ds_read_b64_tr_b16 v[94:95], v27 offset:8704
    ds_read_b64_tr_b16 v[100:101], v28 offset:8192
    ds_read_b64_tr_b16 v[102:103], v28 offset:8704
    ds_read_b64_tr_b16 v[104:105], v27 offset:16384
    ds_read_b64_tr_b16 v[106:107], v27 offset:16896
    ds_read_b64_tr_b16 v[112:113], v28 offset:16384
    ds_read_b64_tr_b16 v[114:115], v28 offset:16896
    ds_read_b64_tr_b16 v[108:109], v27 offset:24576
    ds_read_b64_tr_b16 v[110:111], v27 offset:25088
    ds_read_b64_tr_b16 v[116:117], v28 offset:24576
    ds_read_b64_tr_b16 v[118:119], v28 offset:25088
    ds_read_b64_tr_b16 v[120:121], v27 offset:32768
    ds_read_b64_tr_b16 v[122:123], v27 offset:33280
    ds_read_b64_tr_b16 v[128:129], v28 offset:32768
    ds_read_b64_tr_b16 v[130:131], v28 offset:33280
    ds_read_b64_tr_b16 v[124:125], v27 offset:40960
    ds_read_b64_tr_b16 v[126:127], v27 offset:41472
    ds_read_b64_tr_b16 v[132:133], v28 offset:40960
    ds_read_b64_tr_b16 v[134:135], v28 offset:41472
    ds_read_b64_tr_b16 v[136:137], v27 offset:49152
    ds_read_b64_tr_b16 v[138:139], v27 offset:49664
    ds_read_b64_tr_b16 v[144:145], v28 offset:49152
    ds_read_b64_tr_b16 v[146:147], v28 offset:49664
    ds_read_b64_tr_b16 v[140:141], v27 offset:57344
    ds_read_b64_tr_b16 v[142:143], v27 offset:57856
    ds_read_b64_tr_b16 v[148:149], v28 offset:57344
    ds_read_b64_tr_b16 v[150:151], v28 offset:57856
    v_add_u32 v32, 65536, v27
    ds_read_b64_tr_b16 v[152:153], v32 offset:0
    ds_read_b64_tr_b16 v[154:155], v32 offset:512
    v_add_u32 v32, 65536, v28
    ds_read_b64_tr_b16 v[160:161], v32 offset:0
    ds_read_b64_tr_b16 v[162:163], v32 offset:512
    s_waitcnt lgkmcnt(0)
    s_barrier
    s_load_dwordx2 s[8:9], s[0:1], 32
    s_mov_b32 s10, 4718592
    s_mov_b32 s11, 0x20000
    s_waitcnt lgkmcnt(0)
    s_add_u32 m0, s53, 0
    s_add_u32 s28, s52, 0
    buffer_load_dwordx4 v16, s[8:11], s28 offen lds
    s_add_u32 m0, s53, 4096
    s_add_u32 s28, s52, 131072
    buffer_load_dwordx4 v16, s[8:11], s28 offen lds
    s_add_u32 m0, s53, 8192
    s_add_u32 s28, s52, 262144
    buffer_load_dwordx4 v16, s[8:11], s28 offen lds
    s_add_u32 m0, s53, 12288
    s_add_u32 s28, s52, 393216
    buffer_load_dwordx4 v16, s[8:11], s28 offen lds
    s_add_u32 m0, s53, 16384
    s_add_u32 s28, s52, 524288
    buffer_load_dwordx4 v16, s[8:11], s28 offen lds
    s_add_u32 m0, s53, 20480
    s_add_u32 s28, s52, 655360
    buffer_load_dwordx4 v16, s[8:11], s28 offen lds
    s_add_u32 m0, s53, 24576
    s_add_u32 s28, s52, 786432
    buffer_load_dwordx4 v16, s[8:11], s28 offen lds
    s_add_u32 m0, s53, 28672
    s_add_u32 s28, s52, 917504
    buffer_load_dwordx4 v16, s[8:11], s28 offen lds
    s_add_u32 m0, s53, 32768
    s_add_u32 s28, s52, 1048576
    buffer_load_dwordx4 v16, s[8:11], s28 offen lds
    s_add_u32 m0, s53, 36864
    s_add_u32 s28, s52, 1179648
    buffer_load_dwordx4 v16, s[8:11], s28 offen lds
    s_add_u32 m0, s53, 40960
    s_add_u32 s28, s52, 1310720
    buffer_load_dwordx4 v16, s[8:11], s28 offen lds
    s_add_u32 m0, s53, 45056
    s_add_u32 s28, s52, 1441792
    buffer_load_dwordx4 v16, s[8:11], s28 offen lds
    s_add_u32 m0, s53, 49152
    s_add_u32 s28, s52, 1572864
    buffer_load_dwordx4 v16, s[8:11], s28 offen lds
    s_add_u32 m0, s53, 53248
    s_add_u32 s28, s52, 1703936
    buffer_load_dwordx4 v16, s[8:11], s28 offen lds
    s_add_u32 m0, s53, 57344
    s_add_u32 s28, s52, 1835008
    buffer_load_dwordx4 v16, s[8:11], s28 offen lds
    s_add_u32 m0, s53, 61440
    s_add_u32 s28, s52, 1966080
    buffer_load_dwordx4 v16, s[8:11], s28 offen lds
    s_add_u32 m0, s53, 65536
    s_add_u32 s28, s52, 2097152
    buffer_load_dwordx4 v16, s[8:11], s28 offen lds
    s_add_u32 m0, s53, 69632
    s_add_u32 s28, s52, 2228224
    buffer_load_dwordx4 v16, s[8:11], s28 offen lds
    s_waitcnt vmcnt(18)
    s_barrier
    v_add_u32 v32, 65536, v27
    ds_read_b64_tr_b16 v[156:157], v32 offset:8192
    ds_read_b64_tr_b16 v[158:159], v32 offset:8704
    v_add_u32 v32, 65536, v28
    ds_read_b64_tr_b16 v[164:165], v32 offset:8192
    ds_read_b64_tr_b16 v[166:167], v32 offset:8704
    v_add_u32 v32, 65536, v27
    ds_read_b64_tr_b16 v[168:169], v32 offset:16384
    ds_read_b64_tr_b16 v[170:171], v32 offset:16896
    v_add_u32 v32, 65536, v28
    ds_read_b64_tr_b16 v[176:177], v32 offset:16384
    ds_read_b64_tr_b16 v[178:179], v32 offset:16896
    v_add_u32 v32, 65536, v27
    ds_read_b64_tr_b16 v[172:173], v32 offset:24576
    ds_read_b64_tr_b16 v[174:175], v32 offset:25088
    v_add_u32 v32, 65536, v28
    ds_read_b64_tr_b16 v[180:181], v32 offset:24576
    ds_read_b64_tr_b16 v[182:183], v32 offset:25088
    v_add_u32 v32, 98304, v27
    ds_read_b64_tr_b16 v[184:185], v32 offset:0
    ds_read_b64_tr_b16 v[186:187], v32 offset:512
    v_add_u32 v32, 98304, v28
    ds_read_b64_tr_b16 v[192:193], v32 offset:0
    ds_read_b64_tr_b16 v[194:195], v32 offset:512
    v_add_u32 v32, 98304, v27
    ds_read_b64_tr_b16 v[188:189], v32 offset:8192
    ds_read_b64_tr_b16 v[190:191], v32 offset:8704
    v_add_u32 v32, 98304, v28
    ds_read_b64_tr_b16 v[196:197], v32 offset:8192
    ds_read_b64_tr_b16 v[198:199], v32 offset:8704
    v_add_u32 v32, 98304, v27
    ds_read_b64_tr_b16 v[200:201], v32 offset:16384
    ds_read_b64_tr_b16 v[202:203], v32 offset:16896
    v_add_u32 v32, 98304, v28
    ds_read_b64_tr_b16 v[208:209], v32 offset:16384
    ds_read_b64_tr_b16 v[210:211], v32 offset:16896
    v_add_u32 v32, 98304, v27
    ds_read_b64_tr_b16 v[204:205], v32 offset:24576
    ds_read_b64_tr_b16 v[206:207], v32 offset:25088
    v_add_u32 v32, 98304, v28
    ds_read_b64_tr_b16 v[212:213], v32 offset:24576
    ds_read_b64_tr_b16 v[214:215], v32 offset:25088
    v_add_u32 v32, 131072, v27
    ds_read_b64_tr_b16 v[216:217], v32 offset:0
    ds_read_b64_tr_b16 v[218:219], v32 offset:512
    v_add_u32 v32, 131072, v28
    ds_read_b64_tr_b16 v[224:225], v32 offset:0
    ds_read_b64_tr_b16 v[226:227], v32 offset:512
    v_add_u32 v32, 131072, v27
    ds_read_b64_tr_b16 v[220:221], v32 offset:8192
    ds_read_b64_tr_b16 v[222:223], v32 offset:8704
    v_add_u32 v32, 131072, v28
    ds_read_b64_tr_b16 v[228:229], v32 offset:8192
    ds_read_b64_tr_b16 v[230:231], v32 offset:8704
    s_waitcnt lgkmcnt(0)
    s_barrier
    s_load_dwordx2 s[8:9], s[0:1], 32
    s_mov_b32 s10, 4718592
    s_mov_b32 s11, 0x20000
    s_waitcnt lgkmcnt(0)
    s_add_u32 m0, s53, 73728
    s_add_u32 s28, s52, 2359296
    buffer_load_dwordx4 v16, s[8:11], s28 offen lds
    s_add_u32 m0, s53, 77824
    s_add_u32 s28, s52, 2490368
    buffer_load_dwordx4 v16, s[8:11], s28 offen lds
    s_add_u32 m0, s53, 81920
    s_add_u32 s28, s52, 2621440
    buffer_load_dwordx4 v16, s[8:11], s28 offen lds
    s_add_u32 m0, s53, 86016
    s_add_u32 s28, s52, 2752512
    buffer_load_dwordx4 v16, s[8:11], s28 offen lds
    s_add_u32 m0, s53, 90112
    s_add_u32 s28, s52, 2883584
    buffer_load_dwordx4 v16, s[8:11], s28 offen lds
    s_add_u32 m0, s53, 94208
    s_add_u32 s28, s52, 3014656
    buffer_load_dwordx4 v16, s[8:11], s28 offen lds
    s_add_u32 m0, s53, 98304
    s_add_u32 s28, s52, 3145728
    buffer_load_dwordx4 v16, s[8:11], s28 offen lds
    s_add_u32 m0, s53, 102400
    s_add_u32 s28, s52, 3276800
    buffer_load_dwordx4 v16, s[8:11], s28 offen lds
    s_add_u32 m0, s53, 106496
    s_add_u32 s28, s52, 3407872
    buffer_load_dwordx4 v16, s[8:11], s28 offen lds
    s_add_u32 m0, s53, 110592
    s_add_u32 s28, s52, 3538944
    buffer_load_dwordx4 v16, s[8:11], s28 offen lds
    s_add_u32 m0, s53, 114688
    s_add_u32 s28, s52, 3670016
    buffer_load_dwordx4 v16, s[8:11], s28 offen lds
    s_add_u32 m0, s53, 118784
    s_add_u32 s28, s52, 3801088
    buffer_load_dwordx4 v16, s[8:11], s28 offen lds
    s_add_u32 m0, s53, 122880
    s_add_u32 s28, s52, 3932160
    buffer_load_dwordx4 v16, s[8:11], s28 offen lds
    s_add_u32 m0, s53, 126976
    s_add_u32 s28, s52, 4063232
    buffer_load_dwordx4 v16, s[8:11], s28 offen lds
    s_add_u32 m0, s53, 131072
    s_add_u32 s28, s52, 4194304
    buffer_load_dwordx4 v16, s[8:11], s28 offen lds
    s_add_u32 m0, s53, 135168
    s_add_u32 s28, s52, 4325376
    buffer_load_dwordx4 v16, s[8:11], s28 offen lds
    s_add_u32 m0, s53, 139264
    s_add_u32 s28, s52, 4456448
    buffer_load_dwordx4 v16, s[8:11], s28 offen lds
    s_add_u32 m0, s53, 143360
    s_add_u32 s28, s52, 4587520
    buffer_load_dwordx4 v16, s[8:11], s28 offen lds
    s_add_u32 s28, s22, s20
    s_cmp_lg_u32 s28, 0
    s_cbranch_scc1 L_ch_nh0
    s_mov_b32 s23, 32768
    s_mov_b32 s29, 1
L_spin_6:
    s_sub_u32 s23, s23, 1
    s_cbranch_scc1 L_abort
    s_sleep 2
    s_sleep 4
    buffer_load_dword v43, off, s[16:19], 0 offset:16 sc1
    s_waitcnt vmcnt(0)
    v_cmp_gt_u32 vcc, 256, v43
    s_nop 3
    s_cbranch_vccnz L_spin_6
    s_mov_b32 s28, 114688
    buffer_store_dword v43, off, s[4:7], s28 sc1
L_ch_nh0:
    s_waitcnt vmcnt(18)
    s_barrier
    ds_read_b64_tr_b16 v[232:233], v27 offset:0
    ds_read_b64_tr_b16 v[234:235], v27 offset:512
    ds_read_b64_tr_b16 v[240:241], v28 offset:0
    ds_read_b64_tr_b16 v[242:243], v28 offset:512
    ds_read_b64_tr_b16 v[236:237], v27 offset:8192
    ds_read_b64_tr_b16 v[238:239], v27 offset:8704
    ds_read_b64_tr_b16 v[244:245], v28 offset:8192
    ds_read_b64_tr_b16 v[246:247], v28 offset:8704
    ds_read_b64_tr_b16 v[248:249], v27 offset:16384
    ds_read_b64_tr_b16 v[250:251], v27 offset:16896
    ds_read_b64_tr_b16 a[0:1], v28 offset:16384
    ds_read_b64_tr_b16 a[2:3], v28 offset:16896
    ds_read_b64_tr_b16 v[252:253], v27 offset:24576
    ds_read_b64_tr_b16 v[254:255], v27 offset:25088
    ds_read_b64_tr_b16 a[4:5], v28 offset:24576
    ds_read_b64_tr_b16 a[6:7], v28 offset:25088
    ds_read_b64_tr_b16 a[8:9], v27 offset:32768
    ds_read_b64_tr_b16 a[10:11], v27 offset:33280
    ds_read_b64_tr_b16 a[16:17], v28 offset:32768
    ds_read_b64_tr_b16 a[18:19], v28 offset:33280
    ds_read_b64_tr_b16 a[12:13], v27 offset:40960
    ds_read_b64_tr_b16 a[14:15], v27 offset:41472
    ds_read_b64_tr_b16 a[20:21], v28 offset:40960
    ds_read_b64_tr_b16 a[22:23], v28 offset:41472
    ds_read_b64_tr_b16 a[24:25], v27 offset:49152
    ds_read_b64_tr_b16 a[26:27], v27 offset:49664
    ds_read_b64_tr_b16 a[32:33], v28 offset:49152
    ds_read_b64_tr_b16 a[34:35], v28 offset:49664
    ds_read_b64_tr_b16 a[28:29], v27 offset:57344
    ds_read_b64_tr_b16 a[30:31], v27 offset:57856
    ds_read_b64_tr_b16 a[36:37], v28 offset:57344
    ds_read_b64_tr_b16 a[38:39], v28 offset:57856
    v_add_u32 v32, 65536, v27
    ds_read_b64_tr_b16 a[40:41], v32 offset:0
    ds_read_b64_tr_b16 a[42:43], v32 offset:512
    v_add_u32 v32, 65536, v28
    ds_read_b64_tr_b16 a[48:49], v32 offset:0
    ds_read_b64_tr_b16 a[50:51], v32 offset:512
    s_waitcnt lgkmcnt(0)
    s_barrier
    s_load_dwordx2 s[8:9], s[0:1], 16
    s_mov_b32 s10, 4718592
    s_mov_b32 s11, 0x20000
    s_waitcnt lgkmcnt(0)
    s_add_u32 m0, s53, 0
    s_add_u32 s28, s52, 524288
    buffer_load_dwordx4 v16, s[8:11], s28 offen lds
    s_add_u32 m0, s53, 4096
    s_add_u32 s28, s52, 655360
    buffer_load_dwordx4 v16, s[8:11], s28 offen lds
    s_add_u32 m0, s53, 8192
    s_add_u32 s28, s52, 786432
    buffer_load_dwordx4 v16, s[8:11], s28 offen lds
    s_add_u32 m0, s53, 12288
    s_add_u32 s28, s52, 917504
    buffer_load_dwordx4 v16, s[8:11], s28 offen lds
    s_add_u32 m0, s53, 16384
    s_add_u32 s28, s52, 1572864
    buffer_load_dwordx4 v16, s[8:11], s28 offen lds
    s_add_u32 m0, s53, 20480
    s_add_u32 s28, s52, 1703936
    buffer_load_dwordx4 v16, s[8:11], s28 offen lds
    s_add_u32 m0, s53, 24576
    s_add_u32 s28, s52, 1835008
    buffer_load_dwordx4 v16, s[8:11], s28 offen lds
    s_add_u32 m0, s53, 28672
    s_add_u32 s28, s52, 1966080
    buffer_load_dwordx4 v16, s[8:11], s28 offen lds
    s_add_u32 m0, s53, 32768
    s_add_u32 s28, s52, 2621440
    buffer_load_dwordx4 v16, s[8:11], s28 offen lds
    s_add_u32 m0, s53, 36864
    s_add_u32 s28, s52, 2752512
    buffer_load_dwordx4 v16, s[8:11], s28 offen lds
    s_add_u32 m0, s53, 40960
    s_add_u32 s28, s52, 2883584
    buffer_load_dwordx4 v16, s[8:11], s28 offen lds
    s_add_u32 m0, s53, 45056
    s_add_u32 s28, s52, 3014656
    buffer_load_dwordx4 v16, s[8:11], s28 offen lds
    s_add_u32 m0, s53, 49152
    s_add_u32 s28, s52, 3670016
    buffer_load_dwordx4 v16, s[8:11], s28 offen lds
    s_add_u32 m0, s53, 53248
    s_add_u32 s28, s52, 3801088
    buffer_load_dwordx4 v16, s[8:11], s28 offen lds
    s_add_u32 m0, s53, 57344
    s_add_u32 s28, s52, 3932160
    buffer_load_dwordx4 v16, s[8:11], s28 offen lds
    s_add_u32 m0, s53, 61440
    s_add_u32 s28, s52, 4063232
    buffer_load_dwordx4 v16, s[8:11], s28 offen lds
    s_add_u32 m0, s53, 65536
    s_add_u32 s28, s52, 4456448
    buffer_load_dwordx4 v16, s[8:11], s28 offen lds
    s_add_u32 m0, s53, 69632
    s_add_u32 s28, s52, 4587520
    buffer_load_dwordx4 v16, s[8:11], s28 offen lds
    s_waitcnt vmcnt(18)
    s_barrier
    v_add_u32 v32, 65536, v27
    ds_read_b64_tr_b16 a[44:45], v32 offset:8192
    ds_read_b64_tr_b16 a[46:47], v32 offset:8704
    v_add_u32 v32, 65536, v28
    ds_read_b64_tr_b16 a[52:53], v32 offset:8192
    ds_read_b64_tr_b16 a[54:55], v32 offset:8704
    v_add_u32 v32, 65536, v27
    ds_read_b64_tr_b16 a[56:57], v32 offset:16384
    ds_read_b64_tr_b16 a[58:59], v32 offset:16896
    v_add_u32 v32, 65536, v28
    ds_read_b64_tr_b16 a[64:65], v32 offset:16384
    ds_read_b64_tr_b16 a[66:67], v32 offset:16896
    v_add_u32 v32, 65536, v27
    ds_read_b64_tr_b16 a[60:61], v32 offset:24576
    ds_read_b64_tr_b16 a[62:63], v32 offset:25088
    v_add_u32 v32, 65536, v28
    ds_read_b64_tr_b16 a[68:69], v32 offset:24576
    ds_read_b64_tr_b16 a[70:71], v32 offset:25088
    v_add_u32 v32, 98304, v27
    ds_read_b64_tr_b16 a[72:73], v32 offset:0
    ds_read_b64_tr_b16 a[74:75], v32 offset:512
    v_add_u32 v32, 98304, v28
    ds_read_b64_tr_b16 a[80:81], v32 offset:0
    ds_read_b64_tr_b16 a[82:83], v32 offset:512
    v_add_u32 v32, 98304, v27
    ds_read_b64_tr_b16 a[76:77], v32 offset:8192
    ds_read_b64_tr_b16 a[78:79], v32 offset:8704
    v_add_u32 v32, 98304, v28
    ds_read_b64_tr_b16 a[84:85], v32 offset:8192
    ds_read_b64_tr_b16 a[86:87], v32 offset:8704
    v_add_u32 v32, 98304, v27
    ds_read_b64_tr_b16 a[88:89], v32 offset:16384
    ds_read_b64_tr_b16 a[90:91], v32 offset:16896
    v_add_u32 v32, 98304, v28
    ds_read_b64_tr_b16 a[96:97], v32 offset:16384
    ds_read_b64_tr_b16 a[98:99], v32 offset:16896
    v_add_u32 v32, 98304, v27
    ds_read_b64_tr_b16 a[92:93], v32 offset:24576
    ds_read_b64_tr_b16 a[94:95], v32 offset:25088
    v_add_u32 v32, 98304, v28
    ds_read_b64_tr_b16 a[100:101], v32 offset:24576
    ds_read_b64_tr_b16 a[102:103], v32 offset:25088
    v_add_u32 v32, 131072, v27
    ds_read_b64_tr_b16 a[104:105], v32 offset:0
    ds_read_b64_tr_b16 a[106:107], v32 offset:512
    v_add_u32 v32, 131072, v28
    ds_read_b64_tr_b16 a[112:113], v32 offset:0
    ds_read_b64_tr_b16 a[114:115], v32 offset:512
    v_add_u32 v32, 131072, v27
    ds_read_b64_tr_b16 a[108:109], v32 offset:8192
    ds_read_b64_tr_b16 a[110:111], v32 offset:8704
    v_add_u32 v32, 131072, v28
    ds_read_b64_tr_b16 a[116:117], v32 offset:8192
    ds_read_b64_tr_b16 a[118:119], v32 offset:8704
    s_waitcnt lgkmcnt(0)
    s_barrier
    s_load_dwordx2 s[8:9], s[0:1], 40
    s_mov_b32 s10, 4718592
    s_mov_b32 s11, 0x20000
    s_waitcnt lgkmcnt(0)
    s_add_u32 m0, s60, 73728
    s_add_u32 s28, s61, 0
    buffer_load_dwordx4 v17, s[8:11], s28 offen lds
    s_add_u32 m0, s60, 74752
    s_add_u32 s28, s61, 0
    buffer_load_dwordx4 v18, s[8:11], s28 offen lds
    s_add_u32 m0, s60, 75776
    s_add_u32 s28, s61, 0
    buffer_load_dwordx4 v19, s[8:11], s28 offen lds
    s_add_u32 m0, s60, 76800
    s_add_u32 s28, s61, 0
    buffer_load_dwordx4 v20, s[8:11], s28 offen lds
    s_add_u32 m0, s60, 77824
    s_add_u32 s28, s61, 0
    buffer_load_dwordx4 v21, s[8:11], s28 offen lds
    s_add_u32 m0, s60, 78848
    s_add_u32 s28, s61, 0
    buffer_load_dwordx4 v22, s[8:11], s28 offen lds
    s_add_u32 m0, s60, 79872
    s_add_u32 s28, s61, 0
    buffer_load_dwordx4 v23, s[8:11], s28 offen lds
    s_add_u32 m0, s60, 80896
    s_add_u32 s28, s61, 0
    buffer_load_dwordx4 v24, s[8:11], s28 offen lds
    s_add_u32 m0, s60, 81920
    s_add_u32 s28, s61, 0
    buffer_load_dwordx4 v25, s[8:11], s28 offen lds
    s_add_u32 m0, s60, 110592
    s_add_u32 s28, s61, 36864
    buffer_load_dwordx4 v17, s[8:11], s28 offen lds
    s_add_u32 m0, s60, 111616
    s_add_u32 s28, s61, 36864
    buffer_load_dwordx4 v18, s[8:11], s28 offen lds
    s_add_u32 m0, s60, 112640
    s_add_u32 s28, s61, 36864
    buffer_load_dwordx4 v19, s[8:11], s28 offen lds
    s_add_u32 m0, s60, 113664
    s_add_u32 s28, s61, 36864
    buffer_load_dwordx4 v20, s[8:11], s28 offen lds
    s_add_u32 m0, s60, 114688
    s_add_u32 s28, s61, 36864
    buffer_load_dwordx4 v21, s[8:11], s28 offen lds
    s_add_u32 m0, s60, 115712
    s_add_u32 s28, s61, 36864
    buffer_load_dwordx4 v22, s[8:11], s28 offen lds
    s_add_u32 m0, s60, 116736
    s_add_u32 s28, s61, 36864
    buffer_load_dwordx4 v23, s[8:11], s28 offen lds
    s_add_u32 m0, s60, 117760
    s_add_u32 s28, s61, 36864
    buffer_load_dwordx4 v24, s[8:11], s28 offen lds
    s_add_u32 m0, s60, 118784
    s_add_u32 s28, s61, 36864
    buffer_load_dwordx4 v25, s[8:11], s28 offen lds
    s_waitcnt vmcnt(18)
    s_barrier
    ds_read_b64_tr_b16 a[120:121], v27 offset:0
    ds_read_b64_tr_b16 a[122:123], v27 offset:512
    ds_read_b64_tr_b16 a[128:129], v28 offset:0
    ds_read_b64_tr_b16 a[130:131], v28 offset:512
    ds_read_b64_tr_b16 a[124:125], v27 offset:8192
    ds_read_b64_tr_b16 a[126:127], v27 offset:8704
    ds_read_b64_tr_b16 a[132:133], v28 offset:8192
    ds_read_b64_tr_b16 a[134:135], v28 offset:8704
    ds_read_b64_tr_b16 a[136:137], v27 offset:16384
    ds_read_b64_tr_b16 a[138:139], v27 offset:16896
    ds_read_b64_tr_b16 a[144:145], v28 offset:16384
    ds_read_b64_tr_b16 a[146:147], v28 offset:16896
    ds_read_b64_tr_b16 a[140:141], v27 offset:24576
    ds_read_b64_tr_b16 a[142:143], v27 offset:25088
    ds_read_b64_tr_b16 a[148:149], v28 offset:24576
    ds_read_b64_tr_b16 a[150:151], v28 offset:25088
    ds_read_b64_tr_b16 a[152:153], v27 offset:32768
    ds_read_b64_tr_b16 a[154:155], v27 offset:33280
    ds_read_b64_tr_b16 a[160:161], v28 offset:32768
    ds_read_b64_tr_b16 a[162:163], v28 offset:33280
    ds_read_b64_tr_b16 a[156:157], v27 offset:40960
    ds_read_b64_tr_b16 a[158:159], v27 offset:41472
    ds_read_b64_tr_b16 a[164:165], v28 offset:40960
    ds_read_b64_tr_b16 a[166:167], v28 offset:41472
    ds_read_b64_tr_b16 a[168:169], v27 offset:49152
    ds_read_b64_tr_b16 a[170:171], v27 offset:49664
    ds_read_b64_tr_b16 a[176:177], v28 offset:49152
    ds_read_b64_tr_b16 a[178:179], v28 offset:49664
    ds_read_b64_tr_b16 a[172:173], v27 offset:57344
    ds_read_b64_tr_b16 a[174:175], v27 offset:57856
    ds_read_b64_tr_b16 a[180:181], v28 offset:57344
    ds_read_b64_tr_b16 a[182:183], v28 offset:57856
    v_add_u32 v32, 65536, v27
    ds_read_b64_tr_b16 v[76:77], v32 offset:0
    ds_read_b64_tr_b16 v[78:79], v32 offset:512
    v_add_u32 v32, 65536, v28
    ds_read_b64_tr_b16 v[84:85], v32 offset:0
    ds_read_b64_tr_b16 v[86:87], v32 offset:512
    s_waitcnt lgkmcnt(0)
    s_barrier
    s_load_dwordx2 s[8:9], s[0:1], 16
    s_mov_b32 s10, 4718592
    s_mov_b32 s11, 0x20000
    s_waitcnt lgkmcnt(0)
    s_add_u32 m0, s53, 0
    s_add_u32 s28, s52, 0
    buffer_load_dwordx4 v16, s[8:11], s28 offen lds
    s_add_u32 m0, s53, 4096
    s_add_u32 s28, s52, 131072
    buffer_load_dwordx4 v16, s[8:11], s28 offen lds
    s_add_u32 m0, s53, 8192
    s_add_u32 s28, s52, 262144
    buffer_load_dwordx4 v16, s[8:11], s28 offen lds
    s_add_u32 m0, s53, 12288
    s_add_u32 s28, s52, 393216
    buffer_load_dwordx4 v16, s[8:11], s28 offen lds
    s_add_u32 m0, s53, 16384
    s_add_u32 s28, s52, 1048576
    buffer_load_dwordx4 v16, s[8:11], s28 offen lds
    s_add_u32 m0, s53, 20480
    s_add_u32 s28, s52, 1179648
    buffer_load_dwordx4 v16, s[8:11], s28 offen lds
    s_add_u32 m0, s53, 24576
    s_add_u32 s28, s52, 1310720
    buffer_load_dwordx4 v16, s[8:11], s28 offen lds
    s_add_u32 m0, s53, 28672
    s_add_u32 s28, s52, 1441792
    buffer_load_dwordx4 v16, s[8:11], s28 offen lds
    s_add_u32 m0, s53, 32768
    s_add_u32 s28, s52, 2097152
    buffer_load_dwordx4 v16, s[8:11], s28 offen lds
    s_add_u32 m0, s53, 36864
    s_add_u32 s28, s52, 2228224
    buffer_load_dwordx4 v16, s[8:11], s28 offen lds
    s_add_u32 m0, s53, 40960
    s_add_u32 s28, s52, 2359296
    buffer_load_dwordx4 v16, s[8:11], s28 offen lds
    s_add_u32 m0, s53, 45056
    s_add_u32 s28, s52, 2490368
    buffer_load_dwordx4 v16, s[8:11], s28 offen lds
    s_add_u32 m0, s53, 49152
    s_add_u32 s28, s52, 3145728
    buffer_load_dwordx4 v16, s[8:11], s28 offen lds
    s_add_u32 m0, s53, 53248
    s_add_u32 s28, s52, 3276800
    buffer_load_dwordx4 v16, s[8:11], s28 offen lds
    s_add_u32 m0, s53, 57344
    s_add_u32 s28, s52, 3407872
    buffer_load_dwordx4 v16, s[8:11], s28 offen lds
    s_add_u32 m0, s53, 61440
    s_add_u32 s28, s52, 3538944
    buffer_load_dwordx4 v16, s[8:11], s28 offen lds
    s_add_u32 m0, s53, 65536
    s_add_u32 s28, s52, 4194304
    buffer_load_dwordx4 v16, s[8:11], s28 offen lds
    s_add_u32 m0, s53, 69632
    s_add_u32 s28, s52, 4325376
    buffer_load_dwordx4 v16, s[8:11], s28 offen lds
    s_waitcnt vmcnt(18)
    s_barrier
    v_add_u32 v32, 65536, v29
    ds_read_b64_tr_b16 a[184:185], v32 offset:8192
    ds_read_b64_tr_b16 a[186:187], v32 offset:26624
    v_add_u32 v32, 65536, v30
    ds_read_b64_tr_b16 a[192:193], v32 offset:8192
    ds_read_b64_tr_b16 a[194:195], v32 offset:26624
    v_add_u32 v32, 65536, v29
    ds_read_b64_tr_b16 a[200:201], v32 offset:8448
    ds_read_b64_tr_b16 a[202:203], v32 offset:26880
    v_add_u32 v32, 65536, v30
    ds_read_b64_tr_b16 a[208:209], v32 offset:8448
    ds_read_b64_tr_b16 a[210:211], v32 offset:26880
    v_add_u32 v32, 65536, v29
    ds_read_b64_tr_b16 a[216:217], v32 offset:8704
    ds_read_b64_tr_b16 a[218:219], v32 offset:27136
    v_add_u32 v32, 65536, v30
    ds_read_b64_tr_b16 a[224:225], v32 offset:8704
    ds_read_b64_tr_b16 a[226:227], v32 offset:27136
    v_add_u32 v32, 65536, v29
    ds_read_b64_tr_b16 a[232:233], v32 offset:8960
    ds_read_b64_tr_b16 a[234:235], v32 offset:27392
    v_add_u32 v32, 65536, v30
    ds_read_b64_tr_b16 a[240:241], v32 offset:8960
    ds_read_b64_tr_b16 a[242:243], v32 offset:27392
    v_add_u32 v32, 65536, v31
    ds_read_b64_tr_b16 a[248:249], v32 offset:8192
    ds_read_b64_tr_b16 a[250:251], v32 offset:26624
    v_add_u32 v32, 98304, v29
    ds_read_b64_tr_b16 a[188:189], v32 offset:12288
    ds_read_b64_tr_b16 a[190:191], v32 offset:30720
    v_add_u32 v32, 98304, v30
    ds_read_b64_tr_b16 a[196:197], v32 offset:12288
    ds_read_b64_tr_b16 a[198:199], v32 offset:30720
    v_add_u32 v32, 98304, v29
    ds_read_b64_tr_b16 a[204:205], v32 offset:12544
    ds_read_b64_tr_b16 a[206:207], v32 offset:30976
    v_add_u32 v32, 98304, v30
    ds_read_b64_tr_b16 a[212:213], v32 offset:12544
    ds_read_b64_tr_b16 a[214:215], v32 offset:30976
    v_add_u32 v32, 98304, v29
    ds_read_b64_tr_b16 a[220:221], v32 offset:12800
    ds_read_b64_tr_b16 a[222:223], v32 offset:31232
    v_add_u32 v32, 98304, v30
    ds_read_b64_tr_b16 a[228:229], v32 offset:12800
    ds_read_b64_tr_b16 a[230:231], v32 offset:31232
    v_add_u32 v32, 98304, v29
    ds_read_b64_tr_b16 a[236:237], v32 offset:13056
    ds_read_b64_tr_b16 a[238:239], v32 offset:31488
    v_add_u32 v32, 98304, v30
    ds_read_b64_tr_b16 a[244:245], v32 offset:13056
    ds_read_b64_tr_b16 a[246:247], v32 offset:31488
    v_add_u32 v32, 98304, v31
    ds_read_b64_tr_b16 a[252:253], v32 offset:12288
    ds_read_b64_tr_b16 a[254:255], v32 offset:30720
    s_waitcnt lgkmcnt(0)
    s_barrier
    s_load_dwordx2 s[8:9], s[0:1], 40
    s_mov_b32 s10, 4718592
    s_mov_b32 s11, 0x20000
    s_waitcnt lgkmcnt(0)
    s_add_u32 m0, s60, 73728
    s_add_u32 s28, s61, 73728
    buffer_load_dwordx4 v17, s[8:11], s28 offen lds
    s_add_u32 m0, s60, 74752
    s_add_u32 s28, s61, 73728
    buffer_load_dwordx4 v18, s[8:11], s28 offen lds
    s_add_u32 m0, s60, 75776
    s_add_u32 s28, s61, 73728
    buffer_load_dwordx4 v19, s[8:11], s28 offen lds
    s_add_u32 m0, s60, 76800
    s_add_u32 s28, s61, 73728
    buffer_load_dwordx4 v20, s[8:11], s28 offen lds
    s_add_u32 m0, s60, 77824
    s_add_u32 s28, s61, 73728
    buffer_load_dwordx4 v21, s[8:11], s28 offen lds
    s_add_u32 m0, s60, 78848
    s_add_u32 s28, s61, 73728
    buffer_load_dwordx4 v22, s[8:11], s28 offen lds
    s_add_u32 m0, s60, 79872
    s_add_u32 s28, s61, 73728
    buffer_load_dwordx4 v23, s[8:11], s28 offen lds
    s_add_u32 m0, s60, 80896
    s_add_u32 s28, s61, 73728
    buffer_load_dwordx4 v24, s[8:11], s28 offen lds
    s_add_u32 m0, s60, 81920
    s_add_u32 s28, s61, 73728
    buffer_load_dwordx4 v25, s[8:11], s28 offen lds
    s_add_u32 m0, s60, 110592
    s_add_u32 s28, s61, 110592
    buffer_load_dwordx4 v17, s[8:11], s28 offen lds
    s_add_u32 m0, s60, 111616
    s_add_u32 s28, s61, 110592
    buffer_load_dwordx4 v18, s[8:11], s28 offen lds
    s_add_u32 m0, s60, 112640
    s_add_u32 s28, s61, 110592
    buffer_load_dwordx4 v19, s[8:11], s28 offen lds
    s_add_u32 m0, s60, 113664
    s_add_u32 s28, s61, 110592
    buffer_load_dwordx4 v20, s[8:11], s28 offen lds
    s_add_u32 m0, s60, 114688
    s_add_u32 s28, s61, 110592
    buffer_load_dwordx4 v21, s[8:11], s28 offen lds
    s_add_u32 m0, s60, 115712
    s_add_u32 s28, s61, 110592
    buffer_load_dwordx4 v22, s[8:11], s28 offen lds
    s_add_u32 m0, s60, 116736
    s_add_u32 s28, s61, 110592
    buffer_load_dwordx4 v23, s[8:11], s28 offen lds
    s_add_u32 m0, s60, 117760
    s_add_u32 s28, s61, 110592
    buffer_load_dwordx4 v24, s[8:11], s28 offen lds
    s_add_u32 m0, s60, 118784
    s_add_u32 s28, s61, 110592
    buffer_load_dwordx4 v25, s[8:11], s28 offen lds
    s_add_u32 s28, s22, s20
    s_cmp_lg_u32 s28, 0
    s_cbranch_scc1 L_ch_nh1
    s_mov_b32 s23, 32768
    s_mov_b32 s29, 1
L_spin_7:
    s_sub_u32 s23, s23, 1
    s_cbranch_scc1 L_abort
    s_sleep 2
    s_sleep 4
    buffer_load_dword v43, off, s[16:19], 0 offset:16 sc1
    s_waitcnt vmcnt(0)
    v_cmp_gt_u32 vcc, 256, v43
    s_nop 3
    s_cbranch_vccnz L_spin_7
    s_mov_b32 s28, 115200
    buffer_store_dword v43, off, s[4:7], s28 sc1
L_ch_nh1:
    v_lshlrev_b32 v33, 4, v0
    s_lshl_b32 s42, s20, 11
    s_add_u32 s43, s60, 73728
    s_waitcnt vmcnt(18)
    s_barrier
    ds_read_b64_tr_b16 v[40:41], v27 offset:0
    ds_read_b64_tr_b16 v[42:43], v27 offset:512
    ds_read_b64_tr_b16 v[44:45], v28 offset:0
    ds_read_b64_tr_b16 v[46:47], v28 offset:512
    ds_read_b64_tr_b16 v[48:49], v27 offset:8192
    ds_read_b64_tr_b16 v[50:51], v27 offset:8704
    ds_read_b64_tr_b16 v[52:53], v28 offset:8192
    ds_read_b64_tr_b16 v[54:55], v28 offset:8704
    ds_read_b64_tr_b16 v[56:57], v27 offset:16384
    ds_read_b64_tr_b16 v[58:59], v27 offset:16896
    ds_read_b64_tr_b16 v[60:61], v28 offset:16384
    ds_read_b64_tr_b16 v[62:63], v28 offset:16896
    ds_read_b64_tr_b16 v[64:65], v27 offset:24576
    ds_read_b64_tr_b16 v[66:67], v27 offset:25088
    ds_read_b64_tr_b16 v[68:69], v28 offset:24576
    ds_read_b64_tr_b16 v[70:71], v28 offset:25088
    s_waitcnt lgkmcnt(0)
    s_barrier
    v_add_u32 v34, s42, v33
    v_add_u32 v34, 0, v34
    ds_write_b128 v34, v[40:43] offset:0
    ds_write_b128 v34, v[44:47] offset:1024
    ds_write_b128 v34, v[48:51] offset:8192
    ds_write_b128 v34, v[52:55] offset:9216
    ds_write_b128 v34, v[56:59] offset:16384
    ds_write_b128 v34, v[60:63] offset:17408
    ds_write_b128 v34, v[64:67] offset:24576
    ds_write_b128 v34, v[68:71] offset:25600
    ds_read_b64_tr_b16 v[40:41], v27 offset:32768
    ds_read_b64_tr_b16 v[42:43], v27 offset:33280
    ds_read_b64_tr_b16 v[44:45], v28 offset:32768
    ds_read_b64_tr_b16 v[46:47], v28 offset:33280
    ds_read_b64_tr_b16 v[48:49], v27 offset:40960
    ds_read_b64_tr_b16 v[50:51], v27 offset:41472
    ds_read_b64_tr_b16 v[52:53], v28 offset:40960
    ds_read_b64_tr_b16 v[54:55], v28 offset:41472
    ds_read_b64_tr_b16 v[56:57], v27 offset:49152
    ds_read_b64_tr_b16 v[58:59], v27 offset:49664
    ds_read_b64_tr_b16 v[60:61], v28 offset:49152
    ds_read_b64_tr_b16 v[62:63], v28 offset:49664
    ds_read_b64_tr_b16 v[64:65], v27 offset:57344
    ds_read_b64_tr_b16 v[66:67], v27 offset:57856
    ds_read_b64_tr_b16 v[68:69], v28 offset:57344
    ds_read_b64_tr_b16 v[70:71], v28 offset:57856
    s_waitcnt lgkmcnt(0)
    s_barrier
    v_add_u32 v34, s42, v33
    v_add_u32 v34, 32768, v34
    ds_write_b128 v34, v[40:43] offset:0
    ds_write_b128 v34, v[44:47] offset:1024
    ds_write_b128 v34, v[48:51] offset:8192
    ds_write_b128 v34, v[52:55] offset:9216
    ds_write_b128 v34, v[56:59] offset:16384
    ds_write_b128 v34, v[60:63] offset:17408
    ds_write_b128 v34, v[64:67] offset:24576
    ds_write_b128 v34, v[68:71] offset:25600
    v_add_u32 v32, 65536, v27
    ds_read_b64_tr_b16 v[40:41], v32 offset:0
    ds_read_b64_tr_b16 v[42:43], v32 offset:512
    v_add_u32 v32, 65536, v28
    ds_read_b64_tr_b16 v[44:45], v32 offset:0
    ds_read_b64_tr_b16 v[46:47], v32 offset:512
    s_waitcnt lgkmcnt(0)
    s_barrier
    v_add_u32 v34, s42, v33
    v_add_u32 v34, 65536, v34
    ds_write_b128 v34, v[40:43] offset:0
    ds_write_b128 v34, v[44:47] offset:1024
    s_waitcnt vmcnt(0)
    s_waitcnt lgkmcnt(0)
    s_barrier
    v_add_u32 v34, s43, v33
    v_add_u32 v32, 65536, v29
    ds_read_b64_tr_b16 v[40:41], v32 offset:8192
    ds_read_b64_tr_b16 v[42:43], v32 offset:26624
    v_add_u32 v32, 65536, v30
    ds_read_b64_tr_b16 v[44:45], v32 offset:8192
    ds_read_b64_tr_b16 v[46:47], v32 offset:26624
    v_add_u32 v32, 65536, v29
    ds_read_b64_tr_b16 v[48:49], v32 offset:8448
    ds_read_b64_tr_b16 v[50:51], v32 offset:26880
    v_add_u32 v32, 65536, v30
    ds_read_b64_tr_b16 v[52:53], v32 offset:8448
    ds_read_b64_tr_b16 v[54:55], v32 offset:26880
    v_add_u32 v32, 65536, v29
    ds_read_b64_tr_b16 v[56:57], v32 offset:8704
    ds_read_b64_tr_b16 v[58:59], v32 offset:27136
    v_add_u32 v32, 65536, v30
    ds_read_b64_tr_b16 v[60:61], v32 offset:8704
    ds_read_b64_tr_b16 v[62:63], v32 offset:27136
    v_add_u32 v32, 65536, v29
    ds_read_b64_tr_b16 v[64:65], v32 offset:8960
    ds_read_b64_tr_b16 v[66:67], v32 offset:27392
    v_add_u32 v32, 65536, v30
    ds_read_b64_tr_b16 v[68:69], v32 offset:8960
    ds_read_b64_tr_b16 v[70:71], v32 offset:27392
    v_add_u32 v32, 65536, v31
    ds_read_b64_tr_b16 v[72:73], v32 offset:8192
    ds_read_b64_tr_b16 v[74:75], v32 offset:26624
    s_waitcnt lgkmcnt(0)
    s_barrier
    ds_write_b128 v34, v[40:43] offset:0
    ds_write_b128 v34, v[44:47] offset:1024
    ds_write_b128 v34, v[48:51] offset:2048
    ds_write_b128 v34, v[52:55] offset:3072
    ds_write_b128 v34, v[56:59] offset:4096
    ds_write_b128 v34, v[60:63] offset:5120
    ds_write_b128 v34, v[64:67] offset:6144
    ds_write_b128 v34, v[68:71] offset:7168
    ds_write_b128 v34, v[72:75] offset:8192
    v_add_u32 v32, 98304, v29
    ds_read_b64_tr_b16 v[40:41], v32 offset:12288
    ds_read_b64_tr_b16 v[42:43], v32 offset:30720
    v_add_u32 v32, 98304, v30
    ds_read_b64_tr_b16 v[44:45], v32 offset:12288
    ds_read_b64_tr_b16 v[46:47], v32 offset:30720
    v_add_u32 v32, 98304, v29
    ds_read_b64_tr_b16 v[48:49], v32 offset:12544
    ds_read_b64_tr_b16 v[50:51], v32 offset:30976
    v_add_u32 v32, 98304, v30
    ds_read_b64_tr_b16 v[52:53], v32 offset:12544
    ds_read_b64_tr_b16 v[54:55], v32 offset:30976
    v_add_u32 v32, 98304, v29
    ds_read_b64_tr_b16 v[56:57], v32 offset:12800
    ds_read_b64_tr_b16 v[58:59], v32 offset:31232
    v_add_u32 v32, 98304, v30
    ds_read_b64_tr_b16 v[60:61], v32 offset:12800
    ds_read_b64_tr_b16 v[62:63], v32 offset:31232
    v_add_u32 v32, 98304, v29
    ds_read_b64_tr_b16 v[64:65], v32 offset:13056
    ds_read_b64_tr_b16 v[66:67], v32 offset:31488
    v_add_u32 v32, 98304, v30
    ds_read_b64_tr_b16 v[68:69], v32 offset:13056
    ds_read_b64_tr_b16 v[70:71], v32 offset:31488
    v_add_u32 v32, 98304, v31
    ds_read_b64_tr_b16 v[72:73], v32 offset:12288
    ds_read_b64_tr_b16 v[74:75], v32 offset:30720
    s_waitcnt lgkmcnt(0)
    s_barrier
    ds_write_b128 v34, v[40:43] offset:36864
    ds_write_b128 v34, v[44:47] offset:37888
    ds_write_b128 v34, v[48:51] offset:38912
    ds_write_b128 v34, v[52:55] offset:39936
    ds_write_b128 v34, v[56:59] offset:40960
    ds_write_b128 v34, v[60:63] offset:41984
    ds_write_b128 v34, v[64:67] offset:43008
    ds_write_b128 v34, v[68:71] offset:44032
    ds_write_b128 v34, v[72:75] offset:45056
    v_and_b32 v16, 1, v0
    v_lshlrev_b32 v16, 4, v16
    v_mov_b32 v17, 0x3f80
    v_lshlrev_b32 v17, v16, v17
    v_bfe_u32 v16, v0, 1, 2
    v_cmp_eq_u32 vcc, 0, v16
    s_nop 1
    v_cndmask_b32 v12, 0, v17, vcc
    v_cmp_eq_u32 vcc, 1, v16
    s_nop 1
    v_cndmask_b32 v13, 0, v17, vcc
    v_cmp_eq_u32 vcc, 2, v16
    s_nop 1
    v_cndmask_b32 v14, 0, v17, vcc
    v_cmp_eq_u32 vcc, 3, v16
    s_nop 1
    v_cndmask_b32 v15, 0, v17, vcc
    v_lshrrev_b32 v1, 0, v0
    v_and_b32 v1, 7, v1
    v_lshlrev_b32 v1, 4, v1
    v_lshrrev_b32 v16, 4, v0
    v_and_b32 v16, 3, v16
    v_lshl_or_b32 v1, v16, 7, v1
    v_lshrrev_b32 v16, 3, v0
    v_and_b32 v16, 1, v16
    v_lshl_or_b32 v1, v16, 18, v1
    v_lshrrev_b32 v3, 0, v0
    v_and_b32 v3, 7, v3
    v_lshlrev_b32 v3, 4, v3
    v_lshrrev_b32 v16, 4, v0
    v_and_b32 v16, 3, v16
    v_lshl_or_b32 v3, v16, 12, v3
    v_lshrrev_b32 v16, 3, v0
    v_and_b32 v16, 1, v16
    v_lshl_or_b32 v3, v16, 30, v3
    v_lshrrev_b32 v8, 0, v0
    v_and_b32 v8, 15, v8
    v_lshlrev_b32 v8, 4, v8
    v_lshrrev_b32 v16, 5, v0
    v_and_b32 v16, 1, v16
    v_lshl_or_b32 v8, v16, 8, v8
    v_lshrrev_b32 v16, 4, v0
    v_and_b32 v16, 1, v16
    v_lshl_or_b32 v8, v16, 3, v8
    v_lshrrev_b32 v11, 2, v0
    v_and_b32 v11, 3, v11
    v_lshlrev_b32 v11, 4, v11
    v_lshrrev_b32 v16, 4, v0
    v_and_b32 v16, 3, v16
    v_lshl_or_b32 v11, v16, 7, v11
    v_lshrrev_b32 v16, 0, v0
    v_and_b32 v16, 1, v16
    v_lshl_or_b32 v11, v16, 3, v11
    s_add_u32 s28, s53, 147456
    v_add_u32 v8, s28, v8
    v_add_u32 v11, s28, v11
    s_add_u32 s57, s42, 65536
    s_lshl_b32 s64, s20, 9
    v_lshrrev_b32 v9, 5, v0
    v_and_b32 v9, 1, v9
    v_lshlrev_b32 v9, 4, v9
    v_add_u32 v1, 147456, v1
    v_lshlrev_b32 v10, 2, v0
    v_add_u32 v10, 160768, v10
    v_lshlrev_b32 v0, 4, v0
    v_add_u32 v5, 147456, v0
    s_lshl_b32 s28, s21, 7
    s_add_u32 s36, s36, s28
    s_lshr_b32 s28, s20, 1
    s_add_u32 s28, s28, 16
    s_lshl_b32 s28, s28, 14
    s_add_u32 s37, s36, s28
    s_and_b32 s28, s20, 1
    s_lshl_b32 s28, s28, 3
    s_add_u32 s37, s37, s28
    s_lshl_b32 s28, s20, 14
    s_add_u32 s36, s36, s28
    s_mul_i32 s41, s20, 3072
    s_lshl_b32 s55, s31, 7
    s_mul_i32 s38, s21, 24576
    s_add_u32 s38, s38, s42
    s_mul_i32 s28, s24, 50331648
    s_add_u32 s38, s38, s28
    s_add_u32 s38, s38, 134225920
    s_lshl_b32 s44, s21, 11
    s_lshl_b32 s28, s20, 9
    s_add_u32 s44, s44, s28
    s_lshl_b32 s40, s21, 12
    s_add_u32 s40, s40, s28
    s_lshl_b32 s28, s24, 8
    s_add_u32 s44, s44, s28
    s_add_u32 s44, s44, 196608
    s_lshl_b32 s45, s21, 9
    s_add_u32 s45, s45, s28
    s_add_u32 s45, s45, 65532
    s_mul_i32 s28, s24, 8388608
    s_add_u32 s40, s40, s28
    s_add_u32 s40, s40, 33554432
    s_mov_b32 s50, 1073741824
    s_add_u32 s56, s54, 4294962176
    s_mov_b32 s30, 0
    s_mov_b32 s23, 32768
    s_mov_b32 s29, 1
L_spin_8:
    s_sub_u32 s23, s23, 1
    s_cbranch_scc1 L_abort
    s_sleep 2
    s_sleep 4
    buffer_load_dword v32, off, s[16:19], 0 offset:16 sc1
    s_waitcnt vmcnt(0)
    v_cmp_gt_u32 vcc, 256, v32
    s_nop 3
    s_cbranch_vccnz L_spin_8
    s_waitcnt lgkmcnt(0)
    s_barrier
    v_mov_b32 v6, 0
L_ch_loop:
    v_add_u32 v2, s57, v0
    ds_read_b128 v[72:75], v2 offset:0
    ds_read_b128 v[80:83], v2 offset:1024
    v_add_u32 v2, s42, v0
    ds_read_b128 v[64:67], v2 offset:0
    ds_read_b128 v[68:71], v2 offset:8192
    ds_read_b128 v[56:59], v2 offset:1024
    ds_read_b128 v[60:63], v2 offset:9216
    v_mov_b32 v32, 0
    v_mov_b32 v33, 0
    v_mov_b32 v34, 0
    v_mov_b32 v35, 0
    v_mov_b32 v36, 0
    v_mov_b32 v37, 0
    v_mov_b32 v38, 0
    v_mov_b32 v39, 0
    v_mov_b32 v40, 0
    v_mov_b32 v41, 0
    v_mov_b32 v42, 0
    v_mov_b32 v43, 0
    v_mov_b32 v44, 0
    v_mov_b32 v45, 0
    v_mov_b32 v46, 0
    v_mov_b32 v47, 0
    s_add_u32 s60, s33, s41
    v_add_u32 v7, s41, v5
    s_mov_b32 s23, 32768
    s_mov_b32 s29, 2
    s_cmp_lg_u32 s20, 3
    s_cbranch_scc1 L_ch_ag
    s_waitcnt vmcnt(0)
    s_branch L_ch_agok
L_ch_ag:
    buffer_load_dwordx4 v[48:51], v0, s[4:7], s60 offen offset:0 sc1
    buffer_load_dwordx4 v[52:55], v0, s[4:7], s60 offen offset:1024 sc1
    buffer_load_dwordx4 v[24:27], v0, s[4:7], s60 offen offset:2048 sc1
    s_sub_u32 s23, s23, 1
    s_cbranch_scc1 L_abort
    s_waitcnt vmcnt(2)
    ds_write_b128 v7, v[48:51] offset:0
    v_max_u32 v28, v48, v49
    v_max3_u32 v28, v50, v51, v28
    s_waitcnt vmcnt(1)
    ds_write_b128 v7, v[52:55] offset:1024
    v_max3_u32 v28, v52, v53, v28
    v_max3_u32 v28, v54, v55, v28
    s_waitcnt vmcnt(0)
    ds_write_b128 v7, v[24:27] offset:2048
    v_max3_u32 v28, v24, v25, v28
    v_max3_u32 v28, v26, v27, v28
    v_cmp_eq_u32 vcc, -1, v28
    s_cbranch_vccnz L_ch_ag
L_ch_agok:
    v_cmp_eq_u32 vcc, 0, v6
    v_mov_b32 v16, 0x4444
    v_mov_b32 v7, 0xeeee
    v_cndmask_b32 v7, v7, v16, s[46:47]
    s_cbranch_vccnz L_ch_kw
L_ch_kok:
    s_waitcnt lgkmcnt(0)
    s_barrier
    ds_read_b128 v[48:51], v5 offset:8192
    ds_read_b128 v[52:55], v5 offset:0
    ds_read_b128 v[24:27], v5 offset:1024
    ds_read_b128 v[28:31], v5 offset:2048
    buffer_load_dwordx4 v[16:19], v0, s[4:7], s38 offen offset:0 sc1
    buffer_load_dwordx4 v[20:23], v0, s[4:7], s38 offen offset:1024 sc1
    s_waitcnt lgkmcnt(3)
    v_smfmac_f32_16x16x64_bf16 v[32:35], v[48:51], v[72:79], v7
    s_add_u32 s60, s38, 8192
    v_smfmac_f32_16x16x64_bf16 v[36:39], v[48:51], v[80:87], v7
    s_add_u32 s44, s44, 4
    v_smfmac_f32_16x16x64_bf16 v[40:43], v[48:51], v[216:223], v7
    s_or_b32 s28, s45, s50
    s_mov_b64 exec, 1
    buffer_store_dword v1, off, s[4:7], s28 sc1
    s_mov_b64 exec, -1
    v_smfmac_f32_16x16x64_bf16 v[44:47], v[48:51], v[224:231], v7
    ds_read_b128 v[48:51], v5 offset:3072
    ds_read_b128 v[72:75], v5 offset:4096
    ds_read_b128 v[80:83], v5 offset:5120
    s_waitcnt lgkmcnt(5)
    v_smfmac_f32_16x16x64_bf16 v[32:35], v[52:55], v[64:71], v7
    ds_read_b128 v[64:67], v2 offset:16384
    ds_read_b128 v[68:71], v2 offset:24576
    v_smfmac_f32_16x16x64_bf16 v[36:39], v[52:55], v[56:63], v7
    ds_read_b128 v[56:59], v2 offset:17408
    ds_read_b128 v[60:63], v2 offset:25600
    v_smfmac_f32_16x16x64_bf16 v[40:43], v[52:55], v[88:95], v7
    s_add_u32 s38, s38, 786432
    v_smfmac_f32_16x16x64_bf16 v[44:47], v[52:55], v[96:103], v7
    ds_read_b128 v[52:55], v5 offset:6144
    s_waitcnt lgkmcnt(9)
    v_smfmac_f32_16x16x64_bf16 v[32:35], v[24:27], a[120:127], v7
    v_smfmac_f32_16x16x64_bf16 v[36:39], v[24:27], a[128:135], v7
    v_smfmac_f32_16x16x64_bf16 v[40:43], v[24:27], v[104:111], v7
    v_smfmac_f32_16x16x64_bf16 v[44:47], v[24:27], v[112:119], v7
    buffer_load_dwordx4 v[24:27], v0, s[4:7], s60 offen sc1
    s_waitcnt lgkmcnt(3)
    v_smfmac_f32_16x16x64_bf16 v[32:35], v[28:31], v[64:71], v7
    ds_read_b128 v[64:67], v2 offset:32768
    ds_read_b128 v[68:71], v2 offset:40960
    s_waitcnt lgkmcnt(3)
    v_smfmac_f32_16x16x64_bf16 v[36:39], v[28:31], v[56:63], v7
    ds_read_b128 v[56:59], v2 offset:33792
    ds_read_b128 v[60:63], v2 offset:41984
    v_smfmac_f32_16x16x64_bf16 v[40:43], v[28:31], v[120:127], v7
    v_smfmac_f32_16x16x64_bf16 v[44:47], v[28:31], v[128:135], v7
    buffer_load_dwordx4 v[28:31], v0, s[4:7], s60 offen offset:1024 sc1
    v_smfmac_f32_16x16x64_bf16 v[32:35], v[48:51], a[136:143], v7
    v_smfmac_f32_16x16x64_bf16 v[36:39], v[48:51], a[144:151], v7
    v_smfmac_f32_16x16x64_bf16 v[40:43], v[48:51], v[136:143], v7
    v_smfmac_f32_16x16x64_bf16 v[44:47], v[48:51], v[144:151], v7
    ds_read_b128 v[48:51], v5 offset:7168
    s_waitcnt lgkmcnt(3)
    v_smfmac_f32_16x16x64_bf16 v[32:35], v[72:75], v[64:71], v7
    ds_read_b128 v[64:67], v2 offset:49152
    ds_read_b128 v[68:71], v2 offset:57344
    s_waitcnt lgkmcnt(3)
    v_smfmac_f32_16x16x64_bf16 v[36:39], v[72:75], v[56:63], v7
    ds_read_b128 v[56:59], v2 offset:50176
    ds_read_b128 v[60:63], v2 offset:58368
    v_smfmac_f32_16x16x64_bf16 v[40:43], v[72:75], v[152:159], v7
    v_smfmac_f32_16x16x64_bf16 v[44:47], v[72:75], v[160:167], v7
    v_smfmac_f32_16x16x64_bf16 v[32:35], v[80:83], a[152:159], v7
    v_smfmac_f32_16x16x64_bf16 v[36:39], v[80:83], a[160:167], v7
    v_smfmac_f32_16x16x64_bf16 v[40:43], v[80:83], v[168:175], v7
    v_smfmac_f32_16x16x64_bf16 v[44:47], v[80:83], v[176:183], v7
    v_mov_b32 v72, 0
    s_waitcnt lgkmcnt(2)
    v_smfmac_f32_16x16x64_bf16 v[32:35], v[52:55], v[64:71], v7
    ds_read_b128 v[64:67], v5 offset:0
    ds_read_b128 v[68:71], v5 offset:1024
    s_waitcnt lgkmcnt(2)
    v_smfmac_f32_16x16x64_bf16 v[36:39], v[52:55], v[56:63], v7
    ds_read_b128 v[56:59], v5 offset:2048
    ds_read_b128 v[60:63], v5 offset:3072
    v_smfmac_f32_16x16x64_bf16 v[40:43], v[52:55], v[184:191], v7
    v_mov_b32 v73, 0
    v_smfmac_f32_16x16x64_bf16 v[44:47], v[52:55], v[192:199], v7
    ds_read_b128 v[52:55], v5 offset:8192
    v_smfmac_f32_16x16x64_bf16 v[32:35], v[48:51], a[168:175], v7
    v_mov_b32 v74, 0
    v_smfmac_f32_16x16x64_bf16 v[36:39], v[48:51], a[176:183], v7
    v_mov_b32 v75, 0
    v_smfmac_f32_16x16x64_bf16 v[40:43], v[48:51], v[200:207], v7
    v_mov_b32 v80, 0
    v_smfmac_f32_16x16x64_bf16 v[44:47], v[48:51], v[208:215], v7
    ds_read_b128 v[48:51], v5 offset:4096
    v_mov_b32 v81, 0
    v_mov_b32 v82, 0
    v_mov_b32 v83, 0
    s_waitcnt lgkmcnt(1)
    v_smfmac_f32_16x16x64_bf16 v[72:75], v[52:55], a[104:111], v7
    s_sub_u32 s65, s40, 147456
    v_smfmac_f32_16x16x64_bf16 v[80:83], v[52:55], a[112:119], v7
    ds_read_b128 v[52:55], v5 offset:5120
    v_smfmac_f32_16x16x64_bf16 v[72:75], v[64:67], v[232:239], v7
    v_permlane32_swap_b32 v32, v36
    v_permlane32_swap_b32 v33, v37
    v_permlane32_swap_b32 v34, v38
    v_permlane32_swap_b32 v35, v39
    v_add_f32 v32, v32, v36
    v_add_f32 v33, v33, v37
    v_add_f32 v34, v34, v38
    v_add_f32 v35, v35, v39
    v_cvt_pk_bf16_f32 v32, v32, v33
    v_cvt_pk_bf16_f32 v33, v34, v35
    ds_write_b64 v8, v[32:33] offset:9216
    v_permlane32_swap_b32 v40, v44
    v_permlane32_swap_b32 v41, v45
    v_permlane32_swap_b32 v42, v46
    v_permlane32_swap_b32 v43, v47
    v_add_f32 v40, v40, v44
    v_add_f32 v41, v41, v45
    v_add_f32 v42, v42, v46
    v_add_f32 v43, v43, v47
    v_cvt_pk_bf16_f32 v40, v40, v41
    v_cvt_pk_bf16_f32 v41, v42, v43
    ds_write_b64 v8, v[40:41] offset:9728
    ds_read_b64_tr_b16 v[32:33], v11 offset:9216
    ds_read_b64_tr_b16 v[34:35], v11 offset:9280
    ds_read_b64_tr_b16 v[40:41], v11 offset:9728
    ds_read_b64_tr_b16 v[42:43], v11 offset:9792
    v_add_u32 v2, s54, v10
    v_smfmac_f32_16x16x64_bf16 v[80:83], v[64:67], v[240:247], v7
    ds_read_b128 v[64:67], v5 offset:6144
    v_smfmac_f32_16x16x64_bf16 v[72:75], v[68:71], v[248:255], v7
    v_smfmac_f32_16x16x64_bf16 v[80:83], v[68:71], a[0:7], v7
    ds_read_b128 v[68:71], v5 offset:7168
    v_smfmac_f32_16x16x64_bf16 v[72:75], v[56:59], a[8:15], v7
    s_waitcnt vmcnt(4) lgkmcnt(4)
    v_mfma_f32_16x16x32_bf16 v[16:19], v[16:19], v[32:35], 0
    s_waitcnt vmcnt(3)
    v_mfma_f32_16x16x32_bf16 v[20:23], v[20:23], v[32:35], 0
    s_waitcnt lgkmcnt(2)
    v_mfma_f32_16x16x32_bf16 v[44:47], v[40:43], v[32:35], 0
    s_mov_b64 exec, s[46:47]
    buffer_store_dwordx4 v[40:43], v1, s[4:7], s65 offen sc1
    s_mov_b64 exec, -1
    v_add_u32 v36, s53, v5
    v_smfmac_f32_16x16x64_bf16 v[80:83], v[56:59], a[16:23], v7
    v_smfmac_f32_16x16x64_bf16 v[72:75], v[60:63], a[24:31], v7
    v_cndmask_b32 v16, v20, v16, s[46:47]
    v_cndmask_b32 v17, v21, v17, s[46:47]
    v_cndmask_b32 v18, v22, v18, s[46:47]
    v_cndmask_b32 v19, v23, v19, s[46:47]
    ds_write_b128 v36, v[16:19] offset:9216
    v_cndmask_b32 v44, v44, v45, s[48:49]
    v_cndmask_b32 v46, v46, v47, s[48:49]
    v_cndmask_b32 v44, v46, v44, s[46:47]
    ds_write_b32 v2, v44
    v_smfmac_f32_16x16x64_bf16 v[80:83], v[60:63], a[32:39], v7
    v_smfmac_f32_16x16x64_bf16 v[72:75], v[48:51], a[40:47], v7
    v_smfmac_f32_16x16x64_bf16 v[80:83], v[48:51], a[48:55], v7
    s_waitcnt lgkmcnt(0)
    s_barrier
    ds_read_b128 v[32:35], v5 offset:9216
    ds_read_b128 v[36:39], v5 offset:10240
    ds_read_b128 v[40:43], v5 offset:11264
    ds_read_b128 v[44:47], v5 offset:12288
    ds_read2st64_b32 v[20:21], v10 offset0:0 offset1:1
    ds_read2st64_b32 v[22:23], v10 offset0:2 offset1:3
    v_smfmac_f32_16x16x64_bf16 v[72:75], v[52:55], a[56:63], v7
    v_smfmac_f32_16x16x64_bf16 v[80:83], v[52:55], a[64:71], v7
    v_smfmac_f32_16x16x64_bf16 v[72:75], v[64:67], a[72:79], v7
    v_smfmac_f32_16x16x64_bf16 v[80:83], v[64:67], a[80:87], v7
    v_smfmac_f32_16x16x64_bf16 v[72:75], v[68:71], a[88:95], v7
    v_smfmac_f32_16x16x64_bf16 v[80:83], v[68:71], a[96:103], v7
    v_add_u32 v2, s43, v0
    s_waitcnt lgkmcnt(4)
    v_pk_add_f32 v[32:33], v[32:33], v[36:37]
    s_waitcnt lgkmcnt(2)
    v_pk_add_f32 v[40:41], v[40:41], v[44:45]
    v_pk_add_f32 v[34:35], v[34:35], v[38:39]
    v_pk_add_f32 v[42:43], v[42:43], v[46:47]
    s_waitcnt lgkmcnt(0)
    v_pk_add_f32 v[20:21], v[20:21], v[22:23]
    v_pk_add_f32 v[36:37], v[32:33], v[40:41]
    v_pk_add_f32 v[38:39], v[34:35], v[42:43]
    v_add_f32 v20, v20, v21
    v_max3_f32 v21, v36, v37, v38
    v_max3_f32 v21, v39, v20, v21
    v_permlane32_swap_b32 v72, v80
    v_permlane32_swap_b32 v73, v81
    v_max_f32_dpp v21, v21, v21 row_ror:8 row_mask:0xf bank_mask:0xf
    v_mov_b32 v22, v21
    v_permlane32_swap_b32 v74, v82
    v_permlane32_swap_b32 v75, v83
    v_permlane16_swap_b32 v21, v22
    v_max_f32 v21, v21, v22
    v_mov_b32 v22, v21
    v_pk_add_f32 v[72:73], v[72:73], v[80:81]
    v_pk_add_f32 v[74:75], v[74:75], v[82:83]
    v_permlane32_swap_b32 v21, v22
    v_max_f32 v21, v21, v22
    v_mul_f32 v21, s39, v21
    v_fma_f32 v36, v36, s39, -v21
    v_fma_f32 v37, v37, s39, -v21
    v_fma_f32 v38, v38, s39, -v21
    v_fma_f32 v39, v39, s39, -v21
    v_fma_f32 v20, v20, s39, -v21
    v_exp_f32 v36, v36
    v_exp_f32 v37, v37
    v_exp_f32 v38, v38
    v_exp_f32 v39, v39
    v_exp_f32 v20, v20
    v_cvt_pk_bf16_f32 v80, v72, v73
    v_cvt_pk_bf16_f32 v81, v74, v75
    v_cvt_pk_bf16_f32 v32, v36, v37
    v_cvt_pk_bf16_f32 v33, v38, v39
    v_cvt_pk_bf16_f32 v66, v20, 0
    v_mov_b32_dpp v34, v32 row_ror:8 row_mask:0xf bank_mask:0xf
    v_mov_b32_dpp v35, v33 row_ror:8 row_mask:0xf bank_mask:0xf
    v_lshlrev_b32 v66, v9, v66
    v_mov_b32 v82, v80
    s_waitcnt vmcnt(2)
    v_mfma_f32_16x16x32_bf16 v[40:43], v[24:27], v[32:35], 0
    v_mov_b32 v83, v81
    v_mov_b32_dpp v67, v66 row_ror:8 row_mask:0xf bank_mask:0xf
    s_waitcnt vmcnt(1)
    v_mfma_f32_16x16x32_bf16 v[44:47], v[28:31], v[32:35], 0
    v_permlane32_swap_b32 v80, v82
    v_permlane32_swap_b32 v81, v83
    v_mov_b32 v68, 0x3f803f80
    v_mov_b32 v69, 0x3f803f80
    v_mov_b32 v70, 0x3f803f80
    v_mov_b32 v71, 0x3f803f80
    v_mfma_f32_16x16x16_bf16 v[40:43], v[80:81], v[66:67], v[40:43]
    s_nop 0
    v_mfma_f32_16x16x32_bf16 v[60:63], v[68:71], v[32:35], 0
    ds_read_b128 v[48:51], v2 offset:0
    v_mfma_f32_16x16x16_bf16 v[44:47], v[82:83], v[66:67], v[44:47]
    ds_read_b128 v[52:55], v2 offset:1024
    v_mfma_f32_16x16x16_bf16 v[60:63], v[68:69], v[66:67], v[60:63]
    buffer_load_dword v6, off, s[4:7], s44 sc1
    s_not_b64 exec, s[48:49]
    buffer_store_dwordx4 v[80:83], v0, s[4:7], s40 offen offset:2048 sc1
    s_mov_b64 exec, s[46:47]
    v_add_u32 v7, s64, v1
    s_nop 2
    v_rcp_f32 v60, v60
    s_cmp_eq_u32 s30, 63
    v_pk_mul_f32 v[40:41], v[40:41], v[60:61] op_sel_hi:[1,0]
    v_pk_mul_f32 v[42:43], v[42:43], v[60:61] op_sel_hi:[1,0]
    v_pk_mul_f32 v[44:45], v[44:45], v[60:61] op_sel_hi:[1,0]
    v_pk_mul_f32 v[46:47], v[46:47], v[60:61] op_sel_hi:[1,0]
    v_cvt_pk_bf16_f32 v32, v40, v41
    v_cvt_pk_bf16_f32 v33, v42, v43
    v_cvt_pk_bf16_f32 v34, v44, v45
    v_cvt_pk_bf16_f32 v35, v46, v47
    ds_write_b128 v7, v[32:35] offset:14336
    s_mov_b64 exec, -1
    s_cbranch_scc1 L_ch_end
    s_waitcnt lgkmcnt(0)
    s_barrier
    ds_read_b128 v[40:43], v1 offset:15360
    ds_read_b128 v[32:35], v1 offset:14336
    ds_read_b128 v[44:47], v1 offset:15872
    ds_read_b128 v[36:39], v1 offset:14848
    ds_read_b128 v[56:59], v2 offset:36864
    ds_read_b128 v[24:27], v2 offset:37888
    ds_read_b128 v[28:31], v2 offset:2048
    s_waitcnt lgkmcnt(6)
    v_mfma_f32_16x16x32_bf16 v[64:67], v[48:51], v[40:43], 0
    ds_read_b128 v[48:51], v2 offset:3072
    s_mov_b32 s60, s36
    s_add_u32 s40, s40, 131072
    v_mfma_f32_16x16x32_bf16 v[68:71], v[52:55], v[40:43], 0
    ds_read_b128 v[52:55], v2 offset:38912
    s_add_u32 s63, s55, s33
    s_add_u32 s62, s55, s34
    s_waitcnt lgkmcnt(7)
    v_mfma_f32_16x16x32_bf16 v[64:67], a[184:187], v[32:35], v[64:67]
    s_cmp_eq_u32 s20, 3
    s_cselect_b32 s50, 0, 1073741824
    s_add_u32 s45, s45, 4
    v_mfma_f32_16x16x32_bf16 v[68:71], a[192:195], v[32:35], v[68:71]
    s_waitcnt lgkmcnt(4)
    v_mfma_f32_16x16x32_bf16 v[64:67], v[56:59], v[44:47], v[64:67]
    ds_read_b128 v[56:59], v2 offset:39936
    s_waitcnt lgkmcnt(4)
    v_mfma_f32_16x16x32_bf16 v[68:71], v[24:27], v[44:47], v[68:71]
    ds_read_b128 v[24:27], v2 offset:4096
    v_mfma_f32_16x16x32_bf16 v[64:67], a[188:191], v[36:39], v[64:67]
    v_mfma_f32_16x16x32_bf16 v[68:71], a[196:199], v[36:39], v[68:71]
    s_waitcnt lgkmcnt(4)
    v_mfma_f32_16x16x32_bf16 v[72:75], v[28:31], v[40:43], 0
    ds_read_b128 v[28:31], v2 offset:5120
    s_waitcnt lgkmcnt(4)
    v_mfma_f32_16x16x32_bf16 v[80:83], v[48:51], v[40:43], 0
    ds_read_b128 v[48:51], v2 offset:40960
    v_mfma_f32_16x16x32_bf16 v[72:75], a[200:203], v[32:35], v[72:75]
    v_cvt_pk_bf16_f32 v64, v64, v65
    v_bfi_b32 v64, 1, s30, v64
    v_cvt_pk_bf16_f32 v65, v66, v67
    v_mfma_f32_16x16x32_bf16 v[80:83], a[208:211], v[32:35], v[80:83]
    v_cvt_pk_bf16_f32 v66, v68, v69
    v_cvt_pk_bf16_f32 v67, v70, v71
    v_bfi_b32 v66, 1, s30, v66
    s_waitcnt lgkmcnt(4)
    v_mfma_f32_16x16x32_bf16 v[72:75], v[52:55], v[44:47], v[72:75]
    ds_read_b128 v[52:55], v2 offset:41984
    buffer_store_dwordx4 v[64:67], v3, s[4:7], s60 offen
    s_waitcnt lgkmcnt(4)
    v_mfma_f32_16x16x32_bf16 v[80:83], v[56:59], v[44:47], v[80:83]
    ds_read_b128 v[56:59], v2 offset:6144
    s_add_u32 s60, s60, 65536
    v_mfma_f32_16x16x32_bf16 v[72:75], a[204:207], v[36:39], v[72:75]
    v_mfma_f32_16x16x32_bf16 v[80:83], a[212:215], v[36:39], v[80:83]
    s_waitcnt lgkmcnt(4)
    v_mfma_f32_16x16x32_bf16 v[64:67], v[24:27], v[40:43], 0
    ds_read_b128 v[24:27], v2 offset:7168
    s_waitcnt lgkmcnt(4)
    v_mfma_f32_16x16x32_bf16 v[68:71], v[28:31], v[40:43], 0
    ds_read_b128 v[28:31], v2 offset:8192
    v_mfma_f32_16x16x32_bf16 v[64:67], a[216:219], v[32:35], v[64:67]
    v_cvt_pk_bf16_f32 v72, v72, v73
    v_bfi_b32 v72, 1, s30, v72
    v_cvt_pk_bf16_f32 v73, v74, v75
    v_mfma_f32_16x16x32_bf16 v[68:71], a[224:227], v[32:35], v[68:71]
    v_cvt_pk_bf16_f32 v74, v80, v81
    v_cvt_pk_bf16_f32 v75, v82, v83
    v_bfi_b32 v74, 1, s30, v74
    s_waitcnt lgkmcnt(4)
    v_mfma_f32_16x16x32_bf16 v[64:67], v[48:51], v[44:47], v[64:67]
    ds_read_b128 v[48:51], v2 offset:43008
    buffer_store_dwordx4 v[72:75], v3, s[4:7], s60 offen
    s_waitcnt lgkmcnt(4)
    v_mfma_f32_16x16x32_bf16 v[68:71], v[52:55], v[44:47], v[68:71]
    ds_read_b128 v[52:55], v2 offset:44032
    s_add_u32 s60, s60, 65536
    v_mfma_f32_16x16x32_bf16 v[64:67], a[220:223], v[36:39], v[64:67]
    v_mfma_f32_16x16x32_bf16 v[68:71], a[228:231], v[36:39], v[68:71]
    s_waitcnt lgkmcnt(4)
    v_mfma_f32_16x16x32_bf16 v[72:75], v[56:59], v[40:43], 0
    ds_read_b128 v[56:59], v2 offset:45056
    s_waitcnt lgkmcnt(4)
    v_mfma_f32_16x16x32_bf16 v[80:83], v[24:27], v[40:43], 0
    s_waitcnt lgkmcnt(3)
    v_mfma_f32_16x16x32_bf16 v[60:63], v[28:31], v[40:43], 0
    v_cvt_pk_bf16_f32 v64, v64, v65
    v_bfi_b32 v64, 1, s30, v64
    v_cvt_pk_bf16_f32 v65, v66, v67
    v_mfma_f32_16x16x32_bf16 v[72:75], a[232:235], v[32:35], v[72:75]
    v_cvt_pk_bf16_f32 v66, v68, v69
    v_cvt_pk_bf16_f32 v67, v70, v71
    v_bfi_b32 v66, 1, s30, v66
    v_mfma_f32_16x16x32_bf16 v[80:83], a[240:243], v[32:35], v[80:83]
    buffer_store_dwordx4 v[64:67], v3, s[4:7], s60 offen
    v_mfma_f32_16x16x32_bf16 v[60:63], a[248:251], v[32:35], v[60:63]
    s_add_u32 s60, s60, 65536
    s_waitcnt lgkmcnt(2)
    v_mfma_f32_16x16x32_bf16 v[72:75], v[48:51], v[44:47], v[72:75]
    s_waitcnt lgkmcnt(1)
    v_mfma_f32_16x16x32_bf16 v[80:83], v[52:55], v[44:47], v[80:83]
    s_waitcnt lgkmcnt(0)
    v_mfma_f32_16x16x32_bf16 v[60:63], v[56:59], v[44:47], v[60:63]
    v_mfma_f32_16x16x32_bf16 v[72:75], a[236:239], v[36:39], v[72:75]
    v_mfma_f32_16x16x32_bf16 v[80:83], a[244:247], v[36:39], v[80:83]
    v_mfma_f32_16x16x32_bf16 v[60:63], a[252:255], v[36:39], v[60:63]
    s_cmp_ge_u32 s31, 72
    s_mov_b32 s23, 32768
    s_mov_b32 s29, 4
    s_nop 2
    v_cvt_pk_bf16_f32 v72, v72, v73
    v_bfi_b32 v72, 1, s30, v72
    v_cvt_pk_bf16_f32 v73, v74, v75
    v_cvt_pk_bf16_f32 v74, v80, v81
    v_cvt_pk_bf16_f32 v75, v82, v83
    v_bfi_b32 v74, 1, s30, v74
    buffer_store_dwordx4 v[72:75], v3, s[4:7], s60 offen
    v_cvt_pk_bf16_f32 v60, v60, v61
    v_cvt_pk_bf16_f32 v61, v62, v63
    v_bfi_b32 v60, 1, s30, v60
    buffer_store_dwordx2 v[60:61], v3, s[4:7], s37 offen
    s_cbranch_scc1 L_ch_next
    s_cmp_eq_u32 s20, 0
    s_cbranch_scc1 L_ch_rs
    s_waitcnt vmcnt(0)
L_ch_rs:
    buffer_load_dwordx4 v[32:35], v0, s[4:7], s32 offen offset:0 sc1
    buffer_load_dwordx4 v[36:39], v0, s[4:7], s32 offen offset:1024 sc1
    buffer_load_dwordx4 v[40:43], v0, s[4:7], s32 offen offset:2048 sc1
    buffer_load_dwordx4 v[44:47], v0, s[4:7], s32 offen offset:3072 sc1
    s_sub_u32 s23, s23, 1
    s_cbranch_scc1 L_abort
    v_mov_b32 v50, -1
    v_mov_b32 v51, -1
    s_waitcnt vmcnt(3)
    v_mfma_f32_16x16x32_bf16 v[52:55], v[12:15], v[32:35], 0
    v_bitop3_b32 v56, v32, v34, s30 bitop3:0x7e
    s_waitcnt vmcnt(2)
    v_mfma_f32_16x16x32_bf16 v[52:55], v[12:15], v[36:39], v[52:55]
    v_bitop3_b32 v57, v36, v38, s30 bitop3:0x7e
    s_waitcnt vmcnt(1)
    v_mfma_f32_16x16x32_bf16 v[52:55], v[12:15], v[40:43], v[52:55]
    v_bitop3_b32 v58, v40, v42, s30 bitop3:0x7e
    s_waitcnt vmcnt(0)
    v_mfma_f32_16x16x32_bf16 v[52:55], v[12:15], v[44:47], v[52:55]
    v_bitop3_b32 v59, v44, v46, s30 bitop3:0x7e
    v_or3_b32 v56, v56, v57, v58
    v_bitop3_b32 v56, v56, v59, 1 bitop3:0xa8
    v_cmp_ne_u32 vcc, 0, v56
    s_cbranch_vccnz L_ch_rs
    s_nop 2
    v_add_f32_dpp v52, v52, v52 row_ror:8 row_mask:0xf bank_mask:0xf
    v_add_f32_dpp v53, v53, v53 row_ror:8 row_mask:0xf bank_mask:0xf
    v_add_f32_dpp v54, v54, v54 row_ror:8 row_mask:0xf bank_mask:0xf
    v_add_f32_dpp v55, v55, v55 row_ror:8 row_mask:0xf bank_mask:0xf
    v_cvt_pk_bf16_f32 v48, v52, v53
    v_cvt_pk_bf16_f32 v49, v54, v55
    v_min_u32 v48, -2, v48
    v_min_u32 v49, -2, v49
    buffer_store_dwordx2 v[48:49], v4, s[4:7], s62 offen
    buffer_store_dwordx2 v[50:51], v4, s[4:7], s63 offen
L_ch_next:
    s_mov_b32 s60, s33
    s_mov_b32 s33, s34
    s_mov_b32 s34, s35
    s_mov_b32 s35, s60
    s_add_u32 s30, s30, 1
    s_branch L_ch_loop
L_ch_end:
    s_waitcnt vmcnt(0) lgkmcnt(0)
    s_barrier
    s_cmp_lg_u32 s20, 3
    s_cbranch_scc1 L_exit
    s_mov_b64 exec, 1
    buffer_store_dword v1, off, s[4:7], s45 offset:4 sc1
    s_endpgm
L_ch_kw:
    s_cmp_eq_u32 s30, 63
    s_cbranch_scc1 L_ch_kok
    s_mov_b32 s23, 32768
    s_mov_b32 s29, 3
L_ch_kw2:
    s_sub_u32 s23, s23, 1
    s_cbranch_scc1 L_abort
    s_sleep 2
    buffer_load_dword v6, off, s[4:7], s44 sc1
    s_waitcnt vmcnt(0)
    v_cmp_eq_u32 vcc, 0, v6
    s_cbranch_vccnz L_ch_kw2
    s_branch L_ch_kok
L_proj:
    s_waitcnt vmcnt(0)
    s_barrier
    s_cmp_lg_u32 s20, 0
    s_cbranch_scc1 L_arr_9
    s_mov_b64 exec, 1
    v_mov_b32 v2, 1
    buffer_atomic_add v2, off, s[16:19], 0 offset:16 sc1
    s_mov_b64 exec, -1
L_arr_9:
    s_cmp_eq_u32 s24, 0
    s_cbranch_scc1 L_hold_10
    s_mov_b32 s23, 32768
    s_mov_b32 s29, 1
L_spin_11:
    s_sub_u32 s23, s23, 1
    s_cbranch_scc1 L_abort
    s_sleep 2
    s_sleep 4
    buffer_load_dword v2, off, s[16:19], 0 offset:16 sc1
    s_waitcnt vmcnt(0)
    v_cmp_gt_u32 vcc, 256, v2
    s_nop 3
    s_cbranch_vccnz L_spin_11
    s_lshl_b32 s60, s24, 9
    s_add_u32 s60, s60, 114688
    s_mov_b32 s23, 32768
    s_mov_b32 s29, 30
L_spin_12:
    s_sub_u32 s23, s23, 1
    s_cbranch_scc1 L_abort
    s_sleep 2
    s_sleep 16
    buffer_load_dword v2, off, s[4:7], s60 sc1
    s_waitcnt vmcnt(0)
    v_cmp_eq_u32 vcc, 0, v2
    s_nop 3
    s_cbranch_vccnz L_spin_12
L_hold_10:
    s_lshl_b32 s35, s20, 10
    s_mul_i32 s36, s20, 9216
    s_lshl_b32 s61, s21, 8
    v_lshrrev_b32 v30, 4, v0
    s_mul_i32 s28, s20, 4
    v_add_u32 v30, s28, v30
    v_lshrrev_b32 v20, 0, v30
    v_and_b32 v20, 3, v20
    v_lshlrev_b32 v20, 1, v20
    v_lshrrev_b32 v31, 3, v30
    v_and_b32 v31, 1, v31
    v_lshl_or_b32 v20, v31, 3, v20
    v_and_b32 v31, 15, v0
    v_xor_b32 v20, v20, v31
    v_lshlrev_b32 v20, 4, v20
    v_mul_u32_u24 v30, 8192, v30
    v_add_u32 v20, v20, v30
    s_lshl_b32 s62, s20, 2
    v_lshrrev_b32 v30, 2, v0
    v_and_b32 v30, 3, v30
    v_lshrrev_b32 v31, 4, v0
    v_and_b32 v31, 3, v31
    v_lshl_or_b32 v30, v31, 3, v30
    v_lshrrev_b32 v23, 0, v30
    v_and_b32 v23, 3, v23
    v_lshlrev_b32 v23, 1, v23
    v_lshrrev_b32 v31, 3, v30
    v_and_b32 v31, 1, v31
    v_lshl_or_b32 v23, v31, 3, v23
    v_and_b32 v31, 3, v0
    v_add_u32 v31, s62, v31
    v_xor_b32 v23, v23, v31
    v_lshlrev_b32 v23, 4, v23
    v_mul_u32_u24 v30, 256, v30
    v_add_u32 v23, v23, v30
    v_lshrrev_b32 v30, 2, v0
    v_and_b32 v30, 3, v30
    v_lshrrev_b32 v31, 4, v0
    v_and_b32 v31, 3, v31
    v_lshl_or_b32 v30, v31, 3, v30
    v_lshrrev_b32 v21, 0, v30
    v_and_b32 v21, 3, v21
    v_lshlrev_b32 v21, 1, v21
    v_lshrrev_b32 v31, 3, v30
    v_and_b32 v31, 1, v31
    v_lshl_or_b32 v21, v31, 3, v21
    v_bfe_u32 v31, v0, 1, 1
    v_add_u32 v31, s62, v31
    v_xor_b32 v21, v21, v31
    v_lshlrev_b32 v21, 4, v21
    v_mul_u32_u24 v30, 256, v30
    v_add_u32 v21, v21, v30
    v_and_b32 v31, 1, v0
    v_lshlrev_b32 v31, 3, v31
    v_add_u32 v21, v21, v31
    v_lshrrev_b32 v30, 2, v0
    v_and_b32 v30, 3, v30
    v_lshrrev_b32 v31, 4, v0
    v_and_b32 v31, 3, v31
    v_lshl_or_b32 v30, v31, 3, v30
    v_lshrrev_b32 v22, 0, v30
    v_and_b32 v22, 3, v22
    v_lshlrev_b32 v22, 1, v22
    v_lshrrev_b32 v31, 3, v30
    v_and_b32 v31, 1, v31
    v_lshl_or_b32 v22, v31, 3, v22
    v_bfe_u32 v31, v0, 1, 1
    v_add_u32 v31, s62, v31
    v_add_u32 v31, 2, v31
    v_xor_b32 v22, v22, v31
    v_lshlrev_b32 v22, 4, v22
    v_mul_u32_u24 v30, 256, v30
    v_add_u32 v22, v22, v30
    v_and_b32 v31, 1, v0
    v_lshlrev_b32 v31, 3, v31
    v_add_u32 v22, v22, v31
    s_load_dwordx2 s[8:9], s[0:1], 24
    s_mov_b32 s10, 4718592
    s_mov_b32 s11, 0x20000
    s_waitcnt lgkmcnt(0)
    s_add_u32 m0, s35, 0
    s_add_u32 s28, s61, 0
    buffer_load_dwordx4 v20, s[8:11], s28 offen lds
    s_add_u32 m0, s35, 4096
    s_add_u32 s28, s61, 131072
    buffer_load_dwordx4 v20, s[8:11], s28 offen lds
    s_add_u32 m0, s35, 8192
    s_add_u32 s28, s61, 262144
    buffer_load_dwordx4 v20, s[8:11], s28 offen lds
    s_add_u32 m0, s35, 12288
    s_add_u32 s28, s61, 393216
    buffer_load_dwordx4 v20, s[8:11], s28 offen lds
    s_add_u32 m0, s35, 16384
    s_add_u32 s28, s61, 524288
    buffer_load_dwordx4 v20, s[8:11], s28 offen lds
    s_add_u32 m0, s35, 20480
    s_add_u32 s28, s61, 655360
    buffer_load_dwordx4 v20, s[8:11], s28 offen lds
    s_add_u32 m0, s35, 24576
    s_add_u32 s28, s61, 786432
    buffer_load_dwordx4 v20, s[8:11], s28 offen lds
    s_add_u32 m0, s35, 28672
    s_add_u32 s28, s61, 917504
    buffer_load_dwordx4 v20, s[8:11], s28 offen lds
    s_add_u32 m0, s35, 32768
    s_add_u32 s28, s61, 1048576
    buffer_load_dwordx4 v20, s[8:11], s28 offen lds
    s_add_u32 m0, s35, 36864
    s_add_u32 s28, s61, 1179648
    buffer_load_dwordx4 v20, s[8:11], s28 offen lds
    s_add_u32 m0, s35, 40960
    s_add_u32 s28, s61, 1310720
    buffer_load_dwordx4 v20, s[8:11], s28 offen lds
    s_add_u32 m0, s35, 45056
    s_add_u32 s28, s61, 1441792
    buffer_load_dwordx4 v20, s[8:11], s28 offen lds
    s_add_u32 m0, s35, 49152
    s_add_u32 s28, s61, 1572864
    buffer_load_dwordx4 v20, s[8:11], s28 offen lds
    s_add_u32 m0, s35, 53248
    s_add_u32 s28, s61, 1703936
    buffer_load_dwordx4 v20, s[8:11], s28 offen lds
    s_add_u32 m0, s35, 57344
    s_add_u32 s28, s61, 1835008
    buffer_load_dwordx4 v20, s[8:11], s28 offen lds
    s_add_u32 m0, s35, 61440
    s_add_u32 s28, s61, 1966080
    buffer_load_dwordx4 v20, s[8:11], s28 offen lds
    s_add_u32 m0, s35, 65536
    s_add_u32 s28, s61, 2097152
    buffer_load_dwordx4 v20, s[8:11], s28 offen lds
    s_add_u32 m0, s35, 69632
    s_add_u32 s28, s61, 2228224
    buffer_load_dwordx4 v20, s[8:11], s28 offen lds
    s_load_dwordx2 s[8:9], s[0:1], 24
    s_mov_b32 s10, 4718592
    s_mov_b32 s11, 0x20000
    s_waitcnt lgkmcnt(0)
    s_add_u32 m0, s35, 73728
    s_add_u32 s28, s61, 2359296
    buffer_load_dwordx4 v20, s[8:11], s28 offen lds
    s_add_u32 m0, s35, 77824
    s_add_u32 s28, s61, 2490368
    buffer_load_dwordx4 v20, s[8:11], s28 offen lds
    s_add_u32 m0, s35, 81920
    s_add_u32 s28, s61, 2621440
    buffer_load_dwordx4 v20, s[8:11], s28 offen lds
    s_add_u32 m0, s35, 86016
    s_add_u32 s28, s61, 2752512
    buffer_load_dwordx4 v20, s[8:11], s28 offen lds
    s_add_u32 m0, s35, 90112
    s_add_u32 s28, s61, 2883584
    buffer_load_dwordx4 v20, s[8:11], s28 offen lds
    s_add_u32 m0, s35, 94208
    s_add_u32 s28, s61, 3014656
    buffer_load_dwordx4 v20, s[8:11], s28 offen lds
    s_add_u32 m0, s35, 98304
    s_add_u32 s28, s61, 3145728
    buffer_load_dwordx4 v20, s[8:11], s28 offen lds
    s_add_u32 m0, s35, 102400
    s_add_u32 s28, s61, 3276800
    buffer_load_dwordx4 v20, s[8:11], s28 offen lds
    s_add_u32 m0, s35, 106496
    s_add_u32 s28, s61, 3407872
    buffer_load_dwordx4 v20, s[8:11], s28 offen lds
    s_add_u32 m0, s35, 110592
    s_add_u32 s28, s61, 3538944
    buffer_load_dwordx4 v20, s[8:11], s28 offen lds
    s_add_u32 m0, s35, 114688
    s_add_u32 s28, s61, 3670016
    buffer_load_dwordx4 v20, s[8:11], s28 offen lds
    s_add_u32 m0, s35, 118784
    s_add_u32 s28, s61, 3801088
    buffer_load_dwordx4 v20, s[8:11], s28 offen lds
    s_add_u32 m0, s35, 122880
    s_add_u32 s28, s61, 3932160
    buffer_load_dwordx4 v20, s[8:11], s28 offen lds
    s_add_u32 m0, s35, 126976
    s_add_u32 s28, s61, 4063232
    buffer_load_dwordx4 v20, s[8:11], s28 offen lds
    s_add_u32 m0, s35, 131072
    s_add_u32 s28, s61, 4194304
    buffer_load_dwordx4 v20, s[8:11], s28 offen lds
    s_add_u32 m0, s35, 135168
    s_add_u32 s28, s61, 4325376
    buffer_load_dwordx4 v20, s[8:11], s28 offen lds
    s_add_u32 m0, s35, 139264
    s_add_u32 s28, s61, 4456448
    buffer_load_dwordx4 v20, s[8:11], s28 offen lds
    s_add_u32 m0, s35, 143360
    s_add_u32 s28, s61, 4587520
    buffer_load_dwordx4 v20, s[8:11], s28 offen lds
    s_waitcnt vmcnt(18)
    s_barrier
    ds_read_b64_tr_b16 v[80:81], v23 offset:0
    ds_read_b64_tr_b16 v[82:83], v23 offset:1024
    ds_read_b64_tr_b16 v[84:85], v23 offset:8
    ds_read_b64_tr_b16 v[86:87], v23 offset:1032
    ds_read_b64_tr_b16 v[88:89], v23 offset:8192
    ds_read_b64_tr_b16 v[90:91], v23 offset:9216
    ds_read_b64_tr_b16 v[92:93], v23 offset:8200
    ds_read_b64_tr_b16 v[94:95], v23 offset:9224
    ds_read_b64_tr_b16 v[96:97], v23 offset:16384
    ds_read_b64_tr_b16 v[98:99], v23 offset:17408
    ds_read_b64_tr_b16 v[100:101], v23 offset:16392
    ds_read_b64_tr_b16 v[102:103], v23 offset:17416
    ds_read_b64_tr_b16 v[104:105], v23 offset:24576
    ds_read_b64_tr_b16 v[106:107], v23 offset:25600
    ds_read_b64_tr_b16 v[108:109], v23 offset:24584
    ds_read_b64_tr_b16 v[110:111], v23 offset:25608
    ds_read_b64_tr_b16 v[112:113], v23 offset:32768
    ds_read_b64_tr_b16 v[114:115], v23 offset:33792
    ds_read_b64_tr_b16 v[116:117], v23 offset:32776
    ds_read_b64_tr_b16 v[118:119], v23 offset:33800
    ds_read_b64_tr_b16 v[120:121], v23 offset:40960
    ds_read_b64_tr_b16 v[122:123], v23 offset:41984
    ds_read_b64_tr_b16 v[124:125], v23 offset:40968
    ds_read_b64_tr_b16 v[126:127], v23 offset:41992
    ds_read_b64_tr_b16 v[128:129], v23 offset:49152
    ds_read_b64_tr_b16 v[130:131], v23 offset:50176
    ds_read_b64_tr_b16 v[132:133], v23 offset:49160
    ds_read_b64_tr_b16 v[134:135], v23 offset:50184
    ds_read_b64_tr_b16 v[136:137], v23 offset:57344
    ds_read_b64_tr_b16 v[138:139], v23 offset:58368
    ds_read_b64_tr_b16 v[140:141], v23 offset:57352
    ds_read_b64_tr_b16 v[142:143], v23 offset:58376
    v_add_u32 v24, 65536, v23
    ds_read_b64_tr_b16 v[144:145], v24 offset:0
    ds_read_b64_tr_b16 v[146:147], v24 offset:1024
    ds_read_b64_tr_b16 v[148:149], v24 offset:8
    ds_read_b64_tr_b16 v[150:151], v24 offset:1032
    s_waitcnt lgkmcnt(0)
    s_barrier
    s_load_dwordx2 s[8:9], s[0:1], 32
    s_mov_b32 s10, 4718592
    s_mov_b32 s11, 0x20000
    s_waitcnt lgkmcnt(0)
    s_add_u32 m0, s35, 0
    s_add_u32 s28, s61, 0
    buffer_load_dwordx4 v20, s[8:11], s28 offen lds
    s_add_u32 m0, s35, 4096
    s_add_u32 s28, s61, 131072
    buffer_load_dwordx4 v20, s[8:11], s28 offen lds
    s_add_u32 m0, s35, 8192
    s_add_u32 s28, s61, 262144
    buffer_load_dwordx4 v20, s[8:11], s28 offen lds
    s_add_u32 m0, s35, 12288
    s_add_u32 s28, s61, 393216
    buffer_load_dwordx4 v20, s[8:11], s28 offen lds
    s_add_u32 m0, s35, 16384
    s_add_u32 s28, s61, 524288
    buffer_load_dwordx4 v20, s[8:11], s28 offen lds
    s_add_u32 m0, s35, 20480
    s_add_u32 s28, s61, 655360
    buffer_load_dwordx4 v20, s[8:11], s28 offen lds
    s_add_u32 m0, s35, 24576
    s_add_u32 s28, s61, 786432
    buffer_load_dwordx4 v20, s[8:11], s28 offen lds
    s_add_u32 m0, s35, 28672
    s_add_u32 s28, s61, 917504
    buffer_load_dwordx4 v20, s[8:11], s28 offen lds
    s_add_u32 m0, s35, 32768
    s_add_u32 s28, s61, 1048576
    buffer_load_dwordx4 v20, s[8:11], s28 offen lds
    s_add_u32 m0, s35, 36864
    s_add_u32 s28, s61, 1179648
    buffer_load_dwordx4 v20, s[8:11], s28 offen lds
    s_add_u32 m0, s35, 40960
    s_add_u32 s28, s61, 1310720
    buffer_load_dwordx4 v20, s[8:11], s28 offen lds
    s_add_u32 m0, s35, 45056
    s_add_u32 s28, s61, 1441792
    buffer_load_dwordx4 v20, s[8:11], s28 offen lds
    s_add_u32 m0, s35, 49152
    s_add_u32 s28, s61, 1572864
    buffer_load_dwordx4 v20, s[8:11], s28 offen lds
    s_add_u32 m0, s35, 53248
    s_add_u32 s28, s61, 1703936
    buffer_load_dwordx4 v20, s[8:11], s28 offen lds
    s_add_u32 m0, s35, 57344
    s_add_u32 s28, s61, 1835008
    buffer_load_dwordx4 v20, s[8:11], s28 offen lds
    s_add_u32 m0, s35, 61440
    s_add_u32 s28, s61, 1966080
    buffer_load_dwordx4 v20, s[8:11], s28 offen lds
    s_add_u32 m0, s35, 65536
    s_add_u32 s28, s61, 2097152
    buffer_load_dwordx4 v20, s[8:11], s28 offen lds
    s_add_u32 m0, s35, 69632
    s_add_u32 s28, s61, 2228224
    buffer_load_dwordx4 v20, s[8:11], s28 offen lds
    s_waitcnt vmcnt(18)
    s_barrier
    ds_read_b64_tr_b16 v[152:153], v24 offset:8192
    ds_read_b64_tr_b16 v[154:155], v24 offset:9216
    ds_read_b64_tr_b16 v[156:157], v24 offset:8200
    ds_read_b64_tr_b16 v[158:159], v24 offset:9224
    ds_read_b64_tr_b16 v[160:161], v24 offset:16384
    ds_read_b64_tr_b16 v[162:163], v24 offset:17408
    ds_read_b64_tr_b16 v[164:165], v24 offset:16392
    ds_read_b64_tr_b16 v[166:167], v24 offset:17416
    ds_read_b64_tr_b16 v[168:169], v24 offset:24576
    ds_read_b64_tr_b16 v[170:171], v24 offset:25600
    ds_read_b64_tr_b16 v[172:173], v24 offset:24584
    ds_read_b64_tr_b16 v[174:175], v24 offset:25608
    ds_read_b64_tr_b16 v[176:177], v24 offset:32768
    ds_read_b64_tr_b16 v[178:179], v24 offset:33792
    ds_read_b64_tr_b16 v[180:181], v24 offset:32776
    ds_read_b64_tr_b16 v[182:183], v24 offset:33800
    ds_read_b64_tr_b16 v[184:185], v24 offset:40960
    ds_read_b64_tr_b16 v[186:187], v24 offset:41984
    ds_read_b64_tr_b16 v[188:189], v24 offset:40968
    ds_read_b64_tr_b16 v[190:191], v24 offset:41992
    ds_read_b64_tr_b16 v[192:193], v24 offset:49152
    ds_read_b64_tr_b16 v[194:195], v24 offset:50176
    ds_read_b64_tr_b16 v[196:197], v24 offset:49160
    ds_read_b64_tr_b16 v[198:199], v24 offset:50184
    ds_read_b64_tr_b16 v[200:201], v24 offset:57344
    ds_read_b64_tr_b16 v[202:203], v24 offset:58368
    ds_read_b64_tr_b16 v[204:205], v24 offset:57352
    ds_read_b64_tr_b16 v[206:207], v24 offset:58376
    v_add_u32 v24, 131072, v23
    ds_read_b64_tr_b16 v[208:209], v24 offset:0
    ds_read_b64_tr_b16 v[210:211], v24 offset:1024
    ds_read_b64_tr_b16 v[212:213], v24 offset:8
    ds_read_b64_tr_b16 v[214:215], v24 offset:1032
    ds_read_b64_tr_b16 v[216:217], v24 offset:8192
    ds_read_b64_tr_b16 v[218:219], v24 offset:9216
    ds_read_b64_tr_b16 v[220:221], v24 offset:8200
    ds_read_b64_tr_b16 v[222:223], v24 offset:9224
    s_waitcnt lgkmcnt(0)
    s_barrier
    s_load_dwordx2 s[8:9], s[0:1], 32
    s_mov_b32 s10, 4718592
    s_mov_b32 s11, 0x20000
    s_waitcnt lgkmcnt(0)
    s_add_u32 m0, s35, 73728
    s_add_u32 s28, s61, 2359296
    buffer_load_dwordx4 v20, s[8:11], s28 offen lds
    s_add_u32 m0, s35, 77824
    s_add_u32 s28, s61, 2490368
    buffer_load_dwordx4 v20, s[8:11], s28 offen lds
    s_add_u32 m0, s35, 81920
    s_add_u32 s28, s61, 2621440
    buffer_load_dwordx4 v20, s[8:11], s28 offen lds
    s_add_u32 m0, s35, 86016
    s_add_u32 s28, s61, 2752512
    buffer_load_dwordx4 v20, s[8:11], s28 offen lds
    s_add_u32 m0, s35, 90112
    s_add_u32 s28, s61, 2883584
    buffer_load_dwordx4 v20, s[8:11], s28 offen lds
    s_add_u32 m0, s35, 94208
    s_add_u32 s28, s61, 3014656
    buffer_load_dwordx4 v20, s[8:11], s28 offen lds
    s_add_u32 m0, s35, 98304
    s_add_u32 s28, s61, 3145728
    buffer_load_dwordx4 v20, s[8:11], s28 offen lds
    s_add_u32 m0, s35, 102400
    s_add_u32 s28, s61, 3276800
    buffer_load_dwordx4 v20, s[8:11], s28 offen lds
    s_add_u32 m0, s35, 106496
    s_add_u32 s28, s61, 3407872
    buffer_load_dwordx4 v20, s[8:11], s28 offen lds
    s_add_u32 m0, s35, 110592
    s_add_u32 s28, s61, 3538944
    buffer_load_dwordx4 v20, s[8:11], s28 offen lds
    s_add_u32 m0, s35, 114688
    s_add_u32 s28, s61, 3670016
    buffer_load_dwordx4 v20, s[8:11], s28 offen lds
    s_add_u32 m0, s35, 118784
    s_add_u32 s28, s61, 3801088
    buffer_load_dwordx4 v20, s[8:11], s28 offen lds
    s_add_u32 m0, s35, 122880
    s_add_u32 s28, s61, 3932160
    buffer_load_dwordx4 v20, s[8:11], s28 offen lds
    s_add_u32 m0, s35, 126976
    s_add_u32 s28, s61, 4063232
    buffer_load_dwordx4 v20, s[8:11], s28 offen lds
    s_add_u32 m0, s35, 131072
    s_add_u32 s28, s61, 4194304
    buffer_load_dwordx4 v20, s[8:11], s28 offen lds
    s_add_u32 m0, s35, 135168
    s_add_u32 s28, s61, 4325376
    buffer_load_dwordx4 v20, s[8:11], s28 offen lds
    s_add_u32 m0, s35, 139264
    s_add_u32 s28, s61, 4456448
    buffer_load_dwordx4 v20, s[8:11], s28 offen lds
    s_add_u32 m0, s35, 143360
    s_add_u32 s28, s61, 4587520
    buffer_load_dwordx4 v20, s[8:11], s28 offen lds
    s_waitcnt vmcnt(18)
    s_barrier
    ds_read_b64_tr_b16 v[224:225], v21 offset:0
    ds_read_b64_tr_b16 v[226:227], v21 offset:1024
    ds_read_b64_tr_b16 v[228:229], v22 offset:0
    ds_read_b64_tr_b16 v[230:231], v22 offset:1024
    ds_read_b64_tr_b16 v[232:233], v21 offset:8192
    ds_read_b64_tr_b16 v[234:235], v21 offset:9216
    ds_read_b64_tr_b16 v[236:237], v22 offset:8192
    ds_read_b64_tr_b16 v[238:239], v22 offset:9216
    ds_read_b64_tr_b16 v[240:241], v21 offset:16384
    ds_read_b64_tr_b16 v[242:243], v21 offset:17408
    ds_read_b64_tr_b16 v[244:245], v22 offset:16384
    ds_read_b64_tr_b16 v[246:247], v22 offset:17408
    ds_read_b64_tr_b16 v[248:249], v21 offset:24576
    ds_read_b64_tr_b16 v[250:251], v21 offset:25600
    ds_read_b64_tr_b16 v[252:253], v22 offset:24576
    ds_read_b64_tr_b16 v[254:255], v22 offset:25600
    ds_read_b64_tr_b16 a[0:1], v21 offset:32768
    ds_read_b64_tr_b16 a[2:3], v21 offset:33792
    ds_read_b64_tr_b16 a[4:5], v22 offset:32768
    ds_read_b64_tr_b16 a[6:7], v22 offset:33792
    ds_read_b64_tr_b16 a[8:9], v21 offset:40960
    ds_read_b64_tr_b16 a[10:11], v21 offset:41984
    ds_read_b64_tr_b16 a[12:13], v22 offset:40960
    ds_read_b64_tr_b16 a[14:15], v22 offset:41984
    ds_read_b64_tr_b16 a[16:17], v21 offset:49152
    ds_read_b64_tr_b16 a[18:19], v21 offset:50176
    ds_read_b64_tr_b16 a[20:21], v22 offset:49152
    ds_read_b64_tr_b16 a[22:23], v22 offset:50176
    ds_read_b64_tr_b16 a[24:25], v21 offset:57344
    ds_read_b64_tr_b16 a[26:27], v21 offset:58368
    ds_read_b64_tr_b16 a[28:29], v22 offset:57344
    ds_read_b64_tr_b16 a[30:31], v22 offset:58368
    v_add_u32 v24, 65536, v21
    ds_read_b64_tr_b16 a[32:33], v24 offset:0
    ds_read_b64_tr_b16 a[34:35], v24 offset:1024
    v_add_u32 v24, 65536, v22
    ds_read_b64_tr_b16 a[36:37], v24 offset:0
    ds_read_b64_tr_b16 a[38:39], v24 offset:1024
    s_waitcnt lgkmcnt(0)
    s_barrier
    s_load_dwordx2 s[8:9], s[0:1], 16
    s_mov_b32 s10, 4718592
    s_mov_b32 s11, 0x20000
    s_waitcnt lgkmcnt(0)
    s_add_u32 m0, s35, 0
    s_add_u32 s28, s61, 0
    buffer_load_dwordx4 v20, s[8:11], s28 offen lds
    s_add_u32 m0, s35, 4096
    s_add_u32 s28, s61, 131072
    buffer_load_dwordx4 v20, s[8:11], s28 offen lds
    s_add_u32 m0, s35, 8192
    s_add_u32 s28, s61, 262144
    buffer_load_dwordx4 v20, s[8:11], s28 offen lds
    s_add_u32 m0, s35, 12288
    s_add_u32 s28, s61, 393216
    buffer_load_dwordx4 v20, s[8:11], s28 offen lds
    s_add_u32 m0, s35, 16384
    s_add_u32 s28, s61, 524288
    buffer_load_dwordx4 v20, s[8:11], s28 offen lds
    s_add_u32 m0, s35, 20480
    s_add_u32 s28, s61, 655360
    buffer_load_dwordx4 v20, s[8:11], s28 offen lds
    s_add_u32 m0, s35, 24576
    s_add_u32 s28, s61, 786432
    buffer_load_dwordx4 v20, s[8:11], s28 offen lds
    s_add_u32 m0, s35, 28672
    s_add_u32 s28, s61, 917504
    buffer_load_dwordx4 v20, s[8:11], s28 offen lds
    s_add_u32 m0, s35, 32768
    s_add_u32 s28, s61, 1048576
    buffer_load_dwordx4 v20, s[8:11], s28 offen lds
    s_add_u32 m0, s35, 36864
    s_add_u32 s28, s61, 1179648
    buffer_load_dwordx4 v20, s[8:11], s28 offen lds
    s_add_u32 m0, s35, 40960
    s_add_u32 s28, s61, 1310720
    buffer_load_dwordx4 v20, s[8:11], s28 offen lds
    s_add_u32 m0, s35, 45056
    s_add_u32 s28, s61, 1441792
    buffer_load_dwordx4 v20, s[8:11], s28 offen lds
    s_add_u32 m0, s35, 49152
    s_add_u32 s28, s61, 1572864
    buffer_load_dwordx4 v20, s[8:11], s28 offen lds
    s_add_u32 m0, s35, 53248
    s_add_u32 s28, s61, 1703936
    buffer_load_dwordx4 v20, s[8:11], s28 offen lds
    s_add_u32 m0, s35, 57344
    s_add_u32 s28, s61, 1835008
    buffer_load_dwordx4 v20, s[8:11], s28 offen lds
    s_add_u32 m0, s35, 61440
    s_add_u32 s28, s61, 1966080
    buffer_load_dwordx4 v20, s[8:11], s28 offen lds
    s_add_u32 m0, s35, 65536
    s_add_u32 s28, s61, 2097152
    buffer_load_dwordx4 v20, s[8:11], s28 offen lds
    s_add_u32 m0, s35, 69632
    s_add_u32 s28, s61, 2228224
    buffer_load_dwordx4 v20, s[8:11], s28 offen lds
    s_waitcnt vmcnt(18)
    s_barrier
    v_add_u32 v24, 65536, v21
    ds_read_b64_tr_b16 a[40:41], v24 offset:8192
    ds_read_b64_tr_b16 a[42:43], v24 offset:9216
    v_add_u32 v24, 65536, v22
    ds_read_b64_tr_b16 a[44:45], v24 offset:8192
    ds_read_b64_tr_b16 a[46:47], v24 offset:9216
    v_add_u32 v24, 65536, v21
    ds_read_b64_tr_b16 a[48:49], v24 offset:16384
    ds_read_b64_tr_b16 a[50:51], v24 offset:17408
    v_add_u32 v24, 65536, v22
    ds_read_b64_tr_b16 a[52:53], v24 offset:16384
    ds_read_b64_tr_b16 a[54:55], v24 offset:17408
    v_add_u32 v24, 65536, v21
    ds_read_b64_tr_b16 a[56:57], v24 offset:24576
    ds_read_b64_tr_b16 a[58:59], v24 offset:25600
    v_add_u32 v24, 65536, v22
    ds_read_b64_tr_b16 a[60:61], v24 offset:24576
    ds_read_b64_tr_b16 a[62:63], v24 offset:25600
    v_add_u32 v24, 98304, v21
    ds_read_b64_tr_b16 a[64:65], v24 offset:0
    ds_read_b64_tr_b16 a[66:67], v24 offset:1024
    v_add_u32 v24, 98304, v22
    ds_read_b64_tr_b16 a[68:69], v24 offset:0
    ds_read_b64_tr_b16 a[70:71], v24 offset:1024
    v_add_u32 v24, 98304, v21
    ds_read_b64_tr_b16 a[72:73], v24 offset:8192
    ds_read_b64_tr_b16 a[74:75], v24 offset:9216
    v_add_u32 v24, 98304, v22
    ds_read_b64_tr_b16 a[76:77], v24 offset:8192
    ds_read_b64_tr_b16 a[78:79], v24 offset:9216
    v_add_u32 v24, 98304, v21
    ds_read_b64_tr_b16 a[80:81], v24 offset:16384
    ds_read_b64_tr_b16 a[82:83], v24 offset:17408
    v_add_u32 v24, 98304, v22
    ds_read_b64_tr_b16 a[84:85], v24 offset:16384
    ds_read_b64_tr_b16 a[86:87], v24 offset:17408
    v_add_u32 v24, 98304, v21
    ds_read_b64_tr_b16 a[88:89], v24 offset:24576
    ds_read_b64_tr_b16 a[90:91], v24 offset:25600
    v_add_u32 v24, 98304, v22
    ds_read_b64_tr_b16 a[92:93], v24 offset:24576
    ds_read_b64_tr_b16 a[94:95], v24 offset:25600
    v_add_u32 v24, 131072, v21
    ds_read_b64_tr_b16 a[96:97], v24 offset:0
    ds_read_b64_tr_b16 a[98:99], v24 offset:1024
    v_add_u32 v24, 131072, v22
    ds_read_b64_tr_b16 a[100:101], v24 offset:0
    ds_read_b64_tr_b16 a[102:103], v24 offset:1024
    v_add_u32 v24, 131072, v21
    ds_read_b64_tr_b16 a[104:105], v24 offset:8192
    ds_read_b64_tr_b16 a[106:107], v24 offset:9216
    v_add_u32 v24, 131072, v22
    ds_read_b64_tr_b16 a[108:109], v24 offset:8192
    ds_read_b64_tr_b16 a[110:111], v24 offset:9216
    s_waitcnt lgkmcnt(0)
    s_barrier
    s_load_dwordx2 s[8:9], s[0:1], 16
    s_mov_b32 s10, 4718592
    s_mov_b32 s11, 0x20000
    s_waitcnt lgkmcnt(0)
    s_add_u32 m0, s35, 73728
    s_add_u32 s28, s61, 2359296
    buffer_load_dwordx4 v20, s[8:11], s28 offen lds
    s_add_u32 m0, s35, 77824
    s_add_u32 s28, s61, 2490368
    buffer_load_dwordx4 v20, s[8:11], s28 offen lds
    s_add_u32 m0, s35, 81920
    s_add_u32 s28, s61, 2621440
    buffer_load_dwordx4 v20, s[8:11], s28 offen lds
    s_add_u32 m0, s35, 86016
    s_add_u32 s28, s61, 2752512
    buffer_load_dwordx4 v20, s[8:11], s28 offen lds
    s_add_u32 m0, s35, 90112
    s_add_u32 s28, s61, 2883584
    buffer_load_dwordx4 v20, s[8:11], s28 offen lds
    s_add_u32 m0, s35, 94208
    s_add_u32 s28, s61, 3014656
    buffer_load_dwordx4 v20, s[8:11], s28 offen lds
    s_add_u32 m0, s35, 98304
    s_add_u32 s28, s61, 3145728
    buffer_load_dwordx4 v20, s[8:11], s28 offen lds
    s_add_u32 m0, s35, 102400
    s_add_u32 s28, s61, 3276800
    buffer_load_dwordx4 v20, s[8:11], s28 offen lds
    s_add_u32 m0, s35, 106496
    s_add_u32 s28, s61, 3407872
    buffer_load_dwordx4 v20, s[8:11], s28 offen lds
    s_add_u32 m0, s35, 110592
    s_add_u32 s28, s61, 3538944
    buffer_load_dwordx4 v20, s[8:11], s28 offen lds
    s_add_u32 m0, s35, 114688
    s_add_u32 s28, s61, 3670016
    buffer_load_dwordx4 v20, s[8:11], s28 offen lds
    s_add_u32 m0, s35, 118784
    s_add_u32 s28, s61, 3801088
    buffer_load_dwordx4 v20, s[8:11], s28 offen lds
    s_add_u32 m0, s35, 122880
    s_add_u32 s28, s61, 3932160
    buffer_load_dwordx4 v20, s[8:11], s28 offen lds
    s_add_u32 m0, s35, 126976
    s_add_u32 s28, s61, 4063232
    buffer_load_dwordx4 v20, s[8:11], s28 offen lds
    s_add_u32 m0, s35, 131072
    s_add_u32 s28, s61, 4194304
    buffer_load_dwordx4 v20, s[8:11], s28 offen lds
    s_add_u32 m0, s35, 135168
    s_add_u32 s28, s61, 4325376
    buffer_load_dwordx4 v20, s[8:11], s28 offen lds
    s_add_u32 m0, s35, 139264
    s_add_u32 s28, s61, 4456448
    buffer_load_dwordx4 v20, s[8:11], s28 offen lds
    s_add_u32 m0, s35, 143360
    s_add_u32 s28, s61, 4587520
    buffer_load_dwordx4 v20, s[8:11], s28 offen lds
    s_waitcnt vmcnt(18)
    s_barrier
    ds_read_b64_tr_b16 a[112:113], v23 offset:0
    ds_read_b64_tr_b16 a[114:115], v23 offset:1024
    ds_read_b64_tr_b16 a[116:117], v23 offset:8
    ds_read_b64_tr_b16 a[118:119], v23 offset:1032
    ds_read_b64_tr_b16 a[120:121], v23 offset:8192
    ds_read_b64_tr_b16 a[122:123], v23 offset:9216
    ds_read_b64_tr_b16 a[124:125], v23 offset:8200
    ds_read_b64_tr_b16 a[126:127], v23 offset:9224
    ds_read_b64_tr_b16 a[128:129], v23 offset:16384
    ds_read_b64_tr_b16 a[130:131], v23 offset:17408
    ds_read_b64_tr_b16 a[132:133], v23 offset:16392
    ds_read_b64_tr_b16 a[134:135], v23 offset:17416
    ds_read_b64_tr_b16 a[136:137], v23 offset:24576
    ds_read_b64_tr_b16 a[138:139], v23 offset:25600
    ds_read_b64_tr_b16 a[140:141], v23 offset:24584
    ds_read_b64_tr_b16 a[142:143], v23 offset:25608
    ds_read_b64_tr_b16 a[144:145], v23 offset:32768
    ds_read_b64_tr_b16 a[146:147], v23 offset:33792
    ds_read_b64_tr_b16 a[148:149], v23 offset:32776
    ds_read_b64_tr_b16 a[150:151], v23 offset:33800
    ds_read_b64_tr_b16 a[152:153], v23 offset:40960
    ds_read_b64_tr_b16 a[154:155], v23 offset:41984
    ds_read_b64_tr_b16 a[156:157], v23 offset:40968
    ds_read_b64_tr_b16 a[158:159], v23 offset:41992
    ds_read_b64_tr_b16 a[160:161], v23 offset:49152
    ds_read_b64_tr_b16 a[162:163], v23 offset:50176
    ds_read_b64_tr_b16 a[164:165], v23 offset:49160
    ds_read_b64_tr_b16 a[166:167], v23 offset:50184
    ds_read_b64_tr_b16 a[168:169], v23 offset:57344
    ds_read_b64_tr_b16 a[170:171], v23 offset:58368
    ds_read_b64_tr_b16 a[172:173], v23 offset:57352
    ds_read_b64_tr_b16 a[174:175], v23 offset:58376
    v_add_u32 v24, 65536, v23
    ds_read_b64_tr_b16 a[176:177], v24 offset:0
    ds_read_b64_tr_b16 a[178:179], v24 offset:1024
    ds_read_b64_tr_b16 a[180:181], v24 offset:8
    ds_read_b64_tr_b16 a[182:183], v24 offset:1032
    s_waitcnt lgkmcnt(0)
    s_barrier
    s_waitcnt vmcnt(0)
    s_barrier
    ds_read_b64_tr_b16 a[184:185], v24 offset:8192
    ds_read_b64_tr_b16 a[186:187], v24 offset:9216
    ds_read_b64_tr_b16 a[188:189], v24 offset:8200
    ds_read_b64_tr_b16 a[190:191], v24 offset:9224
    ds_read_b64_tr_b16 a[192:193], v24 offset:16384
    ds_read_b64_tr_b16 a[194:195], v24 offset:17408
    ds_read_b64_tr_b16 a[196:197], v24 offset:16392
    ds_read_b64_tr_b16 a[198:199], v24 offset:17416
    ds_read_b64_tr_b16 a[200:201], v24 offset:24576
    ds_read_b64_tr_b16 a[202:203], v24 offset:25600
    ds_read_b64_tr_b16 a[204:205], v24 offset:24584
    ds_read_b64_tr_b16 a[206:207], v24 offset:25608
    ds_read_b64_tr_b16 a[208:209], v24 offset:32768
    ds_read_b64_tr_b16 a[210:211], v24 offset:33792
    ds_read_b64_tr_b16 a[212:213], v24 offset:32776
    ds_read_b64_tr_b16 a[214:215], v24 offset:33800
    ds_read_b64_tr_b16 a[216:217], v24 offset:40960
    ds_read_b64_tr_b16 a[218:219], v24 offset:41984
    ds_read_b64_tr_b16 a[220:221], v24 offset:40968
    ds_read_b64_tr_b16 a[222:223], v24 offset:41992
    ds_read_b64_tr_b16 a[224:225], v24 offset:49152
    ds_read_b64_tr_b16 a[226:227], v24 offset:50176
    ds_read_b64_tr_b16 a[228:229], v24 offset:49160
    ds_read_b64_tr_b16 a[230:231], v24 offset:50184
    ds_read_b64_tr_b16 a[232:233], v24 offset:57344
    ds_read_b64_tr_b16 a[234:235], v24 offset:58368
    ds_read_b64_tr_b16 a[236:237], v24 offset:57352
    ds_read_b64_tr_b16 a[238:239], v24 offset:58376
    v_add_u32 v24, 131072, v23
    ds_read_b64_tr_b16 a[240:241], v24 offset:0
    ds_read_b64_tr_b16 a[242:243], v24 offset:1024
    ds_read_b64_tr_b16 a[244:245], v24 offset:8
    ds_read_b64_tr_b16 a[246:247], v24 offset:1032
    ds_read_b64_tr_b16 a[248:249], v24 offset:8192
    ds_read_b64_tr_b16 a[250:251], v24 offset:9216
    ds_read_b64_tr_b16 a[252:253], v24 offset:8200
    ds_read_b64_tr_b16 a[254:255], v24 offset:9224
    s_waitcnt lgkmcnt(0)
    s_barrier
    s_lshl_b32 s28, s20, 3
    v_add_u32 v32, 0, v0
    v_mul_u32_u24 v30, 911, v32
    v_lshrrev_b32 v30, 16, v30
    v_mul_u32_u24 v31, 72, v30
    v_sub_u32 v32, v32, v31
    v_add_u32 v30, s28, v30
    v_lshrrev_b32 v6, 1, v30
    v_and_b32 v6, 7, v6
    v_xor_b32 v6, v6, v32
    v_lshlrev_b32 v6, 4, v6
    v_mul_u32_u24 v30, 1152, v30
    v_add_u32 v6, v6, v30
    v_add_u32 v32, 64, v0
    v_mul_u32_u24 v30, 911, v32
    v_lshrrev_b32 v30, 16, v30
    v_mul_u32_u24 v31, 72, v30
    v_sub_u32 v32, v32, v31
    v_add_u32 v30, s28, v30
    v_lshrrev_b32 v7, 1, v30
    v_and_b32 v7, 7, v7
    v_xor_b32 v7, v7, v32
    v_lshlrev_b32 v7, 4, v7
    v_mul_u32_u24 v30, 1152, v30
    v_add_u32 v7, v7, v30
    v_add_u32 v32, 128, v0
    v_mul_u32_u24 v30, 911, v32
    v_lshrrev_b32 v30, 16, v30
    v_mul_u32_u24 v31, 72, v30
    v_sub_u32 v32, v32, v31
    v_add_u32 v30, s28, v30
    v_lshrrev_b32 v8, 1, v30
    v_and_b32 v8, 7, v8
    v_xor_b32 v8, v8, v32
    v_lshlrev_b32 v8, 4, v8
    v_mul_u32_u24 v30, 1152, v30
    v_add_u32 v8, v8, v30
    v_add_u32 v32, 192, v0
    v_mul_u32_u24 v30, 911, v32
    v_lshrrev_b32 v30, 16, v30
    v_mul_u32_u24 v31, 72, v30
    v_sub_u32 v32, v32, v31
    v_add_u32 v30, s28, v30
    v_lshrrev_b32 v9, 1, v30
    v_and_b32 v9, 7, v9
    v_xor_b32 v9, v9, v32
    v_lshlrev_b32 v9, 4, v9
    v_mul_u32_u24 v30, 1152, v30
    v_add_u32 v9, v9, v30
    v_add_u32 v32, 256, v0
    v_mul_u32_u24 v30, 911, v32
    v_lshrrev_b32 v30, 16, v30
    v_mul_u32_u24 v31, 72, v30
    v_sub_u32 v32, v32, v31
    v_add_u32 v30, s28, v30
    v_lshrrev_b32 v10, 1, v30
    v_and_b32 v10, 7, v10
    v_xor_b32 v10, v10, v32
    v_lshlrev_b32 v10, 4, v10
    v_mul_u32_u24 v30, 1152, v30
    v_add_u32 v10, v10, v30
    v_add_u32 v32, 320, v0
    v_mul_u32_u24 v30, 911, v32
    v_lshrrev_b32 v30, 16, v30
    v_mul_u32_u24 v31, 72, v30
    v_sub_u32 v32, v32, v31
    v_add_u32 v30, s28, v30
    v_lshrrev_b32 v11, 1, v30
    v_and_b32 v11, 7, v11
    v_xor_b32 v11, v11, v32
    v_lshlrev_b32 v11, 4, v11
    v_mul_u32_u24 v30, 1152, v30
    v_add_u32 v11, v11, v30
    v_add_u32 v32, 384, v0
    v_mul_u32_u24 v30, 911, v32
    v_lshrrev_b32 v30, 16, v30
    v_mul_u32_u24 v31, 72, v30
    v_sub_u32 v32, v32, v31
    v_add_u32 v30, s28, v30
    v_lshrrev_b32 v12, 1, v30
    v_and_b32 v12, 7, v12
    v_xor_b32 v12, v12, v32
    v_lshlrev_b32 v12, 4, v12
    v_mul_u32_u24 v30, 1152, v30
    v_add_u32 v12, v12, v30
    v_add_u32 v32, 448, v0
    v_mul_u32_u24 v30, 911, v32
    v_lshrrev_b32 v30, 16, v30
    v_mul_u32_u24 v31, 72, v30
    v_sub_u32 v32, v32, v31
    v_add_u32 v30, s28, v30
    v_lshrrev_b32 v13, 1, v30
    v_and_b32 v13, 7, v13
    v_xor_b32 v13, v13, v32
    v_lshlrev_b32 v13, 4, v13
    v_mul_u32_u24 v30, 1152, v30
    v_add_u32 v13, v13, v30
    v_add_u32 v32, 512, v0
    v_mul_u32_u24 v30, 911, v32
    v_lshrrev_b32 v30, 16, v30
    v_mul_u32_u24 v31, 72, v30
    v_sub_u32 v32, v32, v31
    v_add_u32 v30, s28, v30
    v_lshrrev_b32 v14, 1, v30
    v_and_b32 v14, 7, v14
    v_xor_b32 v14, v14, v32
    v_lshlrev_b32 v14, 4, v14
    v_mul_u32_u24 v30, 1152, v30
    v_add_u32 v14, v14, v30
    v_add_u32 v6, 4096, v6
    v_add_u32 v7, 3072, v7
    v_add_u32 v8, 2048, v8
    v_add_u32 v9, 1024, v9
    v_add_u32 v10, 4096, v10
    v_add_u32 v11, 3072, v11
    v_add_u32 v12, 2048, v12
    v_add_u32 v13, 1024, v13
    v_add_u32 v14, 4096, v14
    v_and_b32 v30, 15, v0
    v_bfe_u32 v31, v0, 1, 3
    v_lshrrev_b32 v32, 4, v0
    v_xor_b32 v31, v31, v32
    v_mul_u32_u24 v30, 1152, v30
    v_lshl_add_u32 v1, v31, 4, v30
    v_xor_b32 v31, 4, v31
    v_lshl_add_u32 v2, v31, 4, v30
    v_and_b32 v3, 15, v0
    v_lshlrev_b32 v3, 9, v3
    s_mul_i32 s32, s24, 2359296
    s_add_u32 s32, s32, 1044480
    s_lshl_b32 s33, s20, 13
    s_lshl_b32 s28, s24, 8
    s_add_u32 s33, s33, s28
    s_add_u32 s33, s33, 0
    s_mov_b32 s34, s36
    s_mov_b32 s30, 0
    s_mov_b32 s44, 36864
    s_mov_b32 s40, 1073741824
    s_load_dwordx2 s[8:9], s[0:1], 104
    s_mov_b32 s10, 0
    s_mov_b32 s11, 0x20000
    s_waitcnt lgkmcnt(0)
    v_lshlrev_b32 v0, 4, v0
    s_mul_i32 s37, s24, 50331648
    s_mul_i32 s28, s21, 24576
    s_add_u32 s37, s37, s28
    s_lshl_b32 s28, s20, 11
    s_add_u32 s37, s37, s28
    s_add_u32 s37, s37, 134217728
    s_lshl_b32 s38, s21, 11
    s_lshl_b32 s28, s20, 9
    s_add_u32 s38, s38, s28
    s_lshl_b32 s28, s24, 8
    s_add_u32 s38, s38, s28
    s_add_u32 s39, s38, 131068
    s_add_u32 s38, s38, 196604
    s_mov_b32 s43, 0
    s_mov_b32 s23, 32768
    s_mov_b32 s29, 1
L_spin_13:
    s_sub_u32 s23, s23, 1
    s_cbranch_scc1 L_abort
    s_sleep 2
    s_sleep 4
    buffer_load_dword v30, off, s[16:19], 0 offset:16 sc1
    s_waitcnt vmcnt(0)
    v_cmp_gt_u32 vcc, 256, v30
    s_nop 3
    s_cbranch_vccnz L_spin_13
    s_mov_b32 s23, 32768
    s_mov_b32 s29, 5
L_spin_14:
    s_sub_u32 s23, s23, 1
    s_cbranch_scc1 L_abort
    s_sleep 2
    buffer_load_dword v4, v3, s[4:7], s33 offen sc1
    s_waitcnt vmcnt(0)
    v_cmp_eq_u32 vcc, 0, v4
    s_cbranch_vccnz L_spin_14
    s_add_u32 m0, s34, 0
    s_nop 0
    buffer_load_dwordx4 v6, s[4:7], s32 offen offset:0 sc1 lds
    buffer_load_dwordx4 v7, s[4:7], s32 offen offset:1024 sc1 lds
    buffer_load_dwordx4 v8, s[4:7], s32 offen offset:2048 sc1 lds
    buffer_load_dwordx4 v9, s[4:7], s32 offen offset:3072 sc1 lds
    s_add_u32 m0, s34, 4096
    s_nop 0
    buffer_load_dwordx4 v10, s[4:7], s32 offen offset:0 sc1 lds
    buffer_load_dwordx4 v11, s[4:7], s32 offen offset:1024 sc1 lds
    buffer_load_dwordx4 v12, s[4:7], s32 offen offset:2048 sc1 lds
    buffer_load_dwordx4 v13, s[4:7], s32 offen offset:3072 sc1 lds
    s_add_u32 m0, s34, 8192
    s_nop 0
    buffer_load_dwordx4 v14, s[4:7], s32 offen offset:0 sc1 lds
    s_waitcnt vmcnt(0)
L_proj_loop:
    s_barrier
    ds_read_b128 v[64:67], v1 offset:0
    ds_read_b128 v[68:71], v1 offset:18432
    ds_read_b128 v[72:75], v2 offset:0
    ds_read_b128 v[76:79], v2 offset:18432
    s_add_u32 s32, s32, 36864
    s_add_u32 s33, s33, 4
    s_add_u32 s34, s34, s44
    s_waitcnt lgkmcnt(2)
    v_mfma_f32_16x16x32_bf16 v[16:19], v[80:83], v[64:67], 0
    v_cvt_pk_bf16_f32 v48, v48, v49
    v_cvt_pk_bf16_f32 v49, v50, v51
    v_mfma_f32_16x16x32_bf16 v[32:35], v[64:67], v[224:227], 0
    v_cvt_pk_bf16_f32 v50, v52, v53
    v_cvt_pk_bf16_f32 v51, v54, v55
    v_mfma_f32_16x16x32_bf16 v[20:23], v[84:87], v[64:67], 0
    ds_read_b128 v[52:55], v1 offset:128
    buffer_store_dwordx4 v[48:51], v0, s[8:11], s43 offen offset:0 sc1
    v_mfma_f32_16x16x32_bf16 v[40:43], v[64:67], v[228:231], 0
    ds_read_b128 v[64:67], v2 offset:128
    v_mfma_f32_16x16x32_bf16 v[24:27], v[80:83], v[68:71], 0
    v_cvt_pk_bf16_f32 v56, v56, v57
    v_cvt_pk_bf16_f32 v57, v58, v59
    v_mfma_f32_16x16x32_bf16 v[36:39], v[68:71], v[224:227], 0
    v_cvt_pk_bf16_f32 v58, v60, v61
    v_cvt_pk_bf16_f32 v59, v62, v63
    v_mfma_f32_16x16x32_bf16 v[28:31], v[84:87], v[68:71], 0
    ds_read_b128 v[60:63], v1 offset:18560
    buffer_store_dwordx4 v[56:59], v0, s[8:11], s43 offen offset:1024 sc1
    v_mfma_f32_16x16x32_bf16 v[44:47], v[68:71], v[228:231], 0
    ds_read_b128 v[68:71], v2 offset:18560
    s_waitcnt lgkmcnt(4)
    v_mfma_f32_16x16x32_bf16 v[16:19], v[88:91], v[72:75], v[16:19]
    s_waitcnt vmcnt(2)
    s_or_b32 s28, s38, s40
    s_mov_b64 exec, 1
    buffer_store_dword v2, off, s[4:7], s28 sc1
    s_mov_b64 exec, -1
    v_mfma_f32_16x16x32_bf16 v[32:35], v[72:75], v[232:235], v[32:35]
    v_mfma_f32_16x16x32_bf16 v[20:23], v[92:95], v[72:75], v[20:23]
    v_mfma_f32_16x16x32_bf16 v[40:43], v[72:75], v[236:239], v[40:43]
    ds_read_b128 v[72:75], v1 offset:256
    v_mfma_f32_16x16x32_bf16 v[24:27], v[88:91], v[76:79], v[24:27]
    v_mfma_f32_16x16x32_bf16 v[36:39], v[76:79], v[232:235], v[36:39]
    v_mfma_f32_16x16x32_bf16 v[28:31], v[92:95], v[76:79], v[28:31]
    v_mfma_f32_16x16x32_bf16 v[44:47], v[76:79], v[236:239], v[44:47]
    ds_read_b128 v[76:79], v1 offset:18688
    s_waitcnt lgkmcnt(4)
    v_mfma_f32_16x16x32_bf16 v[16:19], v[96:99], v[52:55], v[16:19]
    v_mfma_f32_16x16x32_bf16 v[32:35], v[52:55], v[240:243], v[32:35]
    v_mfma_f32_16x16x32_bf16 v[20:23], v[100:103], v[52:55], v[20:23]
    v_mfma_f32_16x16x32_bf16 v[40:43], v[52:55], v[244:247], v[40:43]
    ds_read_b128 v[52:55], v2 offset:256
    s_waitcnt lgkmcnt(3)
    v_mfma_f32_16x16x32_bf16 v[24:27], v[96:99], v[60:63], v[24:27]
    v_mfma_f32_16x16x32_bf16 v[36:39], v[60:63], v[240:243], v[36:39]
    v_mfma_f32_16x16x32_bf16 v[28:31], v[100:103], v[60:63], v[28:31]
    v_mfma_f32_16x16x32_bf16 v[44:47], v[60:63], v[244:247], v[44:47]
    ds_read_b128 v[60:63], v2 offset:18688
    v_mfma_f32_16x16x32_bf16 v[16:19], v[104:107], v[64:67], v[16:19]
    v_mfma_f32_16x16x32_bf16 v[32:35], v[64:67], v[248:251], v[32:35]
    v_mfma_f32_16x16x32_bf16 v[20:23], v[108:111], v[64:67], v[20:23]
    v_mfma_f32_16x16x32_bf16 v[40:43], v[64:67], v[252:255], v[40:43]
    ds_read_b128 v[64:67], v1 offset:384
    v_mfma_f32_16x16x32_bf16 v[24:27], v[104:107], v[68:71], v[24:27]
    v_mfma_f32_16x16x32_bf16 v[36:39], v[68:71], v[248:251], v[36:39]
    v_mfma_f32_16x16x32_bf16 v[28:31], v[108:111], v[68:71], v[28:31]
    v_mfma_f32_16x16x32_bf16 v[44:47], v[68:71], v[252:255], v[44:47]
    ds_read_b128 v[68:71], v1 offset:18816
    s_waitcnt lgkmcnt(4)
    v_mfma_f32_16x16x32_bf16 v[16:19], v[112:115], v[72:75], v[16:19]
    v_mfma_f32_16x16x32_bf16 v[32:35], v[72:75], a[0:3], v[32:35]
    v_mfma_f32_16x16x32_bf16 v[20:23], v[116:119], v[72:75], v[20:23]
    v_mfma_f32_16x16x32_bf16 v[40:43], v[72:75], a[4:7], v[40:43]
    ds_read_b128 v[72:75], v2 offset:384
    v_mfma_f32_16x16x32_bf16 v[24:27], v[112:115], v[76:79], v[24:27]
    v_mfma_f32_16x16x32_bf16 v[36:39], v[76:79], a[0:3], v[36:39]
    v_mfma_f32_16x16x32_bf16 v[28:31], v[116:119], v[76:79], v[28:31]
    v_mfma_f32_16x16x32_bf16 v[44:47], v[76:79], a[4:7], v[44:47]
    ds_read_b128 v[76:79], v2 offset:18816
    s_waitcnt lgkmcnt(4)
    v_mfma_f32_16x16x32_bf16 v[16:19], v[120:123], v[52:55], v[16:19]
    v_mfma_f32_16x16x32_bf16 v[32:35], v[52:55], a[8:11], v[32:35]
    v_mfma_f32_16x16x32_bf16 v[20:23], v[124:127], v[52:55], v[20:23]
    v_mfma_f32_16x16x32_bf16 v[40:43], v[52:55], a[12:15], v[40:43]
    ds_read_b128 v[52:55], v1 offset:512
    v_mfma_f32_16x16x32_bf16 v[24:27], v[120:123], v[60:63], v[24:27]
    v_mfma_f32_16x16x32_bf16 v[36:39], v[60:63], a[8:11], v[36:39]
    v_mfma_f32_16x16x32_bf16 v[28:31], v[124:127], v[60:63], v[28:31]
    v_mfma_f32_16x16x32_bf16 v[44:47], v[60:63], a[12:15], v[44:47]
    ds_read_b128 v[60:63], v1 offset:18944
    s_waitcnt lgkmcnt(4)
    v_mfma_f32_16x16x32_bf16 v[16:19], v[128:131], v[64:67], v[16:19]
    v_mfma_f32_16x16x32_bf16 v[32:35], v[64:67], a[16:19], v[32:35]
    v_mfma_f32_16x16x32_bf16 v[20:23], v[132:135], v[64:67], v[20:23]
    v_mfma_f32_16x16x32_bf16 v[40:43], v[64:67], a[20:23], v[40:43]
    ds_read_b128 v[64:67], v2 offset:512
    v_mfma_f32_16x16x32_bf16 v[24:27], v[128:131], v[68:71], v[24:27]
    v_mfma_f32_16x16x32_bf16 v[36:39], v[68:71], a[16:19], v[36:39]
    v_mfma_f32_16x16x32_bf16 v[28:31], v[132:135], v[68:71], v[28:31]
    v_mfma_f32_16x16x32_bf16 v[44:47], v[68:71], a[20:23], v[44:47]
    ds_read_b128 v[68:71], v2 offset:18944
    s_waitcnt lgkmcnt(4)
    v_mfma_f32_16x16x32_bf16 v[16:19], v[136:139], v[72:75], v[16:19]
    v_mfma_f32_16x16x32_bf16 v[32:35], v[72:75], a[24:27], v[32:35]
    v_mfma_f32_16x16x32_bf16 v[20:23], v[140:143], v[72:75], v[20:23]
    v_mfma_f32_16x16x32_bf16 v[40:43], v[72:75], a[28:31], v[40:43]
    ds_read_b128 v[72:75], v1 offset:640
    v_mfma_f32_16x16x32_bf16 v[24:27], v[136:139], v[76:79], v[24:27]
    buffer_load_dword v4, v3, s[4:7], s33 offen sc1
    v_mfma_f32_16x16x32_bf16 v[36:39], v[76:79], a[24:27], v[36:39]
    v_mfma_f32_16x16x32_bf16 v[28:31], v[140:143], v[76:79], v[28:31]
    s_waitcnt vmcnt(2)
    s_or_b32 s28, s39, s40
    s_mov_b64 exec, 1
    buffer_store_dword v2, off, s[4:7], s28 sc1
    s_mov_b64 exec, -1
    v_mfma_f32_16x16x32_bf16 v[44:47], v[76:79], a[28:31], v[44:47]
    ds_read_b128 v[76:79], v1 offset:19072
    s_waitcnt lgkmcnt(4)
    v_mfma_f32_16x16x32_bf16 v[16:19], v[144:147], v[52:55], v[16:19]
    v_mfma_f32_16x16x32_bf16 v[32:35], v[52:55], a[32:35], v[32:35]
    v_mfma_f32_16x16x32_bf16 v[20:23], v[148:151], v[52:55], v[20:23]
    v_mfma_f32_16x16x32_bf16 v[40:43], v[52:55], a[36:39], v[40:43]
    ds_read_b128 v[52:55], v2 offset:640
    v_mfma_f32_16x16x32_bf16 v[24:27], v[144:147], v[60:63], v[24:27]
    v_mfma_f32_16x16x32_bf16 v[36:39], v[60:63], a[32:35], v[36:39]
    v_mfma_f32_16x16x32_bf16 v[28:31], v[148:151], v[60:63], v[28:31]
    v_mfma_f32_16x16x32_bf16 v[44:47], v[60:63], a[36:39], v[44:47]
    ds_read_b128 v[60:63], v2 offset:19072
    s_waitcnt lgkmcnt(4)
    v_mfma_f32_16x16x32_bf16 v[16:19], v[152:155], v[64:67], v[16:19]
    v_mfma_f32_16x16x32_bf16 v[32:35], v[64:67], a[40:43], v[32:35]
    v_mfma_f32_16x16x32_bf16 v[20:23], v[156:159], v[64:67], v[20:23]
    v_mfma_f32_16x16x32_bf16 v[40:43], v[64:67], a[44:47], v[40:43]
    ds_read_b128 v[64:67], v1 offset:768
    v_mfma_f32_16x16x32_bf16 v[24:27], v[152:155], v[68:71], v[24:27]
    v_mfma_f32_16x16x32_bf16 v[36:39], v[68:71], a[40:43], v[36:39]
    v_mfma_f32_16x16x32_bf16 v[28:31], v[156:159], v[68:71], v[28:31]
    v_mfma_f32_16x16x32_bf16 v[44:47], v[68:71], a[44:47], v[44:47]
    ds_read_b128 v[68:71], v1 offset:19200
    s_waitcnt lgkmcnt(4)
    v_mfma_f32_16x16x32_bf16 v[16:19], v[160:163], v[72:75], v[16:19]
    v_mfma_f32_16x16x32_bf16 v[32:35], v[72:75], a[48:51], v[32:35]
    v_mfma_f32_16x16x32_bf16 v[20:23], v[164:167], v[72:75], v[20:23]
    v_mfma_f32_16x16x32_bf16 v[40:43], v[72:75], a[52:55], v[40:43]
    ds_read_b128 v[72:75], v2 offset:768
    v_mfma_f32_16x16x32_bf16 v[24:27], v[160:163], v[76:79], v[24:27]
    v_mfma_f32_16x16x32_bf16 v[36:39], v[76:79], a[48:51], v[36:39]
    v_mfma_f32_16x16x32_bf16 v[28:31], v[164:167], v[76:79], v[28:31]
    v_mfma_f32_16x16x32_bf16 v[44:47], v[76:79], a[52:55], v[44:47]
    ds_read_b128 v[76:79], v2 offset:19200
    s_waitcnt lgkmcnt(4)
    v_mfma_f32_16x16x32_bf16 v[16:19], v[168:171], v[52:55], v[16:19]
    v_mfma_f32_16x16x32_bf16 v[32:35], v[52:55], a[56:59], v[32:35]
    v_mfma_f32_16x16x32_bf16 v[20:23], v[172:175], v[52:55], v[20:23]
    v_mfma_f32_16x16x32_bf16 v[40:43], v[52:55], a[60:63], v[40:43]
    ds_read_b128 v[52:55], v1 offset:896
    v_mfma_f32_16x16x32_bf16 v[24:27], v[168:171], v[60:63], v[24:27]
    v_mfma_f32_16x16x32_bf16 v[36:39], v[60:63], a[56:59], v[36:39]
    v_mfma_f32_16x16x32_bf16 v[28:31], v[172:175], v[60:63], v[28:31]
    v_mfma_f32_16x16x32_bf16 v[44:47], v[60:63], a[60:63], v[44:47]
    ds_read_b128 v[60:63], v1 offset:19328
    s_waitcnt lgkmcnt(4)
    v_mfma_f32_16x16x32_bf16 v[16:19], v[176:179], v[64:67], v[16:19]
    s_waitcnt vmcnt(1)
    v_cmp_eq_u32 vcc, 0, v4
    s_nop 0
    s_cmp_eq_u64 vcc, 0
    s_cselect_b32 s10, 268435456, 0
    s_cmp_eq_u32 s30, 63
    s_cselect_b32 s10, 0, s10
    v_mfma_f32_16x16x32_bf16 v[32:35], v[64:67], a[64:67], v[32:35]
    v_mfma_f32_16x16x32_bf16 v[20:23], v[180:183], v[64:67], v[20:23]
    v_mfma_f32_16x16x32_bf16 v[40:43], v[64:67], a[68:71], v[40:43]
    ds_read_b128 v[64:67], v2 offset:896
    v_mfma_f32_16x16x32_bf16 v[24:27], v[176:179], v[68:71], v[24:27]
    s_add_u32 m0, s34, 0
    s_nop 0
    buffer_load_dwordx4 v6, s[8:11], s32 offen offset:0 sc1 lds
    v_mfma_f32_16x16x32_bf16 v[36:39], v[68:71], a[64:67], v[36:39]
    v_mfma_f32_16x16x32_bf16 v[28:31], v[180:183], v[68:71], v[28:31]
    v_mfma_f32_16x16x32_bf16 v[44:47], v[68:71], a[68:71], v[44:47]
    ds_read_b128 v[68:71], v2 offset:19328
    s_waitcnt lgkmcnt(4)
    v_mfma_f32_16x16x32_bf16 v[16:19], v[184:187], v[72:75], v[16:19]
    buffer_load_dwordx4 v7, s[8:11], s32 offen offset:1024 sc1 lds
    v_mfma_f32_16x16x32_bf16 v[32:35], v[72:75], a[72:75], v[32:35]
    v_mfma_f32_16x16x32_bf16 v[20:23], v[188:191], v[72:75], v[20:23]
    v_mfma_f32_16x16x32_bf16 v[40:43], v[72:75], a[76:79], v[40:43]
    ds_read_b128 v[72:75], v1 offset:1024
    v_mfma_f32_16x16x32_bf16 v[24:27], v[184:187], v[76:79], v[24:27]
    buffer_load_dwordx4 v8, s[8:11], s32 offen offset:2048 sc1 lds
    v_mfma_f32_16x16x32_bf16 v[36:39], v[76:79], a[72:75], v[36:39]
    v_mfma_f32_16x16x32_bf16 v[28:31], v[188:191], v[76:79], v[28:31]
    v_mfma_f32_16x16x32_bf16 v[44:47], v[76:79], a[76:79], v[44:47]
    ds_read_b128 v[76:79], v1 offset:19456
    s_waitcnt lgkmcnt(4)
    v_mfma_f32_16x16x32_bf16 v[16:19], v[192:195], v[52:55], v[16:19]
    buffer_load_dwordx4 v9, s[8:11], s32 offen offset:3072 sc1 lds
    v_mfma_f32_16x16x32_bf16 v[32:35], v[52:55], a[80:83], v[32:35]
    v_mfma_f32_16x16x32_bf16 v[20:23], v[196:199], v[52:55], v[20:23]
    v_mfma_f32_16x16x32_bf16 v[40:43], v[52:55], a[84:87], v[40:43]
    ds_read_b128 v[52:55], v2 offset:1024
    v_mfma_f32_16x16x32_bf16 v[24:27], v[192:195], v[60:63], v[24:27]
    s_add_u32 m0, s34, 4096
    s_nop 0
    buffer_load_dwordx4 v10, s[8:11], s32 offen offset:0 sc1 lds
    v_mfma_f32_16x16x32_bf16 v[36:39], v[60:63], a[80:83], v[36:39]
    v_mfma_f32_16x16x32_bf16 v[28:31], v[196:199], v[60:63], v[28:31]
    v_mfma_f32_16x16x32_bf16 v[44:47], v[60:63], a[84:87], v[44:47]
    ds_read_b128 v[60:63], v2 offset:19456
    s_waitcnt lgkmcnt(4)
    v_mfma_f32_16x16x32_bf16 v[16:19], v[200:203], v[64:67], v[16:19]
    buffer_load_dwordx4 v11, s[8:11], s32 offen offset:1024 sc1 lds
    v_mfma_f32_16x16x32_bf16 v[32:35], v[64:67], a[88:91], v[32:35]
    v_mfma_f32_16x16x32_bf16 v[20:23], v[204:207], v[64:67], v[20:23]
    v_mfma_f32_16x16x32_bf16 v[40:43], v[64:67], a[92:95], v[40:43]
    ds_read_b128 v[64:67], v1 offset:0
    v_mfma_f32_16x16x32_bf16 v[24:27], v[200:203], v[68:71], v[24:27]
    buffer_load_dwordx4 v12, s[8:11], s32 offen offset:2048 sc1 lds
    v_mfma_f32_16x16x32_bf16 v[36:39], v[68:71], a[88:91], v[36:39]
    v_mfma_f32_16x16x32_bf16 v[28:31], v[204:207], v[68:71], v[28:31]
    v_mfma_f32_16x16x32_bf16 v[44:47], v[68:71], a[92:95], v[44:47]
    ds_read_b128 v[68:71], v1 offset:18432
    s_waitcnt lgkmcnt(4)
    v_mfma_f32_16x16x32_bf16 v[16:19], v[208:211], v[72:75], v[16:19]
    buffer_load_dwordx4 v13, s[8:11], s32 offen offset:3072 sc1 lds
    v_mfma_f32_16x16x32_bf16 v[32:35], v[72:75], a[96:99], v[32:35]
    v_mfma_f32_16x16x32_bf16 v[20:23], v[212:215], v[72:75], v[20:23]
    v_mfma_f32_16x16x32_bf16 v[40:43], v[72:75], a[100:103], v[40:43]
    ds_read_b128 v[72:75], v2 offset:0
    v_mfma_f32_16x16x32_bf16 v[24:27], v[208:211], v[76:79], v[24:27]
    s_add_u32 m0, s34, 8192
    s_nop 0
    buffer_load_dwordx4 v14, s[8:11], s32 offen offset:0 sc1 lds
    v_mfma_f32_16x16x32_bf16 v[36:39], v[76:79], a[96:99], v[36:39]
    v_mfma_f32_16x16x32_bf16 v[28:31], v[212:215], v[76:79], v[28:31]
    v_mfma_f32_16x16x32_bf16 v[44:47], v[76:79], a[100:103], v[44:47]
    ds_read_b128 v[76:79], v2 offset:18432
    s_waitcnt lgkmcnt(4)
    v_mfma_f32_16x16x32_bf16 v[16:19], v[216:219], v[52:55], v[16:19]
    v_mfma_f32_16x16x32_bf16 v[32:35], v[52:55], a[104:107], v[32:35]
    v_mfma_f32_16x16x32_bf16 v[20:23], v[220:223], v[52:55], v[20:23]
    v_mfma_f32_16x16x32_bf16 v[40:43], v[52:55], a[108:111], v[40:43]
    v_mfma_f32_16x16x32_bf16 v[24:27], v[216:219], v[60:63], v[24:27]
    v_mfma_f32_16x16x32_bf16 v[36:39], v[60:63], a[104:107], v[36:39]
    v_mfma_f32_16x16x32_bf16 v[28:31], v[220:223], v[60:63], v[28:31]
    v_mfma_f32_16x16x32_bf16 v[44:47], v[60:63], a[108:111], v[44:47]
    s_waitcnt lgkmcnt(2)
    v_mfma_f32_16x16x32_bf16 v[48:51], a[112:115], v[64:67], 0
    s_add_u32 s60, s37, 8192
    s_add_u32 s61, s37, 16384
    v_cvt_pk_bf16_f32 v16, v16, v17
    v_mfma_f32_16x16x32_bf16 v[52:55], a[116:119], v[64:67], 0
    ds_read_b128 v[64:67], v2 offset:128
    v_cvt_pk_bf16_f32 v17, v18, v19
    v_cvt_pk_bf16_f32 v18, v20, v21
    v_cvt_pk_bf16_f32 v19, v22, v23
    v_mfma_f32_16x16x32_bf16 v[56:59], a[112:115], v[68:71], 0
    ds_read_b128 v[20:23], v1 offset:128
    v_cvt_pk_bf16_f32 v24, v24, v25
    v_cvt_pk_bf16_f32 v25, v26, v27
    v_mfma_f32_16x16x32_bf16 v[60:63], a[116:119], v[68:71], 0
    ds_read_b128 v[68:71], v2 offset:18560
    v_cvt_pk_bf16_f32 v26, v28, v29
    v_cvt_pk_bf16_f32 v27, v30, v31
    ds_read_b128 v[28:31], v1 offset:18560
    s_waitcnt lgkmcnt(4)
    v_mfma_f32_16x16x32_bf16 v[48:51], a[120:123], v[72:75], v[48:51]
    buffer_store_dwordx4 v[16:19], v0, s[4:7], s60 offen offset:0 sc1
    v_mfma_f32_16x16x32_bf16 v[52:55], a[124:127], v[72:75], v[52:55]
    ds_read_b128 v[72:75], v1 offset:256
    v_cvt_pk_bf16_f32 v32, v32, v33
    v_cvt_pk_bf16_f32 v33, v34, v35
    v_cvt_pk_bf16_f32 v34, v36, v37
    v_mfma_f32_16x16x32_bf16 v[56:59], a[120:123], v[76:79], v[56:59]
    v_cvt_pk_bf16_f32 v35, v38, v39
    buffer_store_dwordx4 v[24:27], v0, s[4:7], s60 offen offset:1024 sc1
    v_mfma_f32_16x16x32_bf16 v[60:63], a[124:127], v[76:79], v[60:63]
    ds_read_b128 v[76:79], v1 offset:18688
    s_waitcnt lgkmcnt(3)
    v_mfma_f32_16x16x32_bf16 v[48:51], a[128:131], v[20:23], v[48:51]
    v_cvt_pk_bf16_f32 v40, v40, v41
    v_cvt_pk_bf16_f32 v41, v42, v43
    v_mfma_f32_16x16x32_bf16 v[52:55], a[132:135], v[20:23], v[52:55]
    ds_read_b128 v[20:23], v2 offset:256
    s_waitcnt lgkmcnt(2)
    v_mfma_f32_16x16x32_bf16 v[56:59], a[128:131], v[28:31], v[56:59]
    v_cvt_pk_bf16_f32 v42, v44, v45
    v_cvt_pk_bf16_f32 v43, v46, v47
    v_mfma_f32_16x16x32_bf16 v[60:63], a[132:135], v[28:31], v[60:63]
    ds_read_b128 v[28:31], v2 offset:18688
    buffer_store_dwordx4 v[32:35], v0, s[4:7], s61 offen offset:0 sc1
    v_mfma_f32_16x16x32_bf16 v[48:51], a[136:139], v[64:67], v[48:51]
    buffer_store_dwordx4 v[40:43], v0, s[4:7], s61 offen offset:1024 sc1
    v_mfma_f32_16x16x32_bf16 v[52:55], a[140:143], v[64:67], v[52:55]
    ds_read_b128 v[64:67], v1 offset:384
    v_mfma_f32_16x16x32_bf16 v[56:59], a[136:139], v[68:71], v[56:59]
    v_mfma_f32_16x16x32_bf16 v[60:63], a[140:143], v[68:71], v[60:63]
    ds_read_b128 v[68:71], v1 offset:18816
    v_mfma_f32_16x16x32_bf16 v[48:51], a[144:147], v[72:75], v[48:51]
    v_mfma_f32_16x16x32_bf16 v[52:55], a[148:151], v[72:75], v[52:55]
    ds_read_b128 v[72:75], v2 offset:384
    s_waitcnt lgkmcnt(4)
    v_mfma_f32_16x16x32_bf16 v[56:59], a[144:147], v[76:79], v[56:59]
    v_mfma_f32_16x16x32_bf16 v[60:63], a[148:151], v[76:79], v[60:63]
    ds_read_b128 v[76:79], v2 offset:18816
    v_mfma_f32_16x16x32_bf16 v[48:51], a[152:155], v[20:23], v[48:51]
    v_mfma_f32_16x16x32_bf16 v[52:55], a[156:159], v[20:23], v[52:55]
    ds_read_b128 v[20:23], v1 offset:512
    s_waitcnt lgkmcnt(4)
    v_mfma_f32_16x16x32_bf16 v[56:59], a[152:155], v[28:31], v[56:59]
    v_mfma_f32_16x16x32_bf16 v[60:63], a[156:159], v[28:31], v[60:63]
    ds_read_b128 v[28:31], v1 offset:18944
    v_mfma_f32_16x16x32_bf16 v[48:51], a[160:163], v[64:67], v[48:51]
    v_mfma_f32_16x16x32_bf16 v[52:55], a[164:167], v[64:67], v[52:55]
    ds_read_b128 v[64:67], v2 offset:512
    s_waitcnt lgkmcnt(4)
    v_mfma_f32_16x16x32_bf16 v[56:59], a[160:163], v[68:71], v[56:59]
    v_mfma_f32_16x16x32_bf16 v[60:63], a[164:167], v[68:71], v[60:63]
    ds_read_b128 v[68:71], v2 offset:18944
    v_mfma_f32_16x16x32_bf16 v[48:51], a[168:171], v[72:75], v[48:51]
    v_mfma_f32_16x16x32_bf16 v[52:55], a[172:175], v[72:75], v[52:55]
    ds_read_b128 v[72:75], v1 offset:640
    s_waitcnt lgkmcnt(4)
    v_mfma_f32_16x16x32_bf16 v[56:59], a[168:171], v[76:79], v[56:59]
    v_mfma_f32_16x16x32_bf16 v[60:63], a[172:175], v[76:79], v[60:63]
    ds_read_b128 v[76:79], v1 offset:19072
    v_mfma_f32_16x16x32_bf16 v[48:51], a[176:179], v[20:23], v[48:51]
    v_mfma_f32_16x16x32_bf16 v[52:55], a[180:183], v[20:23], v[52:55]
    ds_read_b128 v[20:23], v2 offset:640
    s_waitcnt lgkmcnt(4)
    v_mfma_f32_16x16x32_bf16 v[56:59], a[176:179], v[28:31], v[56:59]
    v_mfma_f32_16x16x32_bf16 v[60:63], a[180:183], v[28:31], v[60:63]
    ds_read_b128 v[28:31], v2 offset:19072
    v_mfma_f32_16x16x32_bf16 v[48:51], a[184:187], v[64:67], v[48:51]
    v_mfma_f32_16x16x32_bf16 v[52:55], a[188:191], v[64:67], v[52:55]
    ds_read_b128 v[64:67], v1 offset:768
    s_waitcnt lgkmcnt(4)
    v_mfma_f32_16x16x32_bf16 v[56:59], a[184:187], v[68:71], v[56:59]
    v_mfma_f32_16x16x32_bf16 v[60:63], a[188:191], v[68:71], v[60:63]
    ds_read_b128 v[68:71], v1 offset:19200
    v_mfma_f32_16x16x32_bf16 v[48:51], a[192:195], v[72:75], v[48:51]
    v_mfma_f32_16x16x32_bf16 v[52:55], a[196:199], v[72:75], v[52:55]
    ds_read_b128 v[72:75], v2 offset:768
    s_waitcnt lgkmcnt(4)
    v_mfma_f32_16x16x32_bf16 v[56:59], a[192:195], v[76:79], v[56:59]
    v_mfma_f32_16x16x32_bf16 v[60:63], a[196:199], v[76:79], v[60:63]
    ds_read_b128 v[76:79], v2 offset:19200
    v_mfma_f32_16x16x32_bf16 v[48:51], a[200:203], v[20:23], v[48:51]
    v_mfma_f32_16x16x32_bf16 v[52:55], a[204:207], v[20:23], v[52:55]
    ds_read_b128 v[20:23], v1 offset:896
    s_waitcnt lgkmcnt(4)
    v_mfma_f32_16x16x32_bf16 v[56:59], a[200:203], v[28:31], v[56:59]
    v_mfma_f32_16x16x32_bf16 v[60:63], a[204:207], v[28:31], v[60:63]
    ds_read_b128 v[28:31], v1 offset:19328
    v_mfma_f32_16x16x32_bf16 v[48:51], a[208:211], v[64:67], v[48:51]
    v_mfma_f32_16x16x32_bf16 v[52:55], a[212:215], v[64:67], v[52:55]
    ds_read_b128 v[64:67], v2 offset:896
    s_waitcnt lgkmcnt(4)
    v_mfma_f32_16x16x32_bf16 v[56:59], a[208:211], v[68:71], v[56:59]
    v_mfma_f32_16x16x32_bf16 v[60:63], a[212:215], v[68:71], v[60:63]
    ds_read_b128 v[68:71], v2 offset:19328
    v_mfma_f32_16x16x32_bf16 v[48:51], a[216:219], v[72:75], v[48:51]
    v_mfma_f32_16x16x32_bf16 v[52:55], a[220:223], v[72:75], v[52:55]
    ds_read_b128 v[72:75], v1 offset:1024
    s_waitcnt lgkmcnt(4)
    v_mfma_f32_16x16x32_bf16 v[56:59], a[216:219], v[76:79], v[56:59]
    v_mfma_f32_16x16x32_bf16 v[60:63], a[220:223], v[76:79], v[60:63]
    ds_read_b128 v[76:79], v1 offset:19456
    v_mfma_f32_16x16x32_bf16 v[48:51], a[224:227], v[20:23], v[48:51]
    v_mfma_f32_16x16x32_bf16 v[52:55], a[228:231], v[20:23], v[52:55]
    ds_read_b128 v[20:23], v2 offset:1024
    s_waitcnt lgkmcnt(4)
    v_mfma_f32_16x16x32_bf16 v[56:59], a[224:227], v[28:31], v[56:59]
    v_mfma_f32_16x16x32_bf16 v[60:63], a[228:231], v[28:31], v[60:63]
    ds_read_b128 v[28:31], v2 offset:19456
    v_mfma_f32_16x16x32_bf16 v[48:51], a[232:235], v[64:67], v[48:51]
    s_add_u32 s39, s39, 4
    s_mov_b32 s40, 0
    v_mfma_f32_16x16x32_bf16 v[52:55], a[236:239], v[64:67], v[52:55]
    s_waitcnt lgkmcnt(3)
    v_add_u32 v1, s44, v1
    v_mfma_f32_16x16x32_bf16 v[56:59], a[232:235], v[68:71], v[56:59]
    v_add_u32 v2, s44, v2
    s_sub_u32 s44, 0, s44
    v_mfma_f32_16x16x32_bf16 v[60:63], a[236:239], v[68:71], v[60:63]
    s_add_u32 s38, s38, 4
    s_mov_b32 s43, s37
    v_mfma_f32_16x16x32_bf16 v[48:51], a[240:243], v[72:75], v[48:51]
    s_add_u32 s37, s37, 786432
    v_mfma_f32_16x16x32_bf16 v[52:55], a[244:247], v[72:75], v[52:55]
    s_waitcnt lgkmcnt(2)
    v_mfma_f32_16x16x32_bf16 v[56:59], a[240:243], v[76:79], v[56:59]
    v_mfma_f32_16x16x32_bf16 v[60:63], a[244:247], v[76:79], v[60:63]
    s_waitcnt lgkmcnt(1)
    v_mfma_f32_16x16x32_bf16 v[48:51], a[248:251], v[20:23], v[48:51]
    v_mfma_f32_16x16x32_bf16 v[52:55], a[252:255], v[20:23], v[52:55]
    s_waitcnt lgkmcnt(0)
    v_mfma_f32_16x16x32_bf16 v[56:59], a[248:251], v[28:31], v[56:59]
    v_mfma_f32_16x16x32_bf16 v[60:63], a[252:255], v[28:31], v[60:63]
    s_add_u32 s30, s30, 1
    s_cmp_lg_u32 s10, 0
    s_waitcnt vmcnt(4)
    s_cbranch_scc1 L_proj_loop
    v_cvt_pk_bf16_f32 v48, v48, v49
    v_cvt_pk_bf16_f32 v49, v50, v51
    v_cvt_pk_bf16_f32 v50, v52, v53
    v_cvt_pk_bf16_f32 v51, v54, v55
    buffer_store_dwordx4 v[48:51], v0, s[4:7], s43 offen offset:0 sc1
    v_cvt_pk_bf16_f32 v56, v56, v57
    v_cvt_pk_bf16_f32 v57, v58, v59
    v_cvt_pk_bf16_f32 v58, v60, v61
    v_cvt_pk_bf16_f32 v59, v62, v63
    buffer_store_dwordx4 v[56:59], v0, s[4:7], s43 offen offset:1024 sc1
    s_waitcnt vmcnt(2)
    s_or_b32 s28, s38, s40
    s_mov_b64 exec, 1
    buffer_store_dword v2, off, s[4:7], s28 sc1
    s_mov_b64 exec, -1
    s_mov_b32 s23, 32768
    s_mov_b32 s29, 6
L_spin_15:
    s_sub_u32 s23, s23, 1
    s_cbranch_scc1 L_abort
    s_sleep 2
    buffer_load_dword v4, v3, s[4:7], s33 offen sc1
    s_waitcnt vmcnt(0)
    s_or_b32 s28, s39, s40
    s_mov_b64 exec, 1
    buffer_store_dword v2, off, s[4:7], s28 sc1
    s_mov_b64 exec, -1
    s_mov_b32 s40, 1073741824
    s_cmp_eq_u32 s30, 64
    s_cbranch_scc1 L_proj_done
    v_cmp_eq_u32 vcc, 0, v4
    s_cbranch_vccnz L_spin_15
    s_add_u32 m0, s34, 0
    s_nop 0
    buffer_load_dwordx4 v6, s[4:7], s32 offen offset:0 sc1 lds
    buffer_load_dwordx4 v7, s[4:7], s32 offen offset:1024 sc1 lds
    buffer_load_dwordx4 v8, s[4:7], s32 offen offset:2048 sc1 lds
    buffer_load_dwordx4 v9, s[4:7], s32 offen offset:3072 sc1 lds
    s_add_u32 m0, s34, 4096
    s_nop 0
    buffer_load_dwordx4 v10, s[4:7], s32 offen offset:0 sc1 lds
    buffer_load_dwordx4 v11, s[4:7], s32 offen offset:1024 sc1 lds
    buffer_load_dwordx4 v12, s[4:7], s32 offen offset:2048 sc1 lds
    buffer_load_dwordx4 v13, s[4:7], s32 offen offset:3072 sc1 lds
    s_add_u32 m0, s34, 8192
    s_nop 0
    buffer_load_dwordx4 v14, s[4:7], s32 offen offset:0 sc1 lds
    s_waitcnt vmcnt(0)
    s_branch L_proj_loop
L_proj_done:
    s_endpgm
L_atn:
    s_waitcnt vmcnt(0)
    s_barrier
    s_cmp_lg_u32 s20, 0
    s_cbranch_scc1 L_arr_16
    s_mov_b64 exec, 1
    v_mov_b32 v2, 1
    buffer_atomic_add v2, off, s[16:19], 0 offset:16 sc1
    s_mov_b64 exec, -1
L_arr_16:
    s_load_dwordx2 s[12:13], s[0:1], 0
    s_mov_b32 s14, 2359296
    s_mov_b32 s15, 0x20000
    s_waitcnt lgkmcnt(0)
    s_lshl_b32 s60, s24, 5
    s_add_u32 s60, s60, s21
    s_add_u32 s60, s60, 24
    s_mul_i32 s61, s60, 36864
    s_mul_i32 s28, s20, 9216
    s_add_u32 s61, s61, s28
    v_lshrrev_b32 v140, 3, v0
    v_mul_u32_u24 v140, 1152, v140
    v_and_b32 v141, 7, v0
    v_lshl_add_u32 v140, v141, 4, v140
    buffer_load_dwordx4 v[16:19], v140, s[12:15], s61 offen offset:0
    buffer_load_dwordx4 v[20:23], v140, s[12:15], s61 offen offset:128
    buffer_load_dwordx4 v[24:27], v140, s[12:15], s61 offen offset:256
    buffer_load_dwordx4 v[28:31], v140, s[12:15], s61 offen offset:384
    buffer_load_dwordx4 v[32:35], v140, s[12:15], s61 offen offset:512
    buffer_load_dwordx4 v[36:39], v140, s[12:15], s61 offen offset:640
    buffer_load_dwordx4 v[40:43], v140, s[12:15], s61 offen offset:768
    buffer_load_dwordx4 v[44:47], v140, s[12:15], s61 offen offset:896
    buffer_load_dwordx4 v[48:51], v140, s[12:15], s61 offen offset:1024
    s_waitcnt vmcnt(8)
    v_lshlrev_b32 v64, 16, v16
    v_and_b32 v65, 0xffff0000, v16
    v_lshlrev_b32 v66, 16, v17
    v_and_b32 v67, 0xffff0000, v17
    v_lshlrev_b32 v68, 16, v18
    v_and_b32 v69, 0xffff0000, v18
    v_lshlrev_b32 v70, 16, v19
    v_and_b32 v71, 0xffff0000, v19
    s_waitcnt vmcnt(7)
    v_lshlrev_b32 v72, 16, v20
    v_and_b32 v73, 0xffff0000, v20
    v_lshlrev_b32 v74, 16, v21
    v_and_b32 v75, 0xffff0000, v21
    v_lshlrev_b32 v76, 16, v22
    v_and_b32 v77, 0xffff0000, v22
    v_lshlrev_b32 v78, 16, v23
    v_and_b32 v79, 0xffff0000, v23
    s_waitcnt vmcnt(6)
    v_lshlrev_b32 v80, 16, v24
    v_and_b32 v81, 0xffff0000, v24
    v_lshlrev_b32 v82, 16, v25
    v_and_b32 v83, 0xffff0000, v25
    v_lshlrev_b32 v84, 16, v26
    v_and_b32 v85, 0xffff0000, v26
    v_lshlrev_b32 v86, 16, v27
    v_and_b32 v87, 0xffff0000, v27
    s_waitcnt vmcnt(5)
    v_lshlrev_b32 v88, 16, v28
    v_and_b32 v89, 0xffff0000, v28
    v_lshlrev_b32 v90, 16, v29
    v_and_b32 v91, 0xffff0000, v29
    v_lshlrev_b32 v92, 16, v30
    v_and_b32 v93, 0xffff0000, v30
    v_lshlrev_b32 v94, 16, v31
    v_and_b32 v95, 0xffff0000, v31
    s_waitcnt vmcnt(4)
    v_lshlrev_b32 v96, 16, v32
    v_and_b32 v97, 0xffff0000, v32
    v_lshlrev_b32 v98, 16, v33
    v_and_b32 v99, 0xffff0000, v33
    v_lshlrev_b32 v100, 16, v34
    v_and_b32 v101, 0xffff0000, v34
    v_lshlrev_b32 v102, 16, v35
    v_and_b32 v103, 0xffff0000, v35
    s_waitcnt vmcnt(3)
    v_lshlrev_b32 v104, 16, v36
    v_and_b32 v105, 0xffff0000, v36
    v_lshlrev_b32 v106, 16, v37
    v_and_b32 v107, 0xffff0000, v37
    v_lshlrev_b32 v108, 16, v38
    v_and_b32 v109, 0xffff0000, v38
    v_lshlrev_b32 v110, 16, v39
    v_and_b32 v111, 0xffff0000, v39
    s_waitcnt vmcnt(2)
    v_lshlrev_b32 v112, 16, v40
    v_and_b32 v113, 0xffff0000, v40
    v_lshlrev_b32 v114, 16, v41
    v_and_b32 v115, 0xffff0000, v41
    v_lshlrev_b32 v116, 16, v42
    v_and_b32 v117, 0xffff0000, v42
    v_lshlrev_b32 v118, 16, v43
    v_and_b32 v119, 0xffff0000, v43
    s_waitcnt vmcnt(1)
    v_lshlrev_b32 v120, 16, v44
    v_and_b32 v121, 0xffff0000, v44
    v_lshlrev_b32 v122, 16, v45
    v_and_b32 v123, 0xffff0000, v45
    v_lshlrev_b32 v124, 16, v46
    v_and_b32 v125, 0xffff0000, v46
    v_lshlrev_b32 v126, 16, v47
    v_and_b32 v127, 0xffff0000, v47
    s_waitcnt vmcnt(0)
    v_lshlrev_b32 v128, 16, v48
    v_and_b32 v129, 0xffff0000, v48
    v_lshlrev_b32 v130, 16, v49
    v_and_b32 v131, 0xffff0000, v49
    v_lshlrev_b32 v132, 16, v50
    v_and_b32 v133, 0xffff0000, v50
    v_lshlrev_b32 v134, 16, v51
    v_and_b32 v135, 0xffff0000, v51
    v_add_f32 v142, v64, v65
    v_add_f32 v142, v142, v66
    v_add_f32 v142, v142, v67
    v_add_f32 v142, v142, v68
    v_add_f32 v142, v142, v69
    v_add_f32 v142, v142, v70
    v_add_f32 v142, v142, v71
    v_add_f32 v142, v142, v72
    v_add_f32 v142, v142, v73
    v_add_f32 v142, v142, v74
    v_add_f32 v142, v142, v75
    v_add_f32 v142, v142, v76
    v_add_f32 v142, v142, v77
    v_add_f32 v142, v142, v78
    v_add_f32 v142, v142, v79
    v_add_f32 v142, v142, v80
    v_add_f32 v142, v142, v81
    v_add_f32 v142, v142, v82
    v_add_f32 v142, v142, v83
    v_add_f32 v142, v142, v84
    v_add_f32 v142, v142, v85
    v_add_f32 v142, v142, v86
    v_add_f32 v142, v142, v87
    v_add_f32 v142, v142, v88
    v_add_f32 v142, v142, v89
    v_add_f32 v142, v142, v90
    v_add_f32 v142, v142, v91
    v_add_f32 v142, v142, v92
    v_add_f32 v142, v142, v93
    v_add_f32 v142, v142, v94
    v_add_f32 v142, v142, v95
    v_add_f32 v142, v142, v96
    v_add_f32 v142, v142, v97
    v_add_f32 v142, v142, v98
    v_add_f32 v142, v142, v99
    v_add_f32 v142, v142, v100
    v_add_f32 v142, v142, v101
    v_add_f32 v142, v142, v102
    v_add_f32 v142, v142, v103
    v_add_f32 v142, v142, v104
    v_add_f32 v142, v142, v105
    v_add_f32 v142, v142, v106
    v_add_f32 v142, v142, v107
    v_add_f32 v142, v142, v108
    v_add_f32 v142, v142, v109
    v_add_f32 v142, v142, v110
    v_add_f32 v142, v142, v111
    v_add_f32 v142, v142, v112
    v_add_f32 v142, v142, v113
    v_add_f32 v142, v142, v114
    v_add_f32 v142, v142, v115
    v_add_f32 v142, v142, v116
    v_add_f32 v142, v142, v117
    v_add_f32 v142, v142, v118
    v_add_f32 v142, v142, v119
    v_add_f32 v142, v142, v120
    v_add_f32 v142, v142, v121
    v_add_f32 v142, v142, v122
    v_add_f32 v142, v142, v123
    v_add_f32 v142, v142, v124
    v_add_f32 v142, v142, v125
    v_add_f32 v142, v142, v126
    v_add_f32 v142, v142, v127
    v_add_f32 v142, v142, v128
    v_add_f32 v142, v142, v129
    v_add_f32 v142, v142, v130
    v_add_f32 v142, v142, v131
    v_add_f32 v142, v142, v132
    v_add_f32 v142, v142, v133
    v_add_f32 v142, v142, v134
    v_add_f32 v142, v142, v135
    s_nop 1
    v_add_f32_dpp v142, v142, v142 quad_perm:[1,0,3,2] row_mask:0xf bank_mask:0xf
    s_nop 1
    v_add_f32_dpp v142, v142, v142 quad_perm:[2,3,0,1] row_mask:0xf bank_mask:0xf
    s_nop 1
    v_add_f32_dpp v142, v142, v142 row_half_mirror row_mask:0xf bank_mask:0xf
    v_mul_f32 v142, 0x3ae38e39, v142
    v_sub_f32 v64, v64, v142
    v_sub_f32 v65, v65, v142
    v_sub_f32 v66, v66, v142
    v_sub_f32 v67, v67, v142
    v_sub_f32 v68, v68, v142
    v_sub_f32 v69, v69, v142
    v_sub_f32 v70, v70, v142
    v_sub_f32 v71, v71, v142
    v_sub_f32 v72, v72, v142
    v_sub_f32 v73, v73, v142
    v_sub_f32 v74, v74, v142
    v_sub_f32 v75, v75, v142
    v_sub_f32 v76, v76, v142
    v_sub_f32 v77, v77, v142
    v_sub_f32 v78, v78, v142
    v_sub_f32 v79, v79, v142
    v_sub_f32 v80, v80, v142
    v_sub_f32 v81, v81, v142
    v_sub_f32 v82, v82, v142
    v_sub_f32 v83, v83, v142
    v_sub_f32 v84, v84, v142
    v_sub_f32 v85, v85, v142
    v_sub_f32 v86, v86, v142
    v_sub_f32 v87, v87, v142
    v_sub_f32 v88, v88, v142
    v_sub_f32 v89, v89, v142
    v_sub_f32 v90, v90, v142
    v_sub_f32 v91, v91, v142
    v_sub_f32 v92, v92, v142
    v_sub_f32 v93, v93, v142
    v_sub_f32 v94, v94, v142
    v_sub_f32 v95, v95, v142
    v_sub_f32 v96, v96, v142
    v_sub_f32 v97, v97, v142
    v_sub_f32 v98, v98, v142
    v_sub_f32 v99, v99, v142
    v_sub_f32 v100, v100, v142
    v_sub_f32 v101, v101, v142
    v_sub_f32 v102, v102, v142
    v_sub_f32 v103, v103, v142
    v_sub_f32 v104, v104, v142
    v_sub_f32 v105, v105, v142
    v_sub_f32 v106, v106, v142
    v_sub_f32 v107, v107, v142
    v_sub_f32 v108, v108, v142
    v_sub_f32 v109, v109, v142
    v_sub_f32 v110, v110, v142
    v_sub_f32 v111, v111, v142
    v_sub_f32 v112, v112, v142
    v_sub_f32 v113, v113, v142
    v_sub_f32 v114, v114, v142
    v_sub_f32 v115, v115, v142
    v_sub_f32 v116, v116, v142
    v_sub_f32 v117, v117, v142
    v_sub_f32 v118, v118, v142
    v_sub_f32 v119, v119, v142
    v_sub_f32 v120, v120, v142
    v_sub_f32 v121, v121, v142
    v_sub_f32 v122, v122, v142
    v_sub_f32 v123, v123, v142
    v_sub_f32 v124, v124, v142
    v_sub_f32 v125, v125, v142
    v_sub_f32 v126, v126, v142
    v_sub_f32 v127, v127, v142
    v_sub_f32 v128, v128, v142
    v_sub_f32 v129, v129, v142
    v_sub_f32 v130, v130, v142
    v_sub_f32 v131, v131, v142
    v_sub_f32 v132, v132, v142
    v_sub_f32 v133, v133, v142
    v_sub_f32 v134, v134, v142
    v_sub_f32 v135, v135, v142
    v_mul_f32 v143, v64, v64
    v_fmac_f32 v143, v65, v65
    v_fmac_f32 v143, v66, v66
    v_fmac_f32 v143, v67, v67
    v_fmac_f32 v143, v68, v68
    v_fmac_f32 v143, v69, v69
    v_fmac_f32 v143, v70, v70
    v_fmac_f32 v143, v71, v71
    v_fmac_f32 v143, v72, v72
    v_fmac_f32 v143, v73, v73
    v_fmac_f32 v143, v74, v74
    v_fmac_f32 v143, v75, v75
    v_fmac_f32 v143, v76, v76
    v_fmac_f32 v143, v77, v77
    v_fmac_f32 v143, v78, v78
    v_fmac_f32 v143, v79, v79
    v_fmac_f32 v143, v80, v80
    v_fmac_f32 v143, v81, v81
    v_fmac_f32 v143, v82, v82
    v_fmac_f32 v143, v83, v83
    v_fmac_f32 v143, v84, v84
    v_fmac_f32 v143, v85, v85
    v_fmac_f32 v143, v86, v86
    v_fmac_f32 v143, v87, v87
    v_fmac_f32 v143, v88, v88
    v_fmac_f32 v143, v89, v89
    v_fmac_f32 v143, v90, v90
    v_fmac_f32 v143, v91, v91
    v_fmac_f32 v143, v92, v92
    v_fmac_f32 v143, v93, v93
    v_fmac_f32 v143, v94, v94
    v_fmac_f32 v143, v95, v95
    v_fmac_f32 v143, v96, v96
    v_fmac_f32 v143, v97, v97
    v_fmac_f32 v143, v98, v98
    v_fmac_f32 v143, v99, v99
    v_fmac_f32 v143, v100, v100
    v_fmac_f32 v143, v101, v101
    v_fmac_f32 v143, v102, v102
    v_fmac_f32 v143, v103, v103
    v_fmac_f32 v143, v104, v104
    v_fmac_f32 v143, v105, v105
    v_fmac_f32 v143, v106, v106
    v_fmac_f32 v143, v107, v107
    v_fmac_f32 v143, v108, v108
    v_fmac_f32 v143, v109, v109
    v_fmac_f32 v143, v110, v110
    v_fmac_f32 v143, v111, v111
    v_fmac_f32 v143, v112, v112
    v_fmac_f32 v143, v113, v113
    v_fmac_f32 v143, v114, v114
    v_fmac_f32 v143, v115, v115
    v_fmac_f32 v143, v116, v116
    v_fmac_f32 v143, v117, v117
    v_fmac_f32 v143, v118, v118
    v_fmac_f32 v143, v119, v119
    v_fmac_f32 v143, v120, v120
    v_fmac_f32 v143, v121, v121
    v_fmac_f32 v143, v122, v122
    v_fmac_f32 v143, v123, v123
    v_fmac_f32 v143, v124, v124
    v_fmac_f32 v143, v125, v125
    v_fmac_f32 v143, v126, v126
    v_fmac_f32 v143, v127, v127
    v_fmac_f32 v143, v128, v128
    v_fmac_f32 v143, v129, v129
    v_fmac_f32 v143, v130, v130
    v_fmac_f32 v143, v131, v131
    v_fmac_f32 v143, v132, v132
    v_fmac_f32 v143, v133, v133
    v_fmac_f32 v143, v134, v134
    v_fmac_f32 v143, v135, v135
    s_nop 1
    v_add_f32_dpp v143, v143, v143 quad_perm:[1,0,3,2] row_mask:0xf bank_mask:0xf
    s_nop 1
    v_add_f32_dpp v143, v143, v143 quad_perm:[2,3,0,1] row_mask:0xf bank_mask:0xf
    s_nop 1
    v_add_f32_dpp v143, v143, v143 row_half_mirror row_mask:0xf bank_mask:0xf
    v_mov_b32 v142, 0x3727c5ac
    v_fmac_f32 v142, 0x3ae38e39, v143
    v_rsq_f32 v142, v142
    s_nop 0
    v_mul_f32 v64, v64, v142
    v_mul_f32 v65, v65, v142
    v_mul_f32 v66, v66, v142
    v_mul_f32 v67, v67, v142
    v_mul_f32 v68, v68, v142
    v_mul_f32 v69, v69, v142
    v_mul_f32 v70, v70, v142
    v_mul_f32 v71, v71, v142
    v_mul_f32 v72, v72, v142
    v_mul_f32 v73, v73, v142
    v_mul_f32 v74, v74, v142
    v_mul_f32 v75, v75, v142
    v_mul_f32 v76, v76, v142
    v_mul_f32 v77, v77, v142
    v_mul_f32 v78, v78, v142
    v_mul_f32 v79, v79, v142
    v_mul_f32 v80, v80, v142
    v_mul_f32 v81, v81, v142
    v_mul_f32 v82, v82, v142
    v_mul_f32 v83, v83, v142
    v_mul_f32 v84, v84, v142
    v_mul_f32 v85, v85, v142
    v_mul_f32 v86, v86, v142
    v_mul_f32 v87, v87, v142
    v_mul_f32 v88, v88, v142
    v_mul_f32 v89, v89, v142
    v_mul_f32 v90, v90, v142
    v_mul_f32 v91, v91, v142
    v_mul_f32 v92, v92, v142
    v_mul_f32 v93, v93, v142
    v_mul_f32 v94, v94, v142
    v_mul_f32 v95, v95, v142
    v_mul_f32 v96, v96, v142
    v_mul_f32 v97, v97, v142
    v_mul_f32 v98, v98, v142
    v_mul_f32 v99, v99, v142
    v_mul_f32 v100, v100, v142
    v_mul_f32 v101, v101, v142
    v_mul_f32 v102, v102, v142
    v_mul_f32 v103, v103, v142
    v_mul_f32 v104, v104, v142
    v_mul_f32 v105, v105, v142
    v_mul_f32 v106, v106, v142
    v_mul_f32 v107, v107, v142
    v_mul_f32 v108, v108, v142
    v_mul_f32 v109, v109, v142
    v_mul_f32 v110, v110, v142
    v_mul_f32 v111, v111, v142
    v_mul_f32 v112, v112, v142
    v_mul_f32 v113, v113, v142
    v_mul_f32 v114, v114, v142
    v_mul_f32 v115, v115, v142
    v_mul_f32 v116, v116, v142
    v_mul_f32 v117, v117, v142
    v_mul_f32 v118, v118, v142
    v_mul_f32 v119, v119, v142
    v_mul_f32 v120, v120, v142
    v_mul_f32 v121, v121, v142
    v_mul_f32 v122, v122, v142
    v_mul_f32 v123, v123, v142
    v_mul_f32 v124, v124, v142
    v_mul_f32 v125, v125, v142
    v_mul_f32 v126, v126, v142
    v_mul_f32 v127, v127, v142
    v_mul_f32 v128, v128, v142
    v_mul_f32 v129, v129, v142
    v_mul_f32 v130, v130, v142
    v_mul_f32 v131, v131, v142
    v_mul_f32 v132, v132, v142
    v_mul_f32 v133, v133, v142
    v_mul_f32 v134, v134, v142
    v_mul_f32 v135, v135, v142
    v_cvt_pk_bf16_f32 v16, v64, v65
    v_cvt_pk_bf16_f32 v17, v66, v67
    v_cvt_pk_bf16_f32 v18, v68, v69
    v_cvt_pk_bf16_f32 v19, v70, v71
    v_cvt_pk_bf16_f32 v20, v72, v73
    v_cvt_pk_bf16_f32 v21, v74, v75
    v_cvt_pk_bf16_f32 v22, v76, v77
    v_cvt_pk_bf16_f32 v23, v78, v79
    v_cvt_pk_bf16_f32 v24, v80, v81
    v_cvt_pk_bf16_f32 v25, v82, v83
    v_cvt_pk_bf16_f32 v26, v84, v85
    v_cvt_pk_bf16_f32 v27, v86, v87
    v_cvt_pk_bf16_f32 v28, v88, v89
    v_cvt_pk_bf16_f32 v29, v90, v91
    v_cvt_pk_bf16_f32 v30, v92, v93
    v_cvt_pk_bf16_f32 v31, v94, v95
    v_cvt_pk_bf16_f32 v32, v96, v97
    v_cvt_pk_bf16_f32 v33, v98, v99
    v_cvt_pk_bf16_f32 v34, v100, v101
    v_cvt_pk_bf16_f32 v35, v102, v103
    v_cvt_pk_bf16_f32 v36, v104, v105
    v_cvt_pk_bf16_f32 v37, v106, v107
    v_cvt_pk_bf16_f32 v38, v108, v109
    v_cvt_pk_bf16_f32 v39, v110, v111
    v_cvt_pk_bf16_f32 v40, v112, v113
    v_cvt_pk_bf16_f32 v41, v114, v115
    v_cvt_pk_bf16_f32 v42, v116, v117
    v_cvt_pk_bf16_f32 v43, v118, v119
    v_cvt_pk_bf16_f32 v44, v120, v121
    v_cvt_pk_bf16_f32 v45, v122, v123
    v_cvt_pk_bf16_f32 v46, v124, v125
    v_cvt_pk_bf16_f32 v47, v126, v127
    v_cvt_pk_bf16_f32 v48, v128, v129
    v_cvt_pk_bf16_f32 v49, v130, v131
    v_cvt_pk_bf16_f32 v50, v132, v133
    v_cvt_pk_bf16_f32 v51, v134, v135
    s_add_u32 s61, s61, 1048576
    buffer_store_dwordx4 v[16:19], v140, s[4:7], s61 offen offset:0 sc1
    buffer_store_dwordx4 v[20:23], v140, s[4:7], s61 offen offset:128 sc1
    buffer_store_dwordx4 v[24:27], v140, s[4:7], s61 offen offset:256 sc1
    buffer_store_dwordx4 v[28:31], v140, s[4:7], s61 offen offset:384 sc1
    buffer_store_dwordx4 v[32:35], v140, s[4:7], s61 offen offset:512 sc1
    buffer_store_dwordx4 v[36:39], v140, s[4:7], s61 offen offset:640 sc1
    buffer_store_dwordx4 v[40:43], v140, s[4:7], s61 offen offset:768 sc1
    buffer_store_dwordx4 v[44:47], v140, s[4:7], s61 offen offset:896 sc1
    buffer_store_dwordx4 v[48:51], v140, s[4:7], s61 offen offset:1024 sc1
    s_mov_b32 s23, 32768
    s_mov_b32 s29, 1
L_spin_17:
    s_sub_u32 s23, s23, 1
    s_cbranch_scc1 L_abort
    s_sleep 2
    s_sleep 4
    buffer_load_dword v141, off, s[16:19], 0 offset:16 sc1
    s_waitcnt vmcnt(0)
    v_cmp_gt_u32 vcc, 256, v141
    s_nop 3
    s_cbranch_vccnz L_spin_17
    v_and_b32 v140, 15, v0
    v_lshlrev_b32 v140, 9, v140
    s_lshl_b32 s61, s20, 13
    s_lshl_b32 s60, s60, 2
    s_add_u32 s61, s61, s60
    v_mov_b32 v141, 1
    s_mov_b64 exec, 0xffff
    buffer_store_dword v141, v140, s[4:7], s61 offen offset:0 sc1
    s_mov_b64 exec, -1
    s_lshl_b32 s45, s21, 2
    s_add_u32 s45, s45, s20
    s_mov_b32 s47, 0x3e0293ee
    v_and_b32 v40, 15, v0
    v_lshrrev_b32 v41, 4, v0
    v_lshlrev_b32 v41, 2, v41
    v_mov_b32 v42, 0xff800000
    v_add_u32 v43, 0, v41
    v_cmp_gt_u32 vcc, v43, v40
    s_nop 1
    v_cndmask_b32 v16, 0, v42, vcc
    v_add_u32 v43, 1, v41
    v_cmp_gt_u32 vcc, v43, v40
    s_nop 1
    v_cndmask_b32 v17, 0, v42, vcc
    v_add_u32 v43, 2, v41
    v_cmp_gt_u32 vcc, v43, v40
    s_nop 1
    v_cndmask_b32 v18, 0, v42, vcc
    v_add_u32 v43, 3, v41
    v_cmp_gt_u32 vcc, v43, v40
    s_nop 1
    v_cndmask_b32 v19, 0, v42, vcc
    v_cmp_lt_u32 vcc, 31, v0
    s_nop 1
    v_cndmask_b32 v20, 0, v42, vcc
    v_cndmask_b32 v21, 0, v42, vcc
    v_cndmask_b32 v22, 0, v42, vcc
    v_cndmask_b32 v23, 0, v42, vcc
    v_lshrrev_b32 v9, 0, v0
    v_and_b32 v9, 3, v9
    v_lshlrev_b32 v9, 9, v9
    v_lshrrev_b32 v40, 2, v0
    v_and_b32 v40, 1, v40
    v_lshl_or_b32 v9, v40, 16, v9
    s_lshl_b32 s28, s45, 11
    s_add_u32 s28, s28, 131076
    v_add_u32 v9, s28, v9
    s_lshl_b32 s36, s45, 9
    s_add_u32 s28, s36, 65536
    v_mov_b32 v40, s28
    v_cndmask_b32 v9, v9, v40, vcc
    v_lshrrev_b32 v12, 0, v0
    v_and_b32 v12, 7, v12
    v_lshlrev_b32 v12, 4, v12
    v_lshrrev_b32 v40, 4, v0
    v_and_b32 v40, 3, v40
    v_lshl_or_b32 v12, v40, 7, v12
    v_lshrrev_b32 v13, 0, v0
    v_and_b32 v13, 31, v13
    v_lshlrev_b32 v13, 4, v13
    v_lshlrev_b32 v0, 4, v0
    s_lshl_b32 s37, s24, 8
    s_add_u32 s36, s36, s37
    s_add_u32 s36, s36, 98300
    s_mov_b32 s54, 1073741824
    v_subrev_u32 v11, 4, v9
    s_mul_i32 s38, s24, 50331648
    s_mul_i32 s28, s45, 24576
    s_add_u32 s38, s38, s28
    s_add_u32 s38, s38, 134217728
    s_mul_i32 s48, s24, 8388608
    s_lshl_b32 s28, s45, 12
    s_add_u32 s48, s48, s28
    s_add_u32 s48, s48, 33554432
    s_mul_i32 s51, s24, 16777216
    s_add_u32 s51, s51, s28
    s_add_u32 s51, s51, 94371840
    s_mov_b32 s30, 0
    v_mov_b32 v230, 0
    v_mov_b32 v231, 0
    s_load_dwordx2 s[8:9], s[0:1], 104
    s_mov_b32 s10, 0
    s_mov_b32 s11, 0x20000
    s_waitcnt lgkmcnt(0)
    s_add_u32 s60, s38, 0
    s_add_u32 s61, s38, 4096
    s_add_u32 s62, s38, 8192
    s_add_u32 s63, s38, 12288
    s_add_u32 s64, s38, 16384
    s_add_u32 s65, s38, 20480
    s_mov_b32 s23, 32768
    s_mov_b32 s29, 13
L_spin_18:
    s_sub_u32 s23, s23, 1
    s_cbranch_scc1 L_abort
    s_sleep 2
    buffer_load_dword v10, v11, s[4:7], s37 offen sc1
    s_waitcnt vmcnt(0)
    v_cmp_eq_u32 vcc, 0, v10
    s_nop 0
    s_cmp_lg_u32 vcc_lo, 0
    s_cbranch_scc1 L_spin_18
    buffer_load_dwordx4 v[24:27], v0, s[4:7], s60 offen offset:0 sc1
    buffer_load_dwordx4 v[28:31], v0, s[4:7], s60 offen offset:1024 sc1
    buffer_load_dwordx4 v[32:35], v0, s[4:7], s60 offen offset:2048 sc1
    buffer_load_dwordx4 v[36:39], v0, s[4:7], s60 offen offset:3072 sc1
    buffer_load_dwordx4 v[40:43], v0, s[4:7], s61 offen offset:0 sc1
    buffer_load_dwordx4 v[44:47], v0, s[4:7], s61 offen offset:1024 sc1
    buffer_load_dwordx4 v[48:51], v0, s[4:7], s61 offen offset:2048 sc1
    buffer_load_dwordx4 v[52:55], v0, s[4:7], s61 offen offset:3072 sc1
    buffer_load_dwordx4 v[56:59], v0, s[4:7], s62 offen offset:0 sc1
    buffer_load_dwordx4 v[60:63], v0, s[4:7], s62 offen offset:1024 sc1
    buffer_load_dwordx4 v[64:67], v0, s[4:7], s62 offen offset:2048 sc1
    buffer_load_dwordx4 v[68:71], v0, s[4:7], s62 offen offset:3072 sc1
    buffer_load_dwordx4 v[72:75], v0, s[4:7], s63 offen offset:0 sc1
    buffer_load_dwordx4 v[76:79], v0, s[4:7], s63 offen offset:1024 sc1
    buffer_load_dwordx4 v[80:83], v0, s[4:7], s63 offen offset:2048 sc1
    buffer_load_dwordx4 v[84:87], v0, s[4:7], s63 offen offset:3072 sc1
    buffer_load_dwordx4 v[88:91], v0, s[4:7], s64 offen offset:0 sc1
    buffer_load_dwordx4 v[92:95], v0, s[4:7], s64 offen offset:1024 sc1
    buffer_load_dwordx4 v[96:99], v0, s[4:7], s64 offen offset:2048 sc1
    buffer_load_dwordx4 v[100:103], v0, s[4:7], s64 offen offset:3072 sc1
    buffer_load_dwordx4 v[104:107], v0, s[4:7], s65 offen offset:0 sc1
    buffer_load_dwordx4 v[108:111], v0, s[4:7], s65 offen offset:1024 sc1
    buffer_load_dwordx4 v[112:115], v0, s[4:7], s65 offen offset:2048 sc1
    buffer_load_dwordx4 v[116:119], v0, s[4:7], s65 offen offset:3072 sc1
    s_waitcnt vmcnt(0)
    buffer_load_dword v10, v9, s[4:7], s37 offen offset:0 sc1
    s_waitcnt vmcnt(0)
L_atn_e:
    v_cmp_eq_u32 s[52:53], 0, v10
    s_add_u32 s38, s38, 786432
    s_add_u32 s60, s38, 0
    s_add_u32 s61, s38, 4096
    s_add_u32 s62, s38, 8192
    s_add_u32 s63, s38, 12288
    s_add_u32 s64, s38, 16384
    s_add_u32 s65, s38, 20480
    s_cmp_eq_u32 s52, 0
    s_cselect_b32 s10, s6, 0
    s_cmp_eq_u32 s30, 63
    s_cselect_b32 s10, 0, s10
    s_cmp_lg_u32 s53, 0
    s_cbranch_scc1 L_atn_ea
    buffer_load_dwordx4 v[184:187], v12, s[4:7], s48 offen offset:0 sc1
    buffer_load_dwordx4 v[188:191], v12, s[4:7], s48 offen offset:512 sc1
    buffer_load_dwordx4 v[192:195], v12, s[4:7], s48 offen offset:1024 sc1
    buffer_load_dwordx4 v[196:199], v12, s[4:7], s48 offen offset:1536 sc1
    buffer_load_dwordx4 v[200:203], v13, s[4:7], s48 offen offset:2048 sc1
    buffer_load_dwordx4 v[204:207], v13, s[4:7], s48 offen offset:2560 sc1
    buffer_load_dwordx4 v[208:211], v13, s[4:7], s48 offen offset:3072 sc1
    buffer_load_dwordx4 v[212:215], v13, s[4:7], s48 offen offset:3584 sc1
L_atn_ea:
    v_mfma_f32_16x16x32_bf16 v[216:219], v[56:59], v[24:27], v[16:19]
    v_mfma_f32_16x16x32_bf16 v[220:223], v[56:59], v[28:31], 0
    v_mfma_f32_16x16x32_bf16 v[224:227], v[60:63], v[28:31], v[16:19]
    v_mfma_f32_16x16x32_bf16 v[216:219], v[64:67], v[32:35], v[216:219]
    buffer_load_dwordx4 a[0:3], v0, s[8:11], s60 offen offset:0 sc1
    v_mfma_f32_16x16x32_bf16 v[220:223], v[64:67], v[36:39], v[220:223]
    v_mfma_f32_16x16x32_bf16 v[224:227], v[68:71], v[36:39], v[224:227]
    v_mfma_f32_16x16x32_bf16 v[216:219], v[72:75], v[40:43], v[216:219]
    v_mfma_f32_16x16x32_bf16 v[220:223], v[72:75], v[44:47], v[220:223]
    buffer_load_dwordx4 a[4:7], v0, s[8:11], s60 offen offset:1024 sc1
    v_mfma_f32_16x16x32_bf16 v[224:227], v[76:79], v[44:47], v[224:227]
    v_mfma_f32_16x16x32_bf16 v[216:219], v[80:83], v[48:51], v[216:219]
    v_mfma_f32_16x16x32_bf16 v[220:223], v[80:83], v[52:55], v[220:223]
    v_mfma_f32_16x16x32_bf16 v[224:227], v[84:87], v[52:55], v[224:227]
    buffer_load_dwordx4 a[8:11], v0, s[8:11], s60 offen offset:2048 sc1
    s_nop 4
    v_max3_f32 v240, v216, v217, v218
    v_max3_f32 v241, v220, v221, v222
    v_max_f32 v240, v219, v240
    v_max3_f32 v241, v223, v224, v241
    v_max3_f32 v241, v225, v226, v241
    v_max_f32 v241, v227, v241
    v_mov_b32 v246, v240
    v_mov_b32 v247, v241
    s_nop 0
    v_permlane16_swap_b32 v240, v246
    v_permlane16_swap_b32 v241, v247
    v_max_f32 v240, v240, v246
    v_max_f32 v241, v241, v247
    v_mov_b32 v246, v240
    v_mov_b32 v247, v241
    s_nop 0
    v_permlane32_swap_b32 v240, v246
    v_permlane32_swap_b32 v241, v247
    buffer_load_dwordx4 a[12:15], v0, s[8:11], s60 offen offset:3072 sc1
    v_max_f32 v240, v240, v246
    v_max_f32 v241, v241, v247
    v_mul_f32 v240, s47, v240
    v_mul_f32 v241, s47, v241
    v_fma_f32 v216, v216, s47, -v240
    v_fma_f32 v217, v217, s47, -v240
    v_fma_f32 v218, v218, s47, -v240
    v_fma_f32 v219, v219, s47, -v240
    v_fma_f32 v220, v220, s47, -v241
    v_fma_f32 v221, v221, s47, -v241
    v_fma_f32 v222, v222, s47, -v241
    v_fma_f32 v223, v223, s47, -v241
    v_fma_f32 v224, v224, s47, -v241
    v_fma_f32 v225, v225, s47, -v241
    v_fma_f32 v226, v226, s47, -v241
    v_fma_f32 v227, v227, s47, -v241
    buffer_load_dwordx4 a[16:19], v0, s[8:11], s61 offen offset:0 sc1
    v_exp_f32 v216, v216
    v_exp_f32 v217, v217
    v_exp_f32 v218, v218
    v_exp_f32 v219, v219
    v_exp_f32 v220, v220
    v_exp_f32 v221, v221
    v_exp_f32 v222, v222
    v_exp_f32 v223, v223
    v_exp_f32 v224, v224
    v_exp_f32 v225, v225
    v_exp_f32 v226, v226
    v_exp_f32 v227, v227
    v_cvt_pk_bf16_f32 v228, v216, v217
    v_cvt_pk_bf16_f32 v229, v218, v219
    v_cvt_pk_bf16_f32 v232, v220, v221
    v_cvt_pk_bf16_f32 v233, v222, v223
    buffer_load_dwordx4 a[20:23], v0, s[8:11], s61 offen offset:1024 sc1
    v_cvt_pk_bf16_f32 v234, v224, v225
    v_cvt_pk_bf16_f32 v235, v226, v227
    s_waitcnt vmcnt(10)
    s_or_b32 s28, s36, s54
    s_mov_b64 exec, 1
    buffer_store_dword v9, off, s[4:7], s28 sc1
    s_mov_b64 exec, -1
    s_add_u32 s36, s36, 4
    v_mfma_f32_16x16x32_bf16 v[120:123], v[88:91], v[228:231], 0
    v_add_f32 v242, v216, v217
    v_mfma_f32_16x16x32_bf16 v[152:155], v[88:91], v[232:235], 0
    v_add_f32 v243, v220, v221
    v_mfma_f32_16x16x32_bf16 v[124:127], v[92:95], v[228:231], 0
    v_add_f32 v242, v242, v218
    v_mfma_f32_16x16x32_bf16 v[156:159], v[92:95], v[232:235], 0
    v_add_f32 v242, v242, v219
    buffer_load_dwordx4 a[24:27], v0, s[8:11], s61 offen offset:2048 sc1
    v_mfma_f32_16x16x32_bf16 v[128:131], v[96:99], v[228:231], 0
    v_add_f32 v243, v243, v222
    v_mfma_f32_16x16x32_bf16 v[160:163], v[96:99], v[232:235], 0
    v_add_f32 v243, v243, v223
    v_mfma_f32_16x16x32_bf16 v[132:135], v[100:103], v[228:231], 0
    v_add_f32 v243, v243, v224
    v_mfma_f32_16x16x32_bf16 v[164:167], v[100:103], v[232:235], 0
    v_add_f32 v243, v243, v225
    buffer_load_dwordx4 a[28:31], v0, s[8:11], s61 offen offset:3072 sc1
    s_waitcnt vmcnt(12)
    v_mfma_f32_16x16x32_bf16 v[136:139], v[104:107], v[228:231], 0
    v_add_f32 v243, v243, v226
    v_mfma_f32_16x16x32_bf16 v[168:171], v[104:107], v[232:235], 0
    v_add_f32 v243, v243, v227
    s_waitcnt vmcnt(11)
    v_mfma_f32_16x16x32_bf16 v[140:143], v[108:111], v[228:231], 0
    v_mfma_f32_16x16x32_bf16 v[172:175], v[108:111], v[232:235], 0
    s_waitcnt vmcnt(10)
    v_mfma_f32_16x16x32_bf16 v[144:147], v[112:115], v[228:231], 0
    v_mfma_f32_16x16x32_bf16 v[176:179], v[112:115], v[232:235], 0
    buffer_load_dwordx4 a[32:35], v0, s[8:11], s62 offen offset:0 sc1
    s_waitcnt vmcnt(10)
    v_mfma_f32_16x16x32_bf16 v[148:151], v[116:119], v[228:231], 0
    v_mfma_f32_16x16x32_bf16 v[180:183], v[116:119], v[232:235], 0
    s_cmp_eq_u32 s53, 0
    s_cbranch_scc1 L_atn_eb
    s_mov_b32 s23, 32768
    s_mov_b32 s29, 14
L_spin_19:
    s_sub_u32 s23, s23, 1
    s_nop 1
    s_cbranch_scc1 L_abort
    s_sleep 2
    buffer_load_dword v10, v9, s[4:7], s37 offen offset:0 sc1
    s_waitcnt vmcnt(0)
    v_cmp_eq_u32 vcc, 0, v10
    s_nop 0
    s_cmp_lg_u32 vcc_hi, 0
    s_cbranch_scc1 L_spin_19
    buffer_load_dwordx4 v[184:187], v12, s[4:7], s48 offen offset:0 sc1
    buffer_load_dwordx4 v[188:191], v12, s[4:7], s48 offen offset:512 sc1
    buffer_load_dwordx4 v[192:195], v12, s[4:7], s48 offen offset:1024 sc1
    buffer_load_dwordx4 v[196:199], v12, s[4:7], s48 offen offset:1536 sc1
    buffer_load_dwordx4 v[200:203], v13, s[4:7], s48 offen offset:2048 sc1
    buffer_load_dwordx4 v[204:207], v13, s[4:7], s48 offen offset:2560 sc1
    buffer_load_dwordx4 v[208:211], v13, s[4:7], s48 offen offset:3072 sc1
    buffer_load_dwordx4 v[212:215], v13, s[4:7], s48 offen offset:3584 sc1
L_atn_eb:
    buffer_load_dwordx4 a[36:39], v0, s[8:11], s62 offen offset:1024 sc1
    buffer_load_dwordx4 a[40:43], v0, s[8:11], s62 offen offset:2048 sc1
    buffer_load_dwordx4 a[44:47], v0, s[8:11], s62 offen offset:3072 sc1
    buffer_load_dwordx4 a[48:51], v0, s[8:11], s63 offen offset:0 sc1
    buffer_load_dwordx4 a[52:55], v0, s[8:11], s63 offen offset:1024 sc1
    buffer_load_dwordx4 a[56:59], v0, s[8:11], s63 offen offset:2048 sc1
    s_add_u32 s48, s48, 131072
    s_add_u32 s66, s51, 131072
    s_waitcnt vmcnt(13)
    v_mfma_f32_16x16x32_bf16 v[216:219], v[184:187], v[24:27], v[20:23]
    v_mfma_f32_16x16x32_bf16 v[220:223], v[184:187], v[28:31], v[20:23]
    s_waitcnt vmcnt(12)
    v_mfma_f32_16x16x32_bf16 v[216:219], v[188:191], v[32:35], v[216:219]
    v_mfma_f32_16x16x32_bf16 v[220:223], v[188:191], v[36:39], v[220:223]
    s_waitcnt vmcnt(11)
    v_mfma_f32_16x16x32_bf16 v[216:219], v[192:195], v[40:43], v[216:219]
    v_mfma_f32_16x16x32_bf16 v[220:223], v[192:195], v[44:47], v[220:223]
    s_waitcnt vmcnt(10)
    v_mfma_f32_16x16x32_bf16 v[216:219], v[196:199], v[48:51], v[216:219]
    v_mfma_f32_16x16x32_bf16 v[220:223], v[196:199], v[52:55], v[220:223]
    buffer_load_dword v10, v9, s[4:7], s37 offen offset:4 sc1
    s_nop 5
    v_max3_f32 v244, v216, v217, v218
    v_max3_f32 v245, v220, v221, v222
    v_max_f32 v244, v219, v244
    v_max_f32 v245, v223, v245
    v_mov_b32 v246, v244
    v_mov_b32 v247, v245
    s_nop 0
    v_permlane16_swap_b32 v244, v246
    v_permlane16_swap_b32 v245, v247
    v_max_f32 v244, v244, v246
    v_max_f32 v245, v245, v247
    v_mov_b32 v246, v244
    v_mov_b32 v247, v245
    s_nop 0
    v_permlane32_swap_b32 v244, v246
    v_permlane32_swap_b32 v245, v247
    v_max_f32 v244, v244, v246
    v_max_f32 v245, v245, v247
    v_mul_f32 v244, s47, v244
    v_mul_f32 v245, s47, v245
    buffer_load_dwordx4 a[60:63], v0, s[8:11], s63 offen offset:3072 sc1
    v_max_f32 v244, v244, v240
    v_max_f32 v245, v245, v241
    v_sub_f32 v248, v240, v244
    v_sub_f32 v250, v241, v245
    v_fma_f32 v216, v216, s47, -v244
    v_fma_f32 v220, v220, s47, -v245
    v_fma_f32 v217, v217, s47, -v244
    v_fma_f32 v221, v221, s47, -v245
    v_fma_f32 v218, v218, s47, -v244
    v_fma_f32 v222, v222, s47, -v245
    v_fma_f32 v219, v219, s47, -v244
    v_fma_f32 v223, v223, s47, -v245
    v_exp_f32 v248, v248
    v_exp_f32 v250, v250
    v_exp_f32 v216, v216
    v_exp_f32 v220, v220
    v_exp_f32 v217, v217
    v_exp_f32 v221, v221
    buffer_load_dwordx4 a[64:67], v0, s[8:11], s64 offen offset:0 sc1
    v_exp_f32 v218, v218
    v_exp_f32 v222, v222
    v_exp_f32 v219, v219
    v_exp_f32 v223, v223
    v_fma_f32 v244, v242, v248, v216
    v_fma_f32 v245, v243, v250, v220
    v_add_f32 v246, v217, v218
    v_add_f32 v247, v221, v222
    v_add_f32 v244, v244, v219
    v_add_f32 v245, v245, v223
    v_add_f32 v244, v244, v246
    v_add_f32 v245, v245, v247
    v_mov_b32 v246, v244
    v_mov_b32 v247, v245
    s_nop 0
    v_permlane16_swap_b32 v244, v246
    v_permlane16_swap_b32 v245, v247
    v_add_f32 v244, v244, v246
    v_add_f32 v245, v245, v247
    buffer_load_dwordx4 a[68:71], v0, s[8:11], s64 offen offset:1024 sc1
    v_mov_b32 v246, v244
    v_mov_b32 v247, v245
    s_nop 0
    v_permlane32_swap_b32 v244, v246
    v_permlane32_swap_b32 v245, v247
    v_add_f32 v244, v244, v246
    v_add_f32 v245, v245, v247
    v_rcp_f32 v244, v244
    v_rcp_f32 v245, v245
    v_mul_f32 v248, v244, v248
    v_mul_f32 v250, v245, v250
    v_mul_f32 v216, v244, v216
    v_mul_f32 v220, v245, v220
    v_mul_f32 v217, v244, v217
    v_mul_f32 v221, v245, v221
    v_mul_f32 v218, v244, v218
    v_mul_f32 v222, v245, v222
    v_mul_f32 v219, v244, v219
    v_mul_f32 v223, v245, v223
    buffer_load_dwordx4 a[72:75], v0, s[8:11], s64 offen offset:2048 sc1
    v_cvt_pk_bf16_f32 v224, v216, v217
    v_cvt_pk_bf16_f32 v226, v220, v221
    v_cvt_pk_bf16_f32 v225, v218, v219
    v_cvt_pk_bf16_f32 v227, v222, v223
    v_pk_mul_f32 v[120:121], v[120:121], v[248:249] op_sel_hi:[1,0]
    v_pk_mul_f32 v[122:123], v[122:123], v[248:249] op_sel_hi:[1,0]
    v_pk_mul_f32 v[124:125], v[124:125], v[248:249] op_sel_hi:[1,0]
    v_pk_mul_f32 v[126:127], v[126:127], v[248:249] op_sel_hi:[1,0]
    v_pk_mul_f32 v[128:129], v[128:129], v[248:249] op_sel_hi:[1,0]
    v_pk_mul_f32 v[130:131], v[130:131], v[248:249] op_sel_hi:[1,0]
    v_pk_mul_f32 v[132:133], v[132:133], v[248:249] op_sel_hi:[1,0]
    v_pk_mul_f32 v[134:135], v[134:135], v[248:249] op_sel_hi:[1,0]
    v_pk_mul_f32 v[136:137], v[136:137], v[248:249] op_sel_hi:[1,0]
    v_pk_mul_f32 v[138:139], v[138:139], v[248:249] op_sel_hi:[1,0]
    v_pk_mul_f32 v[140:141], v[140:141], v[248:249] op_sel_hi:[1,0]
    v_pk_mul_f32 v[142:143], v[142:143], v[248:249] op_sel_hi:[1,0]
    v_pk_mul_f32 v[144:145], v[144:145], v[248:249] op_sel_hi:[1,0]
    v_pk_mul_f32 v[146:147], v[146:147], v[248:249] op_sel_hi:[1,0]
    v_pk_mul_f32 v[148:149], v[148:149], v[248:249] op_sel_hi:[1,0]
    v_pk_mul_f32 v[150:151], v[150:151], v[248:249] op_sel_hi:[1,0]
    v_pk_mul_f32 v[152:153], v[152:153], v[250:251] op_sel_hi:[1,0]
    v_pk_mul_f32 v[154:155], v[154:155], v[250:251] op_sel_hi:[1,0]
    v_pk_mul_f32 v[156:157], v[156:157], v[250:251] op_sel_hi:[1,0]
    v_pk_mul_f32 v[158:159], v[158:159], v[250:251] op_sel_hi:[1,0]
    buffer_load_dwordx4 a[76:79], v0, s[8:11], s64 offen offset:3072 sc1
    v_pk_mul_f32 v[160:161], v[160:161], v[250:251] op_sel_hi:[1,0]
    v_pk_mul_f32 v[162:163], v[162:163], v[250:251] op_sel_hi:[1,0]
    v_pk_mul_f32 v[164:165], v[164:165], v[250:251] op_sel_hi:[1,0]
    v_pk_mul_f32 v[166:167], v[166:167], v[250:251] op_sel_hi:[1,0]
    v_pk_mul_f32 v[168:169], v[168:169], v[250:251] op_sel_hi:[1,0]
    v_pk_mul_f32 v[170:171], v[170:171], v[250:251] op_sel_hi:[1,0]
    v_pk_mul_f32 v[172:173], v[172:173], v[250:251] op_sel_hi:[1,0]
    v_pk_mul_f32 v[174:175], v[174:175], v[250:251] op_sel_hi:[1,0]
    v_pk_mul_f32 v[176:177], v[176:177], v[250:251] op_sel_hi:[1,0]
    v_pk_mul_f32 v[178:179], v[178:179], v[250:251] op_sel_hi:[1,0]
    v_pk_mul_f32 v[180:181], v[180:181], v[250:251] op_sel_hi:[1,0]
    v_pk_mul_f32 v[182:183], v[182:183], v[250:251] op_sel_hi:[1,0]
    s_waitcnt vmcnt(15)
    v_mfma_f32_16x16x16_bf16 v[120:123], v[200:201], v[224:225], v[120:123]
    v_mfma_f32_16x16x16_bf16 v[124:127], v[202:203], v[224:225], v[124:127]
    s_waitcnt vmcnt(14)
    v_mfma_f32_16x16x16_bf16 v[128:131], v[204:205], v[224:225], v[128:131]
    v_mfma_f32_16x16x16_bf16 v[132:135], v[206:207], v[224:225], v[132:135]
    s_waitcnt vmcnt(13)
    v_mfma_f32_16x16x16_bf16 v[136:139], v[208:209], v[224:225], v[136:139]
    s_nop 1
    v_cvt_pk_bf16_f32 v120, v120, v121
    v_mfma_f32_16x16x16_bf16 v[140:143], v[210:211], v[224:225], v[140:143]
    v_cvt_pk_bf16_f32 v121, v122, v123
    v_cvt_pk_bf16_f32 v122, v124, v125
    v_cvt_pk_bf16_f32 v123, v126, v127
    s_waitcnt vmcnt(12)
    v_mfma_f32_16x16x16_bf16 v[144:147], v[212:213], v[224:225], v[144:147]
    buffer_store_dwordx4 v[120:123], v0, s[4:7], s51 offen offset:0 sc1
    v_mfma_f32_16x16x16_bf16 v[148:151], v[214:215], v[224:225], v[148:151]
    v_cvt_pk_bf16_f32 v128, v128, v129
    v_cvt_pk_bf16_f32 v129, v130, v131
    v_cvt_pk_bf16_f32 v130, v132, v133
    v_mfma_f32_16x16x16_bf16 v[152:155], v[200:201], v[226:227], v[152:155]
    v_cvt_pk_bf16_f32 v131, v134, v135
    buffer_store_dwordx4 v[128:131], v0, s[4:7], s51 offen offset:1024 sc1
    v_mfma_f32_16x16x16_bf16 v[156:159], v[202:203], v[226:227], v[156:159]
    v_cvt_pk_bf16_f32 v136, v136, v137
    v_cvt_pk_bf16_f32 v137, v138, v139
    v_cvt_pk_bf16_f32 v138, v140, v141
    v_mfma_f32_16x16x16_bf16 v[160:163], v[204:205], v[226:227], v[160:163]
    v_cvt_pk_bf16_f32 v139, v142, v143
    buffer_store_dwordx4 v[136:139], v0, s[4:7], s51 offen offset:2048 sc1
    v_mfma_f32_16x16x16_bf16 v[164:167], v[206:207], v[226:227], v[164:167]
    v_cvt_pk_bf16_f32 v144, v144, v145
    v_cvt_pk_bf16_f32 v145, v146, v147
    v_cvt_pk_bf16_f32 v146, v148, v149
    v_mfma_f32_16x16x16_bf16 v[168:171], v[208:209], v[226:227], v[168:171]
    v_cvt_pk_bf16_f32 v147, v150, v151
    buffer_store_dwordx4 v[144:147], v0, s[4:7], s51 offen offset:3072 sc1
    v_mfma_f32_16x16x16_bf16 v[172:175], v[210:211], v[226:227], v[172:175]
    v_cvt_pk_bf16_f32 v152, v152, v153
    v_cvt_pk_bf16_f32 v153, v154, v155
    v_cvt_pk_bf16_f32 v154, v156, v157
    v_mfma_f32_16x16x16_bf16 v[176:179], v[212:213], v[226:227], v[176:179]
    v_cvt_pk_bf16_f32 v155, v158, v159
    buffer_store_dwordx4 v[152:155], v0, s[4:7], s66 offen offset:0 sc1
    v_mfma_f32_16x16x16_bf16 v[180:183], v[214:215], v[226:227], v[180:183]
    v_cvt_pk_bf16_f32 v160, v160, v161
    v_cvt_pk_bf16_f32 v161, v162, v163
    v_cvt_pk_bf16_f32 v162, v164, v165
    v_cvt_pk_bf16_f32 v163, v166, v167
    buffer_store_dwordx4 v[160:163], v0, s[4:7], s66 offen offset:1024 sc1
    v_cvt_pk_bf16_f32 v168, v168, v169
    v_cvt_pk_bf16_f32 v169, v170, v171
    v_cvt_pk_bf16_f32 v170, v172, v173
    v_cvt_pk_bf16_f32 v171, v174, v175
    buffer_store_dwordx4 v[168:171], v0, s[4:7], s66 offen offset:2048 sc1
    v_cvt_pk_bf16_f32 v176, v176, v177
    v_cvt_pk_bf16_f32 v177, v178, v179
    v_cvt_pk_bf16_f32 v178, v180, v181
    v_cvt_pk_bf16_f32 v179, v182, v183
    buffer_store_dwordx4 v[176:179], v0, s[4:7], s66 offen offset:3072 sc1
    s_waitcnt vmcnt(8)
    buffer_load_dwordx4 a[80:83], v0, s[8:11], s65 offen offset:0 sc1
    buffer_load_dwordx4 a[84:87], v0, s[8:11], s65 offen offset:1024 sc1
    buffer_load_dwordx4 a[88:91], v0, s[8:11], s65 offen offset:2048 sc1
    buffer_load_dwordx4 a[92:95], v0, s[8:11], s65 offen offset:3072 sc1
    s_add_u32 s51, s51, 262144
    s_mov_b32 s54, 0
    s_add_u32 s30, s30, 1
    s_cmp_lg_u32 s10, 0
    s_cbranch_scc1 L_atn_ec
    s_waitcnt vmcnt(0)
    s_mov_b64 exec, 1
    buffer_store_dword v9, off, s[4:7], s36 sc1
    s_mov_b64 exec, -1
    s_mov_b32 s54, 1073741824
    s_cmp_eq_u32 s30, 64
    s_cbranch_scc1 L_atn_done
    s_mov_b32 s23, 32768
    s_mov_b32 s29, 15
L_spin_20:
    s_sub_u32 s23, s23, 1
    s_cbranch_scc1 L_abort
    s_sleep 2
    buffer_load_dword v10, v9, s[4:7], s37 offen sc1
    s_waitcnt vmcnt(0)
    v_cmp_eq_u32 vcc, 0, v10
    s_nop 0
    s_cmp_lg_u32 vcc_lo, 0
    s_cbranch_scc1 L_spin_20
    buffer_load_dwordx4 a[0:3], v0, s[4:7], s60 offen offset:0 sc1
    buffer_load_dwordx4 a[4:7], v0, s[4:7], s60 offen offset:1024 sc1
    buffer_load_dwordx4 a[8:11], v0, s[4:7], s60 offen offset:2048 sc1
    buffer_load_dwordx4 a[12:15], v0, s[4:7], s60 offen offset:3072 sc1
    buffer_load_dwordx4 a[16:19], v0, s[4:7], s61 offen offset:0 sc1
    buffer_load_dwordx4 a[20:23], v0, s[4:7], s61 offen offset:1024 sc1
    buffer_load_dwordx4 a[24:27], v0, s[4:7], s61 offen offset:2048 sc1
    buffer_load_dwordx4 a[28:31], v0, s[4:7], s61 offen offset:3072 sc1
    buffer_load_dwordx4 a[32:35], v0, s[4:7], s62 offen offset:0 sc1
    buffer_load_dwordx4 a[36:39], v0, s[4:7], s62 offen offset:1024 sc1
    buffer_load_dwordx4 a[40:43], v0, s[4:7], s62 offen offset:2048 sc1
    buffer_load_dwordx4 a[44:47], v0, s[4:7], s62 offen offset:3072 sc1
    buffer_load_dwordx4 a[48:51], v0, s[4:7], s63 offen offset:0 sc1
    buffer_load_dwordx4 a[52:55], v0, s[4:7], s63 offen offset:1024 sc1
    buffer_load_dwordx4 a[56:59], v0, s[4:7], s63 offen offset:2048 sc1
    buffer_load_dwordx4 a[60:63], v0, s[4:7], s63 offen offset:3072 sc1
    buffer_load_dwordx4 a[64:67], v0, s[4:7], s64 offen offset:0 sc1
    buffer_load_dwordx4 a[68:71], v0, s[4:7], s64 offen offset:1024 sc1
    buffer_load_dwordx4 a[72:75], v0, s[4:7], s64 offen offset:2048 sc1
    buffer_load_dwordx4 a[76:79], v0, s[4:7], s64 offen offset:3072 sc1
    buffer_load_dwordx4 a[80:83], v0, s[4:7], s65 offen offset:0 sc1
    buffer_load_dwordx4 a[84:87], v0, s[4:7], s65 offen offset:1024 sc1
    buffer_load_dwordx4 a[88:91], v0, s[4:7], s65 offen offset:2048 sc1
    buffer_load_dwordx4 a[92:95], v0, s[4:7], s65 offen offset:3072 sc1
    s_waitcnt vmcnt(0)
    buffer_load_dword v10, v9, s[4:7], s37 offen offset:4 sc1
    s_waitcnt vmcnt(0)
L_atn_ec:
    s_add_u32 s37, s37, 4
L_atn_o:
    v_cmp_eq_u32 s[52:53], 0, v10
    s_add_u32 s38, s38, 786432
    s_add_u32 s60, s38, 0
    s_add_u32 s61, s38, 4096
    s_add_u32 s62, s38, 8192
    s_add_u32 s63, s38, 12288
    s_add_u32 s64, s38, 16384
    s_add_u32 s65, s38, 20480
    s_cmp_eq_u32 s52, 0
    s_cselect_b32 s10, s6, 0
    s_cmp_eq_u32 s30, 63
    s_cselect_b32 s10, 0, s10
    s_cmp_lg_u32 s53, 0
    s_cbranch_scc1 L_atn_oa
    buffer_load_dwordx4 v[184:187], v12, s[4:7], s48 offen offset:0 sc1
    buffer_load_dwordx4 v[188:191], v12, s[4:7], s48 offen offset:512 sc1
    buffer_load_dwordx4 v[192:195], v12, s[4:7], s48 offen offset:1024 sc1
    buffer_load_dwordx4 v[196:199], v12, s[4:7], s48 offen offset:1536 sc1
    buffer_load_dwordx4 v[200:203], v13, s[4:7], s48 offen offset:2048 sc1
    buffer_load_dwordx4 v[204:207], v13, s[4:7], s48 offen offset:2560 sc1
    buffer_load_dwordx4 v[208:211], v13, s[4:7], s48 offen offset:3072 sc1
    buffer_load_dwordx4 v[212:215], v13, s[4:7], s48 offen offset:3584 sc1
L_atn_oa:
    v_mfma_f32_16x16x32_bf16 v[216:219], a[32:35], a[0:3], v[16:19]
    v_mfma_f32_16x16x32_bf16 v[220:223], a[32:35], a[4:7], 0
    v_mfma_f32_16x16x32_bf16 v[224:227], a[36:39], a[4:7], v[16:19]
    v_mfma_f32_16x16x32_bf16 v[216:219], a[40:43], a[8:11], v[216:219]
    buffer_load_dwordx4 v[24:27], v0, s[8:11], s60 offen offset:0 sc1
    v_mfma_f32_16x16x32_bf16 v[220:223], a[40:43], a[12:15], v[220:223]
    v_mfma_f32_16x16x32_bf16 v[224:227], a[44:47], a[12:15], v[224:227]
    v_mfma_f32_16x16x32_bf16 v[216:219], a[48:51], a[16:19], v[216:219]
    v_mfma_f32_16x16x32_bf16 v[220:223], a[48:51], a[20:23], v[220:223]
    buffer_load_dwordx4 v[28:31], v0, s[8:11], s60 offen offset:1024 sc1
    v_mfma_f32_16x16x32_bf16 v[224:227], a[52:55], a[20:23], v[224:227]
    v_mfma_f32_16x16x32_bf16 v[216:219], a[56:59], a[24:27], v[216:219]
    v_mfma_f32_16x16x32_bf16 v[220:223], a[56:59], a[28:31], v[220:223]
    v_mfma_f32_16x16x32_bf16 v[224:227], a[60:63], a[28:31], v[224:227]
    buffer_load_dwordx4 v[32:35], v0, s[8:11], s60 offen offset:2048 sc1
    s_nop 4
    v_max3_f32 v240, v216, v217, v218
    v_max3_f32 v241, v220, v221, v222
    v_max_f32 v240, v219, v240
    v_max3_f32 v241, v223, v224, v241
    v_max3_f32 v241, v225, v226, v241
    v_max_f32 v241, v227, v241
    v_mov_b32 v246, v240
    v_mov_b32 v247, v241
    s_nop 0
    v_permlane16_swap_b32 v240, v246
    v_permlane16_swap_b32 v241, v247
    v_max_f32 v240, v240, v246
    v_max_f32 v241, v241, v247
    v_mov_b32 v246, v240
    v_mov_b32 v247, v241
    s_nop 0
    v_permlane32_swap_b32 v240, v246
    v_permlane32_swap_b32 v241, v247
    buffer_load_dwordx4 v[36:39], v0, s[8:11], s60 offen offset:3072 sc1
    v_max_f32 v240, v240, v246
    v_max_f32 v241, v241, v247
    v_mul_f32 v240, s47, v240
    v_mul_f32 v241, s47, v241
    v_fma_f32 v216, v216, s47, -v240
    v_fma_f32 v217, v217, s47, -v240
    v_fma_f32 v218, v218, s47, -v240
    v_fma_f32 v219, v219, s47, -v240
    v_fma_f32 v220, v220, s47, -v241
    v_fma_f32 v221, v221, s47, -v241
    v_fma_f32 v222, v222, s47, -v241
    v_fma_f32 v223, v223, s47, -v241
    v_fma_f32 v224, v224, s47, -v241
    v_fma_f32 v225, v225, s47, -v241
    v_fma_f32 v226, v226, s47, -v241
    v_fma_f32 v227, v227, s47, -v241
    buffer_load_dwordx4 v[40:43], v0, s[8:11], s61 offen offset:0 sc1
    v_exp_f32 v216, v216
    v_exp_f32 v217, v217
    v_exp_f32 v218, v218
    v_exp_f32 v219, v219
    v_exp_f32 v220, v220
    v_exp_f32 v221, v221
    v_exp_f32 v222, v222
    v_exp_f32 v223, v223
    v_exp_f32 v224, v224
    v_exp_f32 v225, v225
    v_exp_f32 v226, v226
    v_exp_f32 v227, v227
    v_cvt_pk_bf16_f32 v228, v216, v217
    v_cvt_pk_bf16_f32 v229, v218, v219
    v_cvt_pk_bf16_f32 v232, v220, v221
    v_cvt_pk_bf16_f32 v233, v222, v223
    buffer_load_dwordx4 v[44:47], v0, s[8:11], s61 offen offset:1024 sc1
    v_cvt_pk_bf16_f32 v234, v224, v225
    v_cvt_pk_bf16_f32 v235, v226, v227
    s_waitcnt vmcnt(10)
    s_or_b32 s28, s36, s54
    s_mov_b64 exec, 1
    buffer_store_dword v9, off, s[4:7], s28 sc1
    s_mov_b64 exec, -1
    s_add_u32 s36, s36, 4
    v_mfma_f32_16x16x32_bf16 v[120:123], a[64:67], v[228:231], 0
    v_add_f32 v242, v216, v217
    v_mfma_f32_16x16x32_bf16 v[152:155], a[64:67], v[232:235], 0
    v_add_f32 v243, v220, v221
    v_mfma_f32_16x16x32_bf16 v[124:127], a[68:71], v[228:231], 0
    v_add_f32 v242, v242, v218
    v_mfma_f32_16x16x32_bf16 v[156:159], a[68:71], v[232:235], 0
    v_add_f32 v242, v242, v219
    buffer_load_dwordx4 v[48:51], v0, s[8:11], s61 offen offset:2048 sc1
    v_mfma_f32_16x16x32_bf16 v[128:131], a[72:75], v[228:231], 0
    v_add_f32 v243, v243, v222
    v_mfma_f32_16x16x32_bf16 v[160:163], a[72:75], v[232:235], 0
    v_add_f32 v243, v243, v223
    v_mfma_f32_16x16x32_bf16 v[132:135], a[76:79], v[228:231], 0
    v_add_f32 v243, v243, v224
    v_mfma_f32_16x16x32_bf16 v[164:167], a[76:79], v[232:235], 0
    v_add_f32 v243, v243, v225
    buffer_load_dwordx4 v[52:55], v0, s[8:11], s61 offen offset:3072 sc1
    s_waitcnt vmcnt(12)
    v_mfma_f32_16x16x32_bf16 v[136:139], a[80:83], v[228:231], 0
    v_add_f32 v243, v243, v226
    v_mfma_f32_16x16x32_bf16 v[168:171], a[80:83], v[232:235], 0
    v_add_f32 v243, v243, v227
    s_waitcnt vmcnt(11)
    v_mfma_f32_16x16x32_bf16 v[140:143], a[84:87], v[228:231], 0
    v_mfma_f32_16x16x32_bf16 v[172:175], a[84:87], v[232:235], 0
    s_waitcnt vmcnt(10)
    v_mfma_f32_16x16x32_bf16 v[144:147], a[88:91], v[228:231], 0
    v_mfma_f32_16x16x32_bf16 v[176:179], a[88:91], v[232:235], 0
    buffer_load_dwordx4 v[56:59], v0, s[8:11], s62 offen offset:0 sc1
    s_waitcnt vmcnt(10)
    v_mfma_f32_16x16x32_bf16 v[148:151], a[92:95], v[228:231], 0
    v_mfma_f32_16x16x32_bf16 v[180:183], a[92:95], v[232:235], 0
    s_cmp_eq_u32 s53, 0
    s_cbranch_scc1 L_atn_ob
    s_mov_b32 s23, 32768
    s_mov_b32 s29, 14
L_spin_21:
    s_sub_u32 s23, s23, 1
    s_nop 1
    s_cbranch_scc1 L_abort
    s_sleep 2
    buffer_load_dword v10, v9, s[4:7], s37 offen offset:0 sc1
    s_waitcnt vmcnt(0)
    v_cmp_eq_u32 vcc, 0, v10
    s_nop 0
    s_cmp_lg_u32 vcc_hi, 0
    s_cbranch_scc1 L_spin_21
    buffer_load_dwordx4 v[184:187], v12, s[4:7], s48 offen offset:0 sc1
    buffer_load_dwordx4 v[188:191], v12, s[4:7], s48 offen offset:512 sc1
    buffer_load_dwordx4 v[192:195], v12, s[4:7], s48 offen offset:1024 sc1
    buffer_load_dwordx4 v[196:199], v12, s[4:7], s48 offen offset:1536 sc1
    buffer_load_dwordx4 v[200:203], v13, s[4:7], s48 offen offset:2048 sc1
    buffer_load_dwordx4 v[204:207], v13, s[4:7], s48 offen offset:2560 sc1
    buffer_load_dwordx4 v[208:211], v13, s[4:7], s48 offen offset:3072 sc1
    buffer_load_dwordx4 v[212:215], v13, s[4:7], s48 offen offset:3584 sc1
L_atn_ob:
    buffer_load_dwordx4 v[60:63], v0, s[8:11], s62 offen offset:1024 sc1
    buffer_load_dwordx4 v[64:67], v0, s[8:11], s62 offen offset:2048 sc1
    buffer_load_dwordx4 v[68:71], v0, s[8:11], s62 offen offset:3072 sc1
    buffer_load_dwordx4 v[72:75], v0, s[8:11], s63 offen offset:0 sc1
    buffer_load_dwordx4 v[76:79], v0, s[8:11], s63 offen offset:1024 sc1
    buffer_load_dwordx4 v[80:83], v0, s[8:11], s63 offen offset:2048 sc1
    s_add_u32 s48, s48, 131072
    s_add_u32 s66, s51, 131072
    s_waitcnt vmcnt(13)
    v_mfma_f32_16x16x32_bf16 v[216:219], v[184:187], a[0:3], v[20:23]
    v_mfma_f32_16x16x32_bf16 v[220:223], v[184:187], a[4:7], v[20:23]
    s_waitcnt vmcnt(12)
    v_mfma_f32_16x16x32_bf16 v[216:219], v[188:191], a[8:11], v[216:219]
    v_mfma_f32_16x16x32_bf16 v[220:223], v[188:191], a[12:15], v[220:223]
    s_waitcnt vmcnt(11)
    v_mfma_f32_16x16x32_bf16 v[216:219], v[192:195], a[16:19], v[216:219]
    v_mfma_f32_16x16x32_bf16 v[220:223], v[192:195], a[20:23], v[220:223]
    s_waitcnt vmcnt(10)
    v_mfma_f32_16x16x32_bf16 v[216:219], v[196:199], a[24:27], v[216:219]
    v_mfma_f32_16x16x32_bf16 v[220:223], v[196:199], a[28:31], v[220:223]
    buffer_load_dword v10, v9, s[4:7], s37 offen offset:4 sc1
    s_nop 5
    v_max3_f32 v244, v216, v217, v218
    v_max3_f32 v245, v220, v221, v222
    v_max_f32 v244, v219, v244
    v_max_f32 v245, v223, v245
    v_mov_b32 v246, v244
    v_mov_b32 v247, v245
    s_nop 0
    v_permlane16_swap_b32 v244, v246
    v_permlane16_swap_b32 v245, v247
    v_max_f32 v244, v244, v246
    v_max_f32 v245, v245, v247
    v_mov_b32 v246, v244
    v_mov_b32 v247, v245
    s_nop 0
    v_permlane32_swap_b32 v244, v246
    v_permlane32_swap_b32 v245, v247
    v_max_f32 v244, v244, v246
    v_max_f32 v245, v245, v247
    v_mul_f32 v244, s47, v244
    v_mul_f32 v245, s47, v245
    buffer_load_dwordx4 v[84:87], v0, s[8:11], s63 offen offset:3072 sc1
    v_max_f32 v244, v244, v240
    v_max_f32 v245, v245, v241
    v_sub_f32 v248, v240, v244
    v_sub_f32 v250, v241, v245
    v_fma_f32 v216, v216, s47, -v244
    v_fma_f32 v220, v220, s47, -v245
    v_fma_f32 v217, v217, s47, -v244
    v_fma_f32 v221, v221, s47, -v245
    v_fma_f32 v218, v218, s47, -v244
    v_fma_f32 v222, v222, s47, -v245
    v_fma_f32 v219, v219, s47, -v244
    v_fma_f32 v223, v223, s47, -v245
    v_exp_f32 v248, v248
    v_exp_f32 v250, v250
    v_exp_f32 v216, v216
    v_exp_f32 v220, v220
    v_exp_f32 v217, v217
    v_exp_f32 v221, v221
    buffer_load_dwordx4 v[88:91], v0, s[8:11], s64 offen offset:0 sc1
    v_exp_f32 v218, v218
    v_exp_f32 v222, v222
    v_exp_f32 v219, v219
    v_exp_f32 v223, v223
    v_fma_f32 v244, v242, v248, v216
    v_fma_f32 v245, v243, v250, v220
    v_add_f32 v246, v217, v218
    v_add_f32 v247, v221, v222
    v_add_f32 v244, v244, v219
    v_add_f32 v245, v245, v223
    v_add_f32 v244, v244, v246
    v_add_f32 v245, v245, v247
    v_mov_b32 v246, v244
    v_mov_b32 v247, v245
    s_nop 0
    v_permlane16_swap_b32 v244, v246
    v_permlane16_swap_b32 v245, v247
    v_add_f32 v244, v244, v246
    v_add_f32 v245, v245, v247
    buffer_load_dwordx4 v[92:95], v0, s[8:11], s64 offen offset:1024 sc1
    v_mov_b32 v246, v244
    v_mov_b32 v247, v245
    s_nop 0
    v_permlane32_swap_b32 v244, v246
    v_permlane32_swap_b32 v245, v247
    v_add_f32 v244, v244, v246
    v_add_f32 v245, v245, v247
    v_rcp_f32 v244, v244
    v_rcp_f32 v245, v245
    v_mul_f32 v248, v244, v248
    v_mul_f32 v250, v245, v250
    v_mul_f32 v216, v244, v216
    v_mul_f32 v220, v245, v220
    v_mul_f32 v217, v244, v217
    v_mul_f32 v221, v245, v221
    v_mul_f32 v218, v244, v218
    v_mul_f32 v222, v245, v222
    v_mul_f32 v219, v244, v219
    v_mul_f32 v223, v245, v223
    buffer_load_dwordx4 v[96:99], v0, s[8:11], s64 offen offset:2048 sc1
    v_cvt_pk_bf16_f32 v224, v216, v217
    v_cvt_pk_bf16_f32 v226, v220, v221
    v_cvt_pk_bf16_f32 v225, v218, v219
    v_cvt_pk_bf16_f32 v227, v222, v223
    v_pk_mul_f32 v[120:121], v[120:121], v[248:249] op_sel_hi:[1,0]
    v_pk_mul_f32 v[122:123], v[122:123], v[248:249] op_sel_hi:[1,0]
    v_pk_mul_f32 v[124:125], v[124:125], v[248:249] op_sel_hi:[1,0]
    v_pk_mul_f32 v[126:127], v[126:127], v[248:249] op_sel_hi:[1,0]
    v_pk_mul_f32 v[128:129], v[128:129], v[248:249] op_sel_hi:[1,0]
    v_pk_mul_f32 v[130:131], v[130:131], v[248:249] op_sel_hi:[1,0]
    v_pk_mul_f32 v[132:133], v[132:133], v[248:249] op_sel_hi:[1,0]
    v_pk_mul_f32 v[134:135], v[134:135], v[248:249] op_sel_hi:[1,0]
    v_pk_mul_f32 v[136:137], v[136:137], v[248:249] op_sel_hi:[1,0]
    v_pk_mul_f32 v[138:139], v[138:139], v[248:249] op_sel_hi:[1,0]
    v_pk_mul_f32 v[140:141], v[140:141], v[248:249] op_sel_hi:[1,0]
    v_pk_mul_f32 v[142:143], v[142:143], v[248:249] op_sel_hi:[1,0]
    v_pk_mul_f32 v[144:145], v[144:145], v[248:249] op_sel_hi:[1,0]
    v_pk_mul_f32 v[146:147], v[146:147], v[248:249] op_sel_hi:[1,0]
    v_pk_mul_f32 v[148:149], v[148:149], v[248:249] op_sel_hi:[1,0]
    v_pk_mul_f32 v[150:151], v[150:151], v[248:249] op_sel_hi:[1,0]
    v_pk_mul_f32 v[152:153], v[152:153], v[250:251] op_sel_hi:[1,0]
    v_pk_mul_f32 v[154:155], v[154:155], v[250:251] op_sel_hi:[1,0]
    v_pk_mul_f32 v[156:157], v[156:157], v[250:251] op_sel_hi:[1,0]
    v_pk_mul_f32 v[158:159], v[158:159], v[250:251] op_sel_hi:[1,0]
    buffer_load_dwordx4 v[100:103], v0, s[8:11], s64 offen offset:3072 sc1
    v_pk_mul_f32 v[160:161], v[160:161], v[250:251] op_sel_hi:[1,0]
    v_pk_mul_f32 v[162:163], v[162:163], v[250:251] op_sel_hi:[1,0]
    v_pk_mul_f32 v[164:165], v[164:165], v[250:251] op_sel_hi:[1,0]
    v_pk_mul_f32 v[166:167], v[166:167], v[250:251] op_sel_hi:[1,0]
    v_pk_mul_f32 v[168:169], v[168:169], v[250:251] op_sel_hi:[1,0]
    v_pk_mul_f32 v[170:171], v[170:171], v[250:251] op_sel_hi:[1,0]
    v_pk_mul_f32 v[172:173], v[172:173], v[250:251] op_sel_hi:[1,0]
    v_pk_mul_f32 v[174:175], v[174:175], v[250:251] op_sel_hi:[1,0]
    v_pk_mul_f32 v[176:177], v[176:177], v[250:251] op_sel_hi:[1,0]
    v_pk_mul_f32 v[178:179], v[178:179], v[250:251] op_sel_hi:[1,0]
    v_pk_mul_f32 v[180:181], v[180:181], v[250:251] op_sel_hi:[1,0]
    v_pk_mul_f32 v[182:183], v[182:183], v[250:251] op_sel_hi:[1,0]
    s_waitcnt vmcnt(15)
    v_mfma_f32_16x16x16_bf16 v[120:123], v[200:201], v[224:225], v[120:123]
    v_mfma_f32_16x16x16_bf16 v[124:127], v[202:203], v[224:225], v[124:127]
    s_waitcnt vmcnt(14)
    v_mfma_f32_16x16x16_bf16 v[128:131], v[204:205], v[224:225], v[128:131]
    v_mfma_f32_16x16x16_bf16 v[132:135], v[206:207], v[224:225], v[132:135]
    s_waitcnt vmcnt(13)
    v_mfma_f32_16x16x16_bf16 v[136:139], v[208:209], v[224:225], v[136:139]
    s_nop 1
    v_cvt_pk_bf16_f32 v120, v120, v121
    v_mfma_f32_16x16x16_bf16 v[140:143], v[210:211], v[224:225], v[140:143]
    v_cvt_pk_bf16_f32 v121, v122, v123
    v_cvt_pk_bf16_f32 v122, v124, v125
    v_cvt_pk_bf16_f32 v123, v126, v127
    s_waitcnt vmcnt(12)
    v_mfma_f32_16x16x16_bf16 v[144:147], v[212:213], v[224:225], v[144:147]
    buffer_store_dwordx4 v[120:123], v0, s[4:7], s51 offen offset:0 sc1
    v_mfma_f32_16x16x16_bf16 v[148:151], v[214:215], v[224:225], v[148:151]
    v_cvt_pk_bf16_f32 v128, v128, v129
    v_cvt_pk_bf16_f32 v129, v130, v131
    v_cvt_pk_bf16_f32 v130, v132, v133
    v_mfma_f32_16x16x16_bf16 v[152:155], v[200:201], v[226:227], v[152:155]
    v_cvt_pk_bf16_f32 v131, v134, v135
    buffer_store_dwordx4 v[128:131], v0, s[4:7], s51 offen offset:1024 sc1
    v_mfma_f32_16x16x16_bf16 v[156:159], v[202:203], v[226:227], v[156:159]
    v_cvt_pk_bf16_f32 v136, v136, v137
    v_cvt_pk_bf16_f32 v137, v138, v139
    v_cvt_pk_bf16_f32 v138, v140, v141
    v_mfma_f32_16x16x16_bf16 v[160:163], v[204:205], v[226:227], v[160:163]
    v_cvt_pk_bf16_f32 v139, v142, v143
    buffer_store_dwordx4 v[136:139], v0, s[4:7], s51 offen offset:2048 sc1
    v_mfma_f32_16x16x16_bf16 v[164:167], v[206:207], v[226:227], v[164:167]
    v_cvt_pk_bf16_f32 v144, v144, v145
    v_cvt_pk_bf16_f32 v145, v146, v147
    v_cvt_pk_bf16_f32 v146, v148, v149
    v_mfma_f32_16x16x16_bf16 v[168:171], v[208:209], v[226:227], v[168:171]
    v_cvt_pk_bf16_f32 v147, v150, v151
    buffer_store_dwordx4 v[144:147], v0, s[4:7], s51 offen offset:3072 sc1
    v_mfma_f32_16x16x16_bf16 v[172:175], v[210:211], v[226:227], v[172:175]
    v_cvt_pk_bf16_f32 v152, v152, v153
    v_cvt_pk_bf16_f32 v153, v154, v155
    v_cvt_pk_bf16_f32 v154, v156, v157
    v_mfma_f32_16x16x16_bf16 v[176:179], v[212:213], v[226:227], v[176:179]
    v_cvt_pk_bf16_f32 v155, v158, v159
    buffer_store_dwordx4 v[152:155], v0, s[4:7], s66 offen offset:0 sc1
    v_mfma_f32_16x16x16_bf16 v[180:183], v[214:215], v[226:227], v[180:183]
    v_cvt_pk_bf16_f32 v160, v160, v161
    v_cvt_pk_bf16_f32 v161, v162, v163
    v_cvt_pk_bf16_f32 v162, v164, v165
    v_cvt_pk_bf16_f32 v163, v166, v167
    buffer_store_dwordx4 v[160:163], v0, s[4:7], s66 offen offset:1024 sc1
    v_cvt_pk_bf16_f32 v168, v168, v169
    v_cvt_pk_bf16_f32 v169, v170, v171
    v_cvt_pk_bf16_f32 v170, v172, v173
    v_cvt_pk_bf16_f32 v171, v174, v175
    buffer_store_dwordx4 v[168:171], v0, s[4:7], s66 offen offset:2048 sc1
    v_cvt_pk_bf16_f32 v176, v176, v177
    v_cvt_pk_bf16_f32 v177, v178, v179
    v_cvt_pk_bf16_f32 v178, v180, v181
    v_cvt_pk_bf16_f32 v179, v182, v183
    buffer_store_dwordx4 v[176:179], v0, s[4:7], s66 offen offset:3072 sc1
    s_waitcnt vmcnt(8)
    buffer_load_dwordx4 v[104:107], v0, s[8:11], s65 offen offset:0 sc1
    buffer_load_dwordx4 v[108:111], v0, s[8:11], s65 offen offset:1024 sc1
    buffer_load_dwordx4 v[112:115], v0, s[8:11], s65 offen offset:2048 sc1
    buffer_load_dwordx4 v[116:119], v0, s[8:11], s65 offen offset:3072 sc1
    s_add_u32 s51, s51, 262144
    s_mov_b32 s54, 0
    s_add_u32 s30, s30, 1
    s_cmp_lg_u32 s10, 0
    s_cbranch_scc1 L_atn_oc
    s_waitcnt vmcnt(0)
    s_mov_b64 exec, 1
    buffer_store_dword v9, off, s[4:7], s36 sc1
    s_mov_b64 exec, -1
    s_mov_b32 s54, 1073741824
    s_cmp_eq_u32 s30, 64
    s_cbranch_scc1 L_atn_done
    s_mov_b32 s23, 32768
    s_mov_b32 s29, 15
L_spin_22:
    s_sub_u32 s23, s23, 1
    s_cbranch_scc1 L_abort
    s_sleep 2
    buffer_load_dword v10, v9, s[4:7], s37 offen sc1
    s_waitcnt vmcnt(0)
    v_cmp_eq_u32 vcc, 0, v10
    s_nop 0
    s_cmp_lg_u32 vcc_lo, 0
    s_cbranch_scc1 L_spin_22
    buffer_load_dwordx4 v[24:27], v0, s[4:7], s60 offen offset:0 sc1
    buffer_load_dwordx4 v[28:31], v0, s[4:7], s60 offen offset:1024 sc1
    buffer_load_dwordx4 v[32:35], v0, s[4:7], s60 offen offset:2048 sc1
    buffer_load_dwordx4 v[36:39], v0, s[4:7], s60 offen offset:3072 sc1
    buffer_load_dwordx4 v[40:43], v0, s[4:7], s61 offen offset:0 sc1
    buffer_load_dwordx4 v[44:47], v0, s[4:7], s61 offen offset:1024 sc1
    buffer_load_dwordx4 v[48:51], v0, s[4:7], s61 offen offset:2048 sc1
    buffer_load_dwordx4 v[52:55], v0, s[4:7], s61 offen offset:3072 sc1
    buffer_load_dwordx4 v[56:59], v0, s[4:7], s62 offen offset:0 sc1
    buffer_load_dwordx4 v[60:63], v0, s[4:7], s62 offen offset:1024 sc1
    buffer_load_dwordx4 v[64:67], v0, s[4:7], s62 offen offset:2048 sc1
    buffer_load_dwordx4 v[68:71], v0, s[4:7], s62 offen offset:3072 sc1
    buffer_load_dwordx4 v[72:75], v0, s[4:7], s63 offen offset:0 sc1
    buffer_load_dwordx4 v[76:79], v0, s[4:7], s63 offen offset:1024 sc1
    buffer_load_dwordx4 v[80:83], v0, s[4:7], s63 offen offset:2048 sc1
    buffer_load_dwordx4 v[84:87], v0, s[4:7], s63 offen offset:3072 sc1
    buffer_load_dwordx4 v[88:91], v0, s[4:7], s64 offen offset:0 sc1
    buffer_load_dwordx4 v[92:95], v0, s[4:7], s64 offen offset:1024 sc1
    buffer_load_dwordx4 v[96:99], v0, s[4:7], s64 offen offset:2048 sc1
    buffer_load_dwordx4 v[100:103], v0, s[4:7], s64 offen offset:3072 sc1
    buffer_load_dwordx4 v[104:107], v0, s[4:7], s65 offen offset:0 sc1
    buffer_load_dwordx4 v[108:111], v0, s[4:7], s65 offen offset:1024 sc1
    buffer_load_dwordx4 v[112:115], v0, s[4:7], s65 offen offset:2048 sc1
    buffer_load_dwordx4 v[116:119], v0, s[4:7], s65 offen offset:3072 sc1
    s_waitcnt vmcnt(0)
    buffer_load_dword v10, v9, s[4:7], s37 offen offset:4 sc1
    s_waitcnt vmcnt(0)
L_atn_oc:
    s_add_u32 s37, s37, 4
    s_branch L_atn_e
L_atn_done:
    s_endpgm
L_oproj:
    s_lshl_b32 s40, s20, 10
    s_add_u32 s28, s24, 0
    s_mul_i32 s39, s28, 1179648
    s_add_u32 s39, s39, 243269632
    s_mul_i32 s33, s21, 36864
    s_add_u32 s33, s33, s39
    v_lshlrev_b32 v10, 4, v0
    v_mov_b32 v16, 1
    v_mov_b32 v17, 1
    v_mov_b32 v18, 1
    v_mov_b32 v19, 1
    s_mul_i32 s60, s20, 9216
    s_add_u32 s60, s60, s33
    s_add_u32 s28, s60, 0
    buffer_store_dwordx4 v[16:19], v10, s[4:7], s28 offen
    s_add_u32 s28, s60, 1024
    buffer_store_dwordx4 v[16:19], v10, s[4:7], s28 offen
    s_add_u32 s28, s60, 2048
    buffer_store_dwordx4 v[16:19], v10, s[4:7], s28 offen
    s_add_u32 s28, s60, 3072
    buffer_store_dwordx4 v[16:19], v10, s[4:7], s28 offen
    s_add_u32 s28, s60, 4096
    buffer_store_dwordx4 v[16:19], v10, s[4:7], s28 offen
    s_add_u32 s28, s60, 5120
    buffer_store_dwordx4 v[16:19], v10, s[4:7], s28 offen
    s_add_u32 s28, s60, 6144
    buffer_store_dwordx4 v[16:19], v10, s[4:7], s28 offen
    s_add_u32 s28, s60, 7168
    buffer_store_dwordx4 v[16:19], v10, s[4:7], s28 offen
    s_add_u32 s28, s60, 8192
    buffer_store_dwordx4 v[16:19], v10, s[4:7], s28 offen
    s_add_u32 s28, s60, 589824
    buffer_store_dwordx4 v[16:19], v10, s[4:7], s28 offen
    s_add_u32 s28, s60, 590848
    buffer_store_dwordx4 v[16:19], v10, s[4:7], s28 offen
    s_add_u32 s28, s60, 591872
    buffer_store_dwordx4 v[16:19], v10, s[4:7], s28 offen
    s_add_u32 s28, s60, 592896
    buffer_store_dwordx4 v[16:19], v10, s[4:7], s28 offen
    s_add_u32 s28, s60, 593920
    buffer_store_dwordx4 v[16:19], v10, s[4:7], s28 offen
    s_add_u32 s28, s60, 594944
    buffer_store_dwordx4 v[16:19], v10, s[4:7], s28 offen
    s_add_u32 s28, s60, 595968
    buffer_store_dwordx4 v[16:19], v10, s[4:7], s28 offen
    s_add_u32 s28, s60, 596992
    buffer_store_dwordx4 v[16:19], v10, s[4:7], s28 offen
    s_add_u32 s28, s60, 598016
    buffer_store_dwordx4 v[16:19], v10, s[4:7], s28 offen
    s_waitcnt vmcnt(0)
    s_barrier
    s_cmp_lg_u32 s20, 0
    s_cbranch_scc1 L_arr_23
    s_mov_b64 exec, 1
    v_mov_b32 v2, 1
    buffer_atomic_add v2, off, s[16:19], 0 offset:16 sc1
    s_mov_b64 exec, -1
L_arr_23:
    s_mov_b32 s23, 32768
    s_mov_b32 s29, 1
L_spin_25:
    s_sub_u32 s23, s23, 1
    s_cbranch_scc1 L_abort
    s_sleep 2
    s_sleep 4
    buffer_load_dword v2, off, s[16:19], 0 offset:16 sc1
    s_waitcnt vmcnt(0)
    v_cmp_gt_u32 vcc, 256, v2
    s_nop 3
    s_cbranch_vccnz L_spin_25
    s_lshl_b32 s60, s24, 9
    s_add_u32 s60, s60, 114688
    s_mov_b32 s23, 32768
    s_mov_b32 s29, 30
L_spin_26:
    s_sub_u32 s23, s23, 1
    s_cbranch_scc1 L_abort
    s_sleep 2
    s_sleep 16
    buffer_load_dword v2, off, s[4:7], s60 sc1
    s_waitcnt vmcnt(0)
    v_cmp_eq_u32 vcc, 0, v2
    s_nop 3
    s_cbranch_vccnz L_spin_26
L_hold_24:
    s_mul_i32 s61, s21, 294912
    s_lshl_b32 s28, s20, 3
    v_add_u32 v42, 0, v0
    v_mul_u32_u24 v40, 911, v42
    v_lshrrev_b32 v40, 16, v40
    v_mul_u32_u24 v41, 72, v40
    v_sub_u32 v42, v42, v41
    v_add_u32 v40, s28, v40
    v_lshrrev_b32 v24, 1, v40
    v_and_b32 v24, 3, v24
    v_lshlrev_b32 v24, 1, v24
    v_xor_b32 v24, v24, v42
    v_lshlrev_b32 v24, 4, v24
    v_mul_u32_u24 v40, 1152, v40
    v_add_u32 v24, v24, v40
    v_add_u32 v42, 64, v0
    v_mul_u32_u24 v40, 911, v42
    v_lshrrev_b32 v40, 16, v40
    v_mul_u32_u24 v41, 72, v40
    v_sub_u32 v42, v42, v41
    v_add_u32 v40, s28, v40
    v_lshrrev_b32 v25, 1, v40
    v_and_b32 v25, 3, v25
    v_lshlrev_b32 v25, 1, v25
    v_xor_b32 v25, v25, v42
    v_lshlrev_b32 v25, 4, v25
    v_mul_u32_u24 v40, 1152, v40
    v_add_u32 v25, v25, v40
    v_add_u32 v42, 128, v0
    v_mul_u32_u24 v40, 911, v42
    v_lshrrev_b32 v40, 16, v40
    v_mul_u32_u24 v41, 72, v40
    v_sub_u32 v42, v42, v41
    v_add_u32 v40, s28, v40
    v_lshrrev_b32 v26, 1, v40
    v_and_b32 v26, 3, v26
    v_lshlrev_b32 v26, 1, v26
    v_xor_b32 v26, v26, v42
    v_lshlrev_b32 v26, 4, v26
    v_mul_u32_u24 v40, 1152, v40
    v_add_u32 v26, v26, v40
    v_add_u32 v42, 192, v0
    v_mul_u32_u24 v40, 911, v42
    v_lshrrev_b32 v40, 16, v40
    v_mul_u32_u24 v41, 72, v40
    v_sub_u32 v42, v42, v41
    v_add_u32 v40, s28, v40
    v_lshrrev_b32 v27, 1, v40
    v_and_b32 v27, 3, v27
    v_lshlrev_b32 v27, 1, v27
    v_xor_b32 v27, v27, v42
    v_lshlrev_b32 v27, 4, v27
    v_mul_u32_u24 v40, 1152, v40
    v_add_u32 v27, v27, v40
    v_add_u32 v42, 256, v0
    v_mul_u32_u24 v40, 911, v42
    v_lshrrev_b32 v40, 16, v40
    v_mul_u32_u24 v41, 72, v40
    v_sub_u32 v42, v42, v41
    v_add_u32 v40, s28, v40
    v_lshrrev_b32 v28, 1, v40
    v_and_b32 v28, 3, v28
    v_lshlrev_b32 v28, 1, v28
    v_xor_b32 v28, v28, v42
    v_lshlrev_b32 v28, 4, v28
    v_mul_u32_u24 v40, 1152, v40
    v_add_u32 v28, v28, v40
    v_add_u32 v42, 320, v0
    v_mul_u32_u24 v40, 911, v42
    v_lshrrev_b32 v40, 16, v40
    v_mul_u32_u24 v41, 72, v40
    v_sub_u32 v42, v42, v41
    v_add_u32 v40, s28, v40
    v_lshrrev_b32 v29, 1, v40
    v_and_b32 v29, 3, v29
    v_lshlrev_b32 v29, 1, v29
    v_xor_b32 v29, v29, v42
    v_lshlrev_b32 v29, 4, v29
    v_mul_u32_u24 v40, 1152, v40
    v_add_u32 v29, v29, v40
    v_add_u32 v42, 384, v0
    v_mul_u32_u24 v40, 911, v42
    v_lshrrev_b32 v40, 16, v40
    v_mul_u32_u24 v41, 72, v40
    v_sub_u32 v42, v42, v41
    v_add_u32 v40, s28, v40
    v_lshrrev_b32 v30, 1, v40
    v_and_b32 v30, 3, v30
    v_lshlrev_b32 v30, 1, v30
    v_xor_b32 v30, v30, v42
    v_lshlrev_b32 v30, 4, v30
    v_mul_u32_u24 v40, 1152, v40
    v_add_u32 v30, v30, v40
    v_add_u32 v42, 448, v0
    v_mul_u32_u24 v40, 911, v42
    v_lshrrev_b32 v40, 16, v40
    v_mul_u32_u24 v41, 72, v40
    v_sub_u32 v42, v42, v41
    v_add_u32 v40, s28, v40
    v_lshrrev_b32 v31, 1, v40
    v_and_b32 v31, 3, v31
    v_lshlrev_b32 v31, 1, v31
    v_xor_b32 v31, v31, v42
    v_lshlrev_b32 v31, 4, v31
    v_mul_u32_u24 v40, 1152, v40
    v_add_u32 v31, v31, v40
    v_add_u32 v42, 512, v0
    v_mul_u32_u24 v40, 911, v42
    v_lshrrev_b32 v40, 16, v40
    v_mul_u32_u24 v41, 72, v40
    v_sub_u32 v42, v42, v41
    v_add_u32 v40, s28, v40
    v_lshrrev_b32 v32, 1, v40
    v_and_b32 v32, 3, v32
    v_lshlrev_b32 v32, 1, v32
    v_xor_b32 v32, v32, v42
    v_lshlrev_b32 v32, 4, v32
    v_mul_u32_u24 v40, 1152, v40
    v_add_u32 v32, v32, v40
    s_mul_i32 s62, s20, 18
    v_lshrrev_b32 v40, 2, v0
    v_lshrrev_b32 v33, 1, v40
    v_and_b32 v33, 3, v33
    v_lshlrev_b32 v33, 1, v33
    v_bfe_u32 v41, v0, 1, 1
    v_add_u32 v41, s62, v41
    v_xor_b32 v33, v33, v41
    v_lshlrev_b32 v33, 4, v33
    v_mul_u32_u24 v40, 1152, v40
    v_add_u32 v33, v33, v40
    v_and_b32 v41, 1, v0
    v_lshlrev_b32 v41, 3, v41
    v_add_u32 v33, v33, v41
    v_lshrrev_b32 v40, 2, v0
    v_lshrrev_b32 v34, 1, v40
    v_and_b32 v34, 3, v34
    v_lshlrev_b32 v34, 1, v34
    v_bfe_u32 v41, v0, 1, 1
    v_add_u32 v41, s62, v41
    v_add_u32 v41, 2, v41
    v_xor_b32 v34, v34, v41
    v_lshlrev_b32 v34, 4, v34
    v_mul_u32_u24 v40, 1152, v40
    v_add_u32 v34, v34, v40
    v_and_b32 v41, 1, v0
    v_lshlrev_b32 v41, 3, v41
    v_add_u32 v34, v34, v41
    v_lshrrev_b32 v40, 2, v0
    v_lshrrev_b32 v35, 1, v40
    v_and_b32 v35, 3, v35
    v_lshlrev_b32 v35, 1, v35
    v_bfe_u32 v41, v0, 1, 1
    v_add_u32 v41, s62, v41
    v_add_u32 v41, 4, v41
    v_xor_b32 v35, v35, v41
    v_lshlrev_b32 v35, 4, v35
    v_mul_u32_u24 v40, 1152, v40
    v_add_u32 v35, v35, v40
    v_and_b32 v41, 1, v0
    v_lshlrev_b32 v41, 3, v41
    v_add_u32 v35, v35, v41
    v_lshrrev_b32 v40, 2, v0
    v_lshrrev_b32 v36, 1, v40
    v_and_b32 v36, 3, v36
    v_lshlrev_b32 v36, 1, v36
    v_bfe_u32 v41, v0, 1, 1
    v_add_u32 v41, s62, v41
    v_add_u32 v41, 6, v41
    v_xor_b32 v36, v36, v41
    v_lshlrev_b32 v36, 4, v36
    v_mul_u32_u24 v40, 1152, v40
    v_add_u32 v36, v36, v40
    v_and_b32 v41, 1, v0
    v_lshlrev_b32 v41, 3, v41
    v_add_u32 v36, v36, v41
    s_mul_i32 s60, s20, 9216
    s_load_dwordx2 s[8:9], s[0:1], 40
    s_mov_b32 s10, 4718592
    s_mov_b32 s11, 0x20000
    s_waitcnt lgkmcnt(0)
    s_add_u32 m0, s60, 0
    s_add_u32 s28, s61, 0
    buffer_load_dwordx4 v24, s[8:11], s28 offen lds
    s_add_u32 m0, s60, 1024
    s_add_u32 s28, s61, 0
    buffer_load_dwordx4 v25, s[8:11], s28 offen lds
    s_add_u32 m0, s60, 2048
    s_add_u32 s28, s61, 0
    buffer_load_dwordx4 v26, s[8:11], s28 offen lds
    s_add_u32 m0, s60, 3072
    s_add_u32 s28, s61, 0
    buffer_load_dwordx4 v27, s[8:11], s28 offen lds
    s_add_u32 m0, s60, 4096
    s_add_u32 s28, s61, 0
    buffer_load_dwordx4 v28, s[8:11], s28 offen lds
    s_add_u32 m0, s60, 5120
    s_add_u32 s28, s61, 0
    buffer_load_dwordx4 v29, s[8:11], s28 offen lds
    s_add_u32 m0, s60, 6144
    s_add_u32 s28, s61, 0
    buffer_load_dwordx4 v30, s[8:11], s28 offen lds
    s_add_u32 m0, s60, 7168
    s_add_u32 s28, s61, 0
    buffer_load_dwordx4 v31, s[8:11], s28 offen lds
    s_add_u32 m0, s60, 8192
    s_add_u32 s28, s61, 0
    buffer_load_dwordx4 v32, s[8:11], s28 offen lds
    s_add_u32 m0, s60, 36864
    s_add_u32 s28, s61, 36864
    buffer_load_dwordx4 v24, s[8:11], s28 offen lds
    s_add_u32 m0, s60, 37888
    s_add_u32 s28, s61, 36864
    buffer_load_dwordx4 v25, s[8:11], s28 offen lds
    s_add_u32 m0, s60, 38912
    s_add_u32 s28, s61, 36864
    buffer_load_dwordx4 v26, s[8:11], s28 offen lds
    s_add_u32 m0, s60, 39936
    s_add_u32 s28, s61, 36864
    buffer_load_dwordx4 v27, s[8:11], s28 offen lds
    s_add_u32 m0, s60, 40960
    s_add_u32 s28, s61, 36864
    buffer_load_dwordx4 v28, s[8:11], s28 offen lds
    s_add_u32 m0, s60, 41984
    s_add_u32 s28, s61, 36864
    buffer_load_dwordx4 v29, s[8:11], s28 offen lds
    s_add_u32 m0, s60, 43008
    s_add_u32 s28, s61, 36864
    buffer_load_dwordx4 v30, s[8:11], s28 offen lds
    s_add_u32 m0, s60, 44032
    s_add_u32 s28, s61, 36864
    buffer_load_dwordx4 v31, s[8:11], s28 offen lds
    s_add_u32 m0, s60, 45056
    s_add_u32 s28, s61, 36864
    buffer_load_dwordx4 v32, s[8:11], s28 offen lds
    s_add_u32 m0, s60, 73728
    s_add_u32 s28, s61, 73728
    buffer_load_dwordx4 v24, s[8:11], s28 offen lds
    s_add_u32 m0, s60, 74752
    s_add_u32 s28, s61, 73728
    buffer_load_dwordx4 v25, s[8:11], s28 offen lds
    s_add_u32 m0, s60, 75776
    s_add_u32 s28, s61, 73728
    buffer_load_dwordx4 v26, s[8:11], s28 offen lds
    s_add_u32 m0, s60, 76800
    s_add_u32 s28, s61, 73728
    buffer_load_dwordx4 v27, s[8:11], s28 offen lds
    s_add_u32 m0, s60, 77824
    s_add_u32 s28, s61, 73728
    buffer_load_dwordx4 v28, s[8:11], s28 offen lds
    s_add_u32 m0, s60, 78848
    s_add_u32 s28, s61, 73728
    buffer_load_dwordx4 v29, s[8:11], s28 offen lds
    s_add_u32 m0, s60, 79872
    s_add_u32 s28, s61, 73728
    buffer_load_dwordx4 v30, s[8:11], s28 offen lds
    s_add_u32 m0, s60, 80896
    s_add_u32 s28, s61, 73728
    buffer_load_dwordx4 v31, s[8:11], s28 offen lds
    s_add_u32 m0, s60, 81920
    s_add_u32 s28, s61, 73728
    buffer_load_dwordx4 v32, s[8:11], s28 offen lds
    s_add_u32 m0, s60, 110592
    s_add_u32 s28, s61, 110592
    buffer_load_dwordx4 v24, s[8:11], s28 offen lds
    s_add_u32 m0, s60, 111616
    s_add_u32 s28, s61, 110592
    buffer_load_dwordx4 v25, s[8:11], s28 offen lds
    s_add_u32 m0, s60, 112640
    s_add_u32 s28, s61, 110592
    buffer_load_dwordx4 v26, s[8:11], s28 offen lds
    s_add_u32 m0, s60, 113664
    s_add_u32 s28, s61, 110592
    buffer_load_dwordx4 v27, s[8:11], s28 offen lds
    s_add_u32 m0, s60, 114688
    s_add_u32 s28, s61, 110592
    buffer_load_dwordx4 v28, s[8:11], s28 offen lds
    s_add_u32 m0, s60, 115712
    s_add_u32 s28, s61, 110592
    buffer_load_dwordx4 v29, s[8:11], s28 offen lds
    s_add_u32 m0, s60, 116736
    s_add_u32 s28, s61, 110592
    buffer_load_dwordx4 v30, s[8:11], s28 offen lds
    s_add_u32 m0, s60, 117760
    s_add_u32 s28, s61, 110592
    buffer_load_dwordx4 v31, s[8:11], s28 offen lds
    s_add_u32 m0, s60, 118784
    s_add_u32 s28, s61, 110592
    buffer_load_dwordx4 v32, s[8:11], s28 offen lds
    s_waitcnt vmcnt(18)
    s_barrier
    ds_read_b64_tr_b16 v[224:225], v33 offset:0
    ds_read_b64_tr_b16 v[226:227], v33 offset:18432
    ds_read_b64_tr_b16 a[0:1], v34 offset:0
    ds_read_b64_tr_b16 a[2:3], v34 offset:18432
    ds_read_b64_tr_b16 a[32:33], v35 offset:0
    ds_read_b64_tr_b16 a[34:35], v35 offset:18432
    ds_read_b64_tr_b16 a[64:65], v36 offset:0
    ds_read_b64_tr_b16 a[66:67], v36 offset:18432
    ds_read_b64_tr_b16 a[96:97], v33 offset:128
    ds_read_b64_tr_b16 a[98:99], v33 offset:18560
    ds_read_b64_tr_b16 a[128:129], v34 offset:128
    ds_read_b64_tr_b16 a[130:131], v34 offset:18560
    ds_read_b64_tr_b16 a[160:161], v35 offset:128
    ds_read_b64_tr_b16 a[162:163], v35 offset:18560
    ds_read_b64_tr_b16 a[192:193], v36 offset:128
    ds_read_b64_tr_b16 a[194:195], v36 offset:18560
    ds_read_b64_tr_b16 a[224:225], v33 offset:256
    ds_read_b64_tr_b16 a[226:227], v33 offset:18688
    ds_read_b64_tr_b16 v[228:229], v33 offset:36864
    ds_read_b64_tr_b16 v[230:231], v33 offset:55296
    ds_read_b64_tr_b16 a[4:5], v34 offset:36864
    ds_read_b64_tr_b16 a[6:7], v34 offset:55296
    ds_read_b64_tr_b16 a[36:37], v35 offset:36864
    ds_read_b64_tr_b16 a[38:39], v35 offset:55296
    ds_read_b64_tr_b16 a[68:69], v36 offset:36864
    ds_read_b64_tr_b16 a[70:71], v36 offset:55296
    ds_read_b64_tr_b16 a[100:101], v33 offset:36992
    ds_read_b64_tr_b16 a[102:103], v33 offset:55424
    ds_read_b64_tr_b16 a[132:133], v34 offset:36992
    ds_read_b64_tr_b16 a[134:135], v34 offset:55424
    ds_read_b64_tr_b16 a[164:165], v35 offset:36992
    ds_read_b64_tr_b16 a[166:167], v35 offset:55424
    ds_read_b64_tr_b16 a[196:197], v36 offset:36992
    ds_read_b64_tr_b16 a[198:199], v36 offset:55424
    ds_read_b64_tr_b16 a[228:229], v33 offset:37120
    ds_read_b64_tr_b16 a[230:231], v33 offset:55552
    s_waitcnt lgkmcnt(0)
    s_barrier
    s_add_u32 m0, s60, 0
    s_add_u32 s28, s61, 147456
    buffer_load_dwordx4 v24, s[8:11], s28 offen lds
    s_add_u32 m0, s60, 1024
    s_add_u32 s28, s61, 147456
    buffer_load_dwordx4 v25, s[8:11], s28 offen lds
    s_add_u32 m0, s60, 2048
    s_add_u32 s28, s61, 147456
    buffer_load_dwordx4 v26, s[8:11], s28 offen lds
    s_add_u32 m0, s60, 3072
    s_add_u32 s28, s61, 147456
    buffer_load_dwordx4 v27, s[8:11], s28 offen lds
    s_add_u32 m0, s60, 4096
    s_add_u32 s28, s61, 147456
    buffer_load_dwordx4 v28, s[8:11], s28 offen lds
    s_add_u32 m0, s60, 5120
    s_add_u32 s28, s61, 147456
    buffer_load_dwordx4 v29, s[8:11], s28 offen lds
    s_add_u32 m0, s60, 6144
    s_add_u32 s28, s61, 147456
    buffer_load_dwordx4 v30, s[8:11], s28 offen lds
    s_add_u32 m0, s60, 7168
    s_add_u32 s28, s61, 147456
    buffer_load_dwordx4 v31, s[8:11], s28 offen lds
    s_add_u32 m0, s60, 8192
    s_add_u32 s28, s61, 147456
    buffer_load_dwordx4 v32, s[8:11], s28 offen lds
    s_add_u32 m0, s60, 36864
    s_add_u32 s28, s61, 184320
    buffer_load_dwordx4 v24, s[8:11], s28 offen lds
    s_add_u32 m0, s60, 37888
    s_add_u32 s28, s61, 184320
    buffer_load_dwordx4 v25, s[8:11], s28 offen lds
    s_add_u32 m0, s60, 38912
    s_add_u32 s28, s61, 184320
    buffer_load_dwordx4 v26, s[8:11], s28 offen lds
    s_add_u32 m0, s60, 39936
    s_add_u32 s28, s61, 184320
    buffer_load_dwordx4 v27, s[8:11], s28 offen lds
    s_add_u32 m0, s60, 40960
    s_add_u32 s28, s61, 184320
    buffer_load_dwordx4 v28, s[8:11], s28 offen lds
    s_add_u32 m0, s60, 41984
    s_add_u32 s28, s61, 184320
    buffer_load_dwordx4 v29, s[8:11], s28 offen lds
    s_add_u32 m0, s60, 43008
    s_add_u32 s28, s61, 184320
    buffer_load_dwordx4 v30, s[8:11], s28 offen lds
    s_add_u32 m0, s60, 44032
    s_add_u32 s28, s61, 184320
    buffer_load_dwordx4 v31, s[8:11], s28 offen lds
    s_add_u32 m0, s60, 45056
    s_add_u32 s28, s61, 184320
    buffer_load_dwordx4 v32, s[8:11], s28 offen lds
    s_waitcnt vmcnt(18)
    s_barrier
    v_add_u32 v37, 65536, v33
    ds_read_b64_tr_b16 v[232:233], v37 offset:8192
    ds_read_b64_tr_b16 v[234:235], v37 offset:26624
    v_add_u32 v37, 65536, v34
    ds_read_b64_tr_b16 a[8:9], v37 offset:8192
    ds_read_b64_tr_b16 a[10:11], v37 offset:26624
    v_add_u32 v37, 65536, v35
    ds_read_b64_tr_b16 a[40:41], v37 offset:8192
    ds_read_b64_tr_b16 a[42:43], v37 offset:26624
    v_add_u32 v37, 65536, v36
    ds_read_b64_tr_b16 a[72:73], v37 offset:8192
    ds_read_b64_tr_b16 a[74:75], v37 offset:26624
    v_add_u32 v37, 65536, v33
    ds_read_b64_tr_b16 a[104:105], v37 offset:8320
    ds_read_b64_tr_b16 a[106:107], v37 offset:26752
    v_add_u32 v37, 65536, v34
    ds_read_b64_tr_b16 a[136:137], v37 offset:8320
    ds_read_b64_tr_b16 a[138:139], v37 offset:26752
    v_add_u32 v37, 65536, v35
    ds_read_b64_tr_b16 a[168:169], v37 offset:8320
    ds_read_b64_tr_b16 a[170:171], v37 offset:26752
    v_add_u32 v37, 65536, v36
    ds_read_b64_tr_b16 a[200:201], v37 offset:8320
    ds_read_b64_tr_b16 a[202:203], v37 offset:26752
    v_add_u32 v37, 65536, v33
    ds_read_b64_tr_b16 a[232:233], v37 offset:8448
    ds_read_b64_tr_b16 a[234:235], v37 offset:26880
    ds_read_b64_tr_b16 v[236:237], v37 offset:45056
    ds_read_b64_tr_b16 v[238:239], v37 offset:63488
    v_add_u32 v37, 98304, v34
    ds_read_b64_tr_b16 a[12:13], v37 offset:12288
    ds_read_b64_tr_b16 a[14:15], v37 offset:30720
    v_add_u32 v37, 98304, v35
    ds_read_b64_tr_b16 a[44:45], v37 offset:12288
    ds_read_b64_tr_b16 a[46:47], v37 offset:30720
    v_add_u32 v37, 98304, v36
    ds_read_b64_tr_b16 a[76:77], v37 offset:12288
    ds_read_b64_tr_b16 a[78:79], v37 offset:30720
    v_add_u32 v37, 98304, v33
    ds_read_b64_tr_b16 a[108:109], v37 offset:12416
    ds_read_b64_tr_b16 a[110:111], v37 offset:30848
    v_add_u32 v37, 98304, v34
    ds_read_b64_tr_b16 a[140:141], v37 offset:12416
    ds_read_b64_tr_b16 a[142:143], v37 offset:30848
    v_add_u32 v37, 98304, v35
    ds_read_b64_tr_b16 a[172:173], v37 offset:12416
    ds_read_b64_tr_b16 a[174:175], v37 offset:30848
    v_add_u32 v37, 98304, v36
    ds_read_b64_tr_b16 a[204:205], v37 offset:12416
    ds_read_b64_tr_b16 a[206:207], v37 offset:30848
    v_add_u32 v37, 98304, v33
    ds_read_b64_tr_b16 a[236:237], v37 offset:12544
    ds_read_b64_tr_b16 a[238:239], v37 offset:30976
    s_waitcnt lgkmcnt(0)
    s_barrier
    s_add_u32 m0, s60, 73728
    s_add_u32 s28, s61, 221184
    buffer_load_dwordx4 v24, s[8:11], s28 offen lds
    s_add_u32 m0, s60, 74752
    s_add_u32 s28, s61, 221184
    buffer_load_dwordx4 v25, s[8:11], s28 offen lds
    s_add_u32 m0, s60, 75776
    s_add_u32 s28, s61, 221184
    buffer_load_dwordx4 v26, s[8:11], s28 offen lds
    s_add_u32 m0, s60, 76800
    s_add_u32 s28, s61, 221184
    buffer_load_dwordx4 v27, s[8:11], s28 offen lds
    s_add_u32 m0, s60, 77824
    s_add_u32 s28, s61, 221184
    buffer_load_dwordx4 v28, s[8:11], s28 offen lds
    s_add_u32 m0, s60, 78848
    s_add_u32 s28, s61, 221184
    buffer_load_dwordx4 v29, s[8:11], s28 offen lds
    s_add_u32 m0, s60, 79872
    s_add_u32 s28, s61, 221184
    buffer_load_dwordx4 v30, s[8:11], s28 offen lds
    s_add_u32 m0, s60, 80896
    s_add_u32 s28, s61, 221184
    buffer_load_dwordx4 v31, s[8:11], s28 offen lds
    s_add_u32 m0, s60, 81920
    s_add_u32 s28, s61, 221184
    buffer_load_dwordx4 v32, s[8:11], s28 offen lds
    s_add_u32 m0, s60, 110592
    s_add_u32 s28, s61, 258048
    buffer_load_dwordx4 v24, s[8:11], s28 offen lds
    s_add_u32 m0, s60, 111616
    s_add_u32 s28, s61, 258048
    buffer_load_dwordx4 v25, s[8:11], s28 offen lds
    s_add_u32 m0, s60, 112640
    s_add_u32 s28, s61, 258048
    buffer_load_dwordx4 v26, s[8:11], s28 offen lds
    s_add_u32 m0, s60, 113664
    s_add_u32 s28, s61, 258048
    buffer_load_dwordx4 v27, s[8:11], s28 offen lds
    s_add_u32 m0, s60, 114688
    s_add_u32 s28, s61, 258048
    buffer_load_dwordx4 v28, s[8:11], s28 offen lds
    s_add_u32 m0, s60, 115712
    s_add_u32 s28, s61, 258048
    buffer_load_dwordx4 v29, s[8:11], s28 offen lds
    s_add_u32 m0, s60, 116736
    s_add_u32 s28, s61, 258048
    buffer_load_dwordx4 v30, s[8:11], s28 offen lds
    s_add_u32 m0, s60, 117760
    s_add_u32 s28, s61, 258048
    buffer_load_dwordx4 v31, s[8:11], s28 offen lds
    s_add_u32 m0, s60, 118784
    s_add_u32 s28, s61, 258048
    buffer_load_dwordx4 v32, s[8:11], s28 offen lds
    s_waitcnt vmcnt(18)
    s_barrier
    ds_read_b64_tr_b16 v[240:241], v33 offset:0
    ds_read_b64_tr_b16 v[242:243], v33 offset:18432
    ds_read_b64_tr_b16 a[16:17], v34 offset:0
    ds_read_b64_tr_b16 a[18:19], v34 offset:18432
    ds_read_b64_tr_b16 a[48:49], v35 offset:0
    ds_read_b64_tr_b16 a[50:51], v35 offset:18432
    ds_read_b64_tr_b16 a[80:81], v36 offset:0
    ds_read_b64_tr_b16 a[82:83], v36 offset:18432
    ds_read_b64_tr_b16 a[112:113], v33 offset:128
    ds_read_b64_tr_b16 a[114:115], v33 offset:18560
    ds_read_b64_tr_b16 a[144:145], v34 offset:128
    ds_read_b64_tr_b16 a[146:147], v34 offset:18560
    ds_read_b64_tr_b16 a[176:177], v35 offset:128
    ds_read_b64_tr_b16 a[178:179], v35 offset:18560
    ds_read_b64_tr_b16 a[208:209], v36 offset:128
    ds_read_b64_tr_b16 a[210:211], v36 offset:18560
    ds_read_b64_tr_b16 a[240:241], v33 offset:256
    ds_read_b64_tr_b16 a[242:243], v33 offset:18688
    ds_read_b64_tr_b16 v[244:245], v33 offset:36864
    ds_read_b64_tr_b16 v[246:247], v33 offset:55296
    ds_read_b64_tr_b16 a[20:21], v34 offset:36864
    ds_read_b64_tr_b16 a[22:23], v34 offset:55296
    ds_read_b64_tr_b16 a[52:53], v35 offset:36864
    ds_read_b64_tr_b16 a[54:55], v35 offset:55296
    ds_read_b64_tr_b16 a[84:85], v36 offset:36864
    ds_read_b64_tr_b16 a[86:87], v36 offset:55296
    ds_read_b64_tr_b16 a[116:117], v33 offset:36992
    ds_read_b64_tr_b16 a[118:119], v33 offset:55424
    ds_read_b64_tr_b16 a[148:149], v34 offset:36992
    ds_read_b64_tr_b16 a[150:151], v34 offset:55424
    ds_read_b64_tr_b16 a[180:181], v35 offset:36992
    ds_read_b64_tr_b16 a[182:183], v35 offset:55424
    ds_read_b64_tr_b16 a[212:213], v36 offset:36992
    ds_read_b64_tr_b16 a[214:215], v36 offset:55424
    ds_read_b64_tr_b16 a[244:245], v33 offset:37120
    ds_read_b64_tr_b16 a[246:247], v33 offset:55552
    s_waitcnt lgkmcnt(0)
    s_barrier
    s_waitcnt vmcnt(0)
    s_barrier
    v_add_u32 v37, 65536, v33
    ds_read_b64_tr_b16 v[248:249], v37 offset:8192
    ds_read_b64_tr_b16 v[250:251], v37 offset:26624
    v_add_u32 v37, 65536, v34
    ds_read_b64_tr_b16 a[24:25], v37 offset:8192
    ds_read_b64_tr_b16 a[26:27], v37 offset:26624
    v_add_u32 v37, 65536, v35
    ds_read_b64_tr_b16 a[56:57], v37 offset:8192
    ds_read_b64_tr_b16 a[58:59], v37 offset:26624
    v_add_u32 v37, 65536, v36
    ds_read_b64_tr_b16 a[88:89], v37 offset:8192
    ds_read_b64_tr_b16 a[90:91], v37 offset:26624
    v_add_u32 v37, 65536, v33
    ds_read_b64_tr_b16 a[120:121], v37 offset:8320
    ds_read_b64_tr_b16 a[122:123], v37 offset:26752
    v_add_u32 v37, 65536, v34
    ds_read_b64_tr_b16 a[152:153], v37 offset:8320
    ds_read_b64_tr_b16 a[154:155], v37 offset:26752
    v_add_u32 v37, 65536, v35
    ds_read_b64_tr_b16 a[184:185], v37 offset:8320
    ds_read_b64_tr_b16 a[186:187], v37 offset:26752
    v_add_u32 v37, 65536, v36
    ds_read_b64_tr_b16 a[216:217], v37 offset:8320
    ds_read_b64_tr_b16 a[218:219], v37 offset:26752
    v_add_u32 v37, 65536, v33
    ds_read_b64_tr_b16 a[248:249], v37 offset:8448
    ds_read_b64_tr_b16 a[250:251], v37 offset:26880
    ds_read_b64_tr_b16 v[252:253], v37 offset:45056
    ds_read_b64_tr_b16 v[254:255], v37 offset:63488
    v_add_u32 v37, 98304, v34
    ds_read_b64_tr_b16 a[28:29], v37 offset:12288
    ds_read_b64_tr_b16 a[30:31], v37 offset:30720
    v_add_u32 v37, 98304, v35
    ds_read_b64_tr_b16 a[60:61], v37 offset:12288
    ds_read_b64_tr_b16 a[62:63], v37 offset:30720
    v_add_u32 v37, 98304, v36
    ds_read_b64_tr_b16 a[92:93], v37 offset:12288
    ds_read_b64_tr_b16 a[94:95], v37 offset:30720
    v_add_u32 v37, 98304, v33
    ds_read_b64_tr_b16 a[124:125], v37 offset:12416
    ds_read_b64_tr_b16 a[126:127], v37 offset:30848
    v_add_u32 v37, 98304, v34
    ds_read_b64_tr_b16 a[156:157], v37 offset:12416
    ds_read_b64_tr_b16 a[158:159], v37 offset:30848
    v_add_u32 v37, 98304, v35
    ds_read_b64_tr_b16 a[188:189], v37 offset:12416
    ds_read_b64_tr_b16 a[190:191], v37 offset:30848
    v_add_u32 v37, 98304, v36
    ds_read_b64_tr_b16 a[220:221], v37 offset:12416
    ds_read_b64_tr_b16 a[222:223], v37 offset:30848
    v_add_u32 v37, 98304, v33
    ds_read_b64_tr_b16 a[252:253], v37 offset:12544
    ds_read_b64_tr_b16 a[254:255], v37 offset:30976
    s_waitcnt lgkmcnt(0)
    s_barrier
    v_min_u32 v9, 1, v0
    v_lshlrev_b32 v9, 9, v9
    v_and_b32 v40, 1, v0
    v_lshlrev_b32 v40, 4, v40
    v_mov_b32 v41, 0x3f80
    v_lshlrev_b32 v41, v40, v41
    v_bfe_u32 v40, v0, 1, 2
    v_cmp_eq_u32 vcc, 0, v40
    s_nop 1
    v_cndmask_b32 v16, 0, v41, vcc
    v_cmp_eq_u32 vcc, 1, v40
    s_nop 1
    v_cndmask_b32 v17, 0, v41, vcc
    v_cmp_eq_u32 vcc, 2, v40
    s_nop 1
    v_cndmask_b32 v18, 0, v41, vcc
    v_cmp_eq_u32 vcc, 3, v40
    s_nop 1
    v_cndmask_b32 v19, 0, v41, vcc
    v_lshrrev_b32 v40, 4, v0
    v_and_b32 v41, 15, v0
    v_mul_u32_u24 v42, 73728, v40
    v_lshl_add_u32 v1, v41, 4, v42
    v_lshl_add_u32 v2, v41, 2, v42
    s_mul_i32 s60, s20, 576
    s_add_u32 s61, s60, 16384
    v_lshrrev_b32 v5, 0, v0
    v_and_b32 v5, 15, v5
    v_lshlrev_b32 v5, 2, v5
    v_lshrrev_b32 v42, 4, v0
    v_and_b32 v42, 1, v42
    v_lshl_or_b32 v5, v42, 7, v5
    v_add_u32 v5, s61, v5
    v_lshrrev_b32 v6, 0, v0
    v_and_b32 v6, 3, v6
    v_lshlrev_b32 v6, 4, v6
    v_lshrrev_b32 v42, 4, v0
    v_and_b32 v42, 1, v42
    v_lshl_or_b32 v6, v42, 3, v6
    v_add_u32 v6, s61, v6
    v_mul_u32_u24 v42, 2304, v40
    v_lshl_add_u32 v3, v41, 4, v42
    v_lshrrev_b32 v41, 2, v0
    v_and_b32 v41, 3, v41
    v_lshlrev_b32 v41, 2, v41
    v_lshrrev_b32 v42, 4, v0
    v_and_b32 v42, 3, v42
    v_lshl_or_b32 v41, v42, 0, v41
    v_mul_u32_u24 v4, 2304, v41
    v_and_b32 v41, 3, v0
    v_lshl_add_u32 v4, v41, 4, v4
    s_lshr_b32 s61, s20, 1
    s_mul_i32 s62, s61, 2304
    s_add_u32 s62, s62, 16384
    v_lshlrev_b32 v7, 5, v0
    v_add_u32 v7, s62, v7
    v_lshlrev_b32 v8, 1, v0
    s_mul_i32 s32, s21, 2304
    s_mul_i32 s61, s61, 1152
    s_add_u32 s34, s32, s61
    s_add_u32 s32, s32, s60
    s_add_u32 s32, s32, s39
    s_add_u32 s33, s33, s60
    s_lshl_b32 s36, s21, 11
    s_lshl_b32 s28, s20, 9
    s_add_u32 s36, s36, s28
    s_add_u32 s28, s33, 589824
    s_xor_b32 s41, s28, s33
    s_add_u32 s28, s32, 589824
    s_xor_b32 s53, s28, s32
    s_bitcmp0_b32 s20, 0
    s_cselect_b32 s58, -1, 0
    s_cselect_b32 s59, 1.0, 0
    s_mov_b64 s[56:57], 1
    s_add_u32 s28, s62, 2048
    v_lshl_add_u32 v11, v8, 1, s28
    s_lshl_b32 s28, s20, 2
    s_add_u32 s28, s28, 22528
    v_mov_b32 v12, s28
    v_mov_b32 v13, 22528
    s_mov_b32 s44, 16384
    s_mov_b32 s30, 0
    s_mov_b32 s42, 0
    s_mov_b64 s[54:55], 0
    v_lshlrev_b32 v0, 4, v0
    v_add_u32 v15, 4096, v0
    s_load_dwordx2 s[8:9], s[0:1], 104
    s_mov_b32 s10, 0
    s_mov_b32 s11, 0x20000
    s_waitcnt lgkmcnt(0)
    s_add_u32 s64, s33, 9216
    s_add_u32 s65, s33, 18432
    s_add_u32 s66, s33, 27648
    v_add_u32 v14, 32768, v0
    s_mul_i32 s60, s24, 2359296
    s_lshl_b32 s61, s24, 8
    s_add_u32 s35, s60, s34
    s_bitcmp1_b32 s20, 0
    s_mov_b32 s28, 11534336
    s_cselect_b32 s28, 6291456, s28
    s_add_u32 s35, s35, s28
    s_add_u32 s36, s36, s61
    s_add_u32 s36, s36, 32768
    s_load_dwordx2 s[12:13], s[0:1], 0
    s_mov_b32 s14, 2359296
    s_mov_b32 s15, 0x20000
    s_waitcnt lgkmcnt(0)
    s_cmp_eq_u32 s24, 0
    s_cbranch_scc1 L_oproj_o
    s_load_dwordx2 s[12:13], s[0:1], 104
    s_mov_b32 s14, 268435456
    s_mov_b32 s15, 0x20000
    s_waitcnt lgkmcnt(0)
    s_add_u32 s34, s34, 16777216
L_oproj_o:
    s_mul_i32 s37, s21, 1024
    s_add_u32 s37, s37, s61
    s_add_u32 s37, s37, 98304
    s_mul_i32 s38, s24, 16777216
    s_mul_i32 s28, s21, 8192
    s_add_u32 s38, s38, s28
    s_add_u32 s38, s38, 94371840
    s_lshr_b32 s28, s20, 1
    s_mul_i32 s43, s28, 8192
    s_mul_i32 s28, s28, 131072
    s_add_u32 s38, s38, s28
    s_and_b32 s28, s20, 1
    s_lshl_b32 s28, s28, 12
    s_add_u32 s43, s43, s28
    s_add_u32 s43, s43, 32768
    s_add_u32 s38, s38, s28
    s_mov_b32 s23, 32768
    s_mov_b32 s29, 1
L_spin_27:
    s_sub_u32 s23, s23, 1
    s_cbranch_scc1 L_abort
    s_sleep 2
    s_sleep 4
    buffer_load_dword v40, off, s[16:19], 0 offset:16 sc1
    s_waitcnt vmcnt(0)
    v_cmp_gt_u32 vcc, 256, v40
    s_nop 3
    s_cbranch_vccnz L_spin_27
    s_mov_b32 s23, 32768
    s_mov_b32 s29, 11
L_spin_28:
    s_sub_u32 s23, s23, 1
    s_cbranch_scc1 L_abort
    s_sleep 2
    buffer_load_dword v10, v9, s[4:7], s37 offen offset:0 sc1
    s_waitcnt vmcnt(0)
    v_cmp_eq_u32 vcc, 0, v10
    s_cbranch_vccnz L_spin_28
    s_mov_b32 m0, s43
    s_nop 0
    buffer_load_dwordx4 v0, s[4:7], s38 offen offset:0 sc1 lds
    buffer_load_dwordx4 v0, s[4:7], s38 offen offset:1024 sc1 lds
    buffer_load_dwordx4 v0, s[4:7], s38 offen offset:2048 sc1 lds
    buffer_load_dwordx4 v0, s[4:7], s38 offen offset:3072 sc1 lds
    s_waitcnt vmcnt(0)
    s_barrier
    ds_read_b128 v[20:23], v14 offset:0
    ds_read_b128 v[52:55], v14 offset:8192
    ds_read_b128 v[24:27], v14 offset:1024
    ds_read_b128 v[56:59], v14 offset:9216
    ds_read_b128 v[28:31], v14 offset:2048
    ds_read_b128 v[60:63], v14 offset:10240
    ds_read_b128 v[32:35], v14 offset:3072
    ds_read_b128 v[64:67], v14 offset:11264
    s_waitcnt lgkmcnt(6)
    v_mfma_f32_16x16x32_bf16 v[92:95], v[20:23], v[224:227], 0
    ds_read_b128 v[36:39], v14 offset:4096
    s_lshr_b32 s31, s30, 1
    v_mfma_f32_16x16x32_bf16 v[96:99], v[52:55], v[224:227], 0
    ds_read_b128 v[68:71], v14 offset:12288
    s_waitcnt lgkmcnt(6)
    v_mfma_f32_16x16x32_bf16 v[92:95], v[24:27], v[228:231], v[92:95]
    ds_read_b128 v[40:43], v14 offset:5120
    s_add_u32 s61, s32, 36864
    v_mfma_f32_16x16x32_bf16 v[96:99], v[56:59], v[228:231], v[96:99]
    ds_read_b128 v[72:75], v14 offset:13312
    s_waitcnt lgkmcnt(6)
    v_mfma_f32_16x16x32_bf16 v[92:95], v[28:31], v[232:235], v[92:95]
    ds_read_b128 v[44:47], v14 offset:6144
    s_add_u32 s62, s32, 294912
    v_mfma_f32_16x16x32_bf16 v[96:99], v[60:63], v[232:235], v[96:99]
    ds_read_b128 v[76:79], v14 offset:14336
    s_waitcnt lgkmcnt(6)
    v_mfma_f32_16x16x32_bf16 v[92:95], v[32:35], v[236:239], v[92:95]
    ds_read_b128 v[48:51], v14 offset:7168
    s_add_u32 s63, s32, 331776
    v_mfma_f32_16x16x32_bf16 v[96:99], v[64:67], v[236:239], v[96:99]
    ds_read_b128 v[80:83], v14 offset:15360
    s_waitcnt lgkmcnt(6)
    v_mfma_f32_16x16x32_bf16 v[92:95], v[36:39], v[240:243], v[92:95]
    s_add_u32 s37, s37, 4
    s_add_u32 s38, s38, 262144
    v_mfma_f32_16x16x32_bf16 v[96:99], v[68:71], v[240:243], v[96:99]
    s_waitcnt lgkmcnt(4)
    s_add_u32 s43, s43, s44
    v_mfma_f32_16x16x32_bf16 v[92:95], v[40:43], v[244:247], v[92:95]
    s_cmp_eq_u32 s30, 63
    s_cselect_b32 s47, 0, s6
    v_mfma_f32_16x16x32_bf16 v[96:99], v[72:75], v[244:247], v[96:99]
    s_waitcnt lgkmcnt(2)
    v_mfma_f32_16x16x32_bf16 v[92:95], v[44:47], v[248:251], v[92:95]
    v_mfma_f32_16x16x32_bf16 v[96:99], v[76:79], v[248:251], v[96:99]
    s_waitcnt lgkmcnt(1)
    v_mfma_f32_16x16x32_bf16 v[92:95], v[48:51], v[252:255], v[92:95]
    s_waitcnt lgkmcnt(0)
    v_mfma_f32_16x16x32_bf16 v[96:99], v[80:83], v[252:255], v[96:99]
    v_mfma_f32_16x16x32_bf16 v[100:103], v[20:23], a[0:3], 0
    v_mfma_f32_16x16x32_bf16 v[104:107], v[52:55], a[0:3], 0
    v_mfma_f32_16x16x32_bf16 v[100:103], v[24:27], a[4:7], v[100:103]
    v_mfma_f32_16x16x32_bf16 v[104:107], v[56:59], a[4:7], v[104:107]
    v_mfma_f32_16x16x32_bf16 v[100:103], v[28:31], a[8:11], v[100:103]
    s_nop 0
    v_cvt_pk_bf16_f32 v108, v92, v93
    v_mfma_f32_16x16x32_bf16 v[104:107], v[60:63], a[8:11], v[104:107]
    v_bfi_b32 v108, 1, s31, v108
    v_mfma_f32_16x16x32_bf16 v[100:103], v[32:35], a[12:15], v[100:103]
    v_cvt_pk_bf16_f32 v112, v94, v95
    v_mfma_f32_16x16x32_bf16 v[104:107], v[64:67], a[12:15], v[104:107]
    v_bfi_b32 v112, 1, s31, v112
    v_mfma_f32_16x16x32_bf16 v[100:103], v[36:39], a[16:19], v[100:103]
    v_cvt_pk_bf16_f32 v116, v96, v97
    v_mfma_f32_16x16x32_bf16 v[104:107], v[68:71], a[16:19], v[104:107]
    v_bfi_b32 v116, 1, s31, v116
    v_mfma_f32_16x16x32_bf16 v[100:103], v[40:43], a[20:23], v[100:103]
    v_cvt_pk_bf16_f32 v120, v98, v99
    v_mfma_f32_16x16x32_bf16 v[104:107], v[72:75], a[20:23], v[104:107]
    v_bfi_b32 v120, 1, s31, v120
    v_mfma_f32_16x16x32_bf16 v[100:103], v[44:47], a[24:27], v[100:103]
    v_mfma_f32_16x16x32_bf16 v[104:107], v[76:79], a[24:27], v[104:107]
    v_mfma_f32_16x16x32_bf16 v[100:103], v[48:51], a[28:31], v[100:103]
    v_mfma_f32_16x16x32_bf16 v[104:107], v[80:83], a[28:31], v[104:107]
    v_mfma_f32_16x16x32_bf16 v[92:95], v[20:23], a[32:35], 0
    v_mfma_f32_16x16x32_bf16 v[96:99], v[52:55], a[32:35], 0
    v_mfma_f32_16x16x32_bf16 v[92:95], v[24:27], a[36:39], v[92:95]
    v_mfma_f32_16x16x32_bf16 v[96:99], v[56:59], a[36:39], v[96:99]
    v_mfma_f32_16x16x32_bf16 v[92:95], v[28:31], a[40:43], v[92:95]
    s_nop 1
    v_cvt_pk_bf16_f32 v109, v100, v101
    v_mfma_f32_16x16x32_bf16 v[96:99], v[60:63], a[40:43], v[96:99]
    v_cvt_pk_bf16_f32 v113, v102, v103
    v_mfma_f32_16x16x32_bf16 v[92:95], v[32:35], a[44:47], v[92:95]
    v_cvt_pk_bf16_f32 v117, v104, v105
    v_mfma_f32_16x16x32_bf16 v[96:99], v[64:67], a[44:47], v[96:99]
    v_cvt_pk_bf16_f32 v121, v106, v107
    v_mfma_f32_16x16x32_bf16 v[92:95], v[36:39], a[48:51], v[92:95]
    v_mfma_f32_16x16x32_bf16 v[96:99], v[68:71], a[48:51], v[96:99]
    v_mfma_f32_16x16x32_bf16 v[92:95], v[40:43], a[52:55], v[92:95]
    v_mfma_f32_16x16x32_bf16 v[96:99], v[72:75], a[52:55], v[96:99]
    v_mfma_f32_16x16x32_bf16 v[92:95], v[44:47], a[56:59], v[92:95]
    v_mfma_f32_16x16x32_bf16 v[96:99], v[76:79], a[56:59], v[96:99]
    buffer_load_dword v10, v9, s[4:7], s37 offen offset:0 sc1
    v_mfma_f32_16x16x32_bf16 v[92:95], v[48:51], a[60:63], v[92:95]
    v_mfma_f32_16x16x32_bf16 v[96:99], v[80:83], a[60:63], v[96:99]
    v_mfma_f32_16x16x32_bf16 v[100:103], v[20:23], a[64:67], 0
    v_mfma_f32_16x16x32_bf16 v[104:107], v[52:55], a[64:67], 0
    v_mfma_f32_16x16x32_bf16 v[100:103], v[24:27], a[68:71], v[100:103]
    v_mfma_f32_16x16x32_bf16 v[104:107], v[56:59], a[68:71], v[104:107]
    v_mfma_f32_16x16x32_bf16 v[100:103], v[28:31], a[72:75], v[100:103]
    s_nop 1
    v_cvt_pk_bf16_f32 v110, v92, v93
    v_mfma_f32_16x16x32_bf16 v[104:107], v[60:63], a[72:75], v[104:107]
    v_cvt_pk_bf16_f32 v114, v94, v95
    v_mfma_f32_16x16x32_bf16 v[100:103], v[32:35], a[76:79], v[100:103]
    v_cvt_pk_bf16_f32 v118, v96, v97
    v_mfma_f32_16x16x32_bf16 v[104:107], v[64:67], a[76:79], v[104:107]
    v_cvt_pk_bf16_f32 v122, v98, v99
    v_mfma_f32_16x16x32_bf16 v[100:103], v[36:39], a[80:83], v[100:103]
    v_mfma_f32_16x16x32_bf16 v[104:107], v[68:71], a[80:83], v[104:107]
    v_mfma_f32_16x16x32_bf16 v[100:103], v[40:43], a[84:87], v[100:103]
    v_mfma_f32_16x16x32_bf16 v[104:107], v[72:75], a[84:87], v[104:107]
    v_mfma_f32_16x16x32_bf16 v[100:103], v[44:47], a[88:91], v[100:103]
    v_mfma_f32_16x16x32_bf16 v[104:107], v[76:79], a[88:91], v[104:107]
    v_mfma_f32_16x16x32_bf16 v[100:103], v[48:51], a[92:95], v[100:103]
    v_mfma_f32_16x16x32_bf16 v[104:107], v[80:83], a[92:95], v[104:107]
    v_mfma_f32_16x16x32_bf16 v[92:95], v[20:23], a[96:99], 0
    v_mfma_f32_16x16x32_bf16 v[96:99], v[52:55], a[96:99], 0
    v_mfma_f32_16x16x32_bf16 v[92:95], v[24:27], a[100:103], v[92:95]
    v_mfma_f32_16x16x32_bf16 v[96:99], v[56:59], a[100:103], v[96:99]
    v_mfma_f32_16x16x32_bf16 v[92:95], v[28:31], a[104:107], v[92:95]
    s_nop 1
    v_cvt_pk_bf16_f32 v111, v100, v101
    v_mfma_f32_16x16x32_bf16 v[96:99], v[60:63], a[104:107], v[96:99]
    buffer_store_dwordx4 v[108:111], v1, s[4:7], s32 offen offset:0
    v_mfma_f32_16x16x32_bf16 v[92:95], v[32:35], a[108:111], v[92:95]
    v_mfma_f32_16x16x32_bf16 v[96:99], v[64:67], a[108:111], v[96:99]
    v_cvt_pk_bf16_f32 v115, v102, v103
    v_mfma_f32_16x16x32_bf16 v[92:95], v[36:39], a[112:115], v[92:95]
    buffer_store_dwordx4 v[112:115], v1, s[4:7], s61 offen offset:0
    v_mfma_f32_16x16x32_bf16 v[96:99], v[68:71], a[112:115], v[96:99]
    v_mfma_f32_16x16x32_bf16 v[92:95], v[40:43], a[116:119], v[92:95]
    v_cvt_pk_bf16_f32 v119, v104, v105
    v_mfma_f32_16x16x32_bf16 v[96:99], v[72:75], a[116:119], v[96:99]
    buffer_store_dwordx4 v[116:119], v1, s[4:7], s62 offen offset:0
    v_mfma_f32_16x16x32_bf16 v[92:95], v[44:47], a[120:123], v[92:95]
    v_mfma_f32_16x16x32_bf16 v[96:99], v[76:79], a[120:123], v[96:99]
    v_cvt_pk_bf16_f32 v123, v106, v107
    v_mfma_f32_16x16x32_bf16 v[92:95], v[48:51], a[124:127], v[92:95]
    buffer_store_dwordx4 v[120:123], v1, s[4:7], s63 offen offset:0
    v_mfma_f32_16x16x32_bf16 v[96:99], v[80:83], a[124:127], v[96:99]
    s_waitcnt vmcnt(4)
    v_cmp_eq_u32 vcc, 0, v10
    s_nop 0
    s_cmp_eq_u64 vcc, 0
    s_cselect_b32 s10, s47, 0
    v_mfma_f32_16x16x32_bf16 v[100:103], v[20:23], a[128:131], 0
    s_mov_b32 m0, s43
    v_mfma_f32_16x16x32_bf16 v[104:107], v[52:55], a[128:131], 0
    buffer_load_dwordx4 v0, s[8:11], s38 offen offset:0 sc1 lds
    v_mfma_f32_16x16x32_bf16 v[100:103], v[24:27], a[132:135], v[100:103]
    v_mfma_f32_16x16x32_bf16 v[104:107], v[56:59], a[132:135], v[104:107]
    v_mfma_f32_16x16x32_bf16 v[100:103], v[28:31], a[136:139], v[100:103]
    buffer_load_dwordx4 v0, s[8:11], s38 offen offset:1024 sc1 lds
    v_mfma_f32_16x16x32_bf16 v[104:107], v[60:63], a[136:139], v[104:107]
    v_cvt_pk_bf16_f32 v108, v92, v93
    v_mfma_f32_16x16x32_bf16 v[100:103], v[32:35], a[140:143], v[100:103]
    v_bfi_b32 v108, 1, s31, v108
    v_mfma_f32_16x16x32_bf16 v[104:107], v[64:67], a[140:143], v[104:107]
    buffer_load_dwordx4 v0, s[8:11], s38 offen offset:2048 sc1 lds
    v_mfma_f32_16x16x32_bf16 v[100:103], v[36:39], a[144:147], v[100:103]
    v_cvt_pk_bf16_f32 v112, v94, v95
    v_mfma_f32_16x16x32_bf16 v[104:107], v[68:71], a[144:147], v[104:107]
    v_bfi_b32 v112, 1, s31, v112
    v_mfma_f32_16x16x32_bf16 v[100:103], v[40:43], a[148:151], v[100:103]
    buffer_load_dwordx4 v0, s[8:11], s38 offen offset:3072 sc1 lds
    v_mfma_f32_16x16x32_bf16 v[104:107], v[72:75], a[148:151], v[104:107]
    v_cvt_pk_bf16_f32 v116, v96, v97
    v_mfma_f32_16x16x32_bf16 v[100:103], v[44:47], a[152:155], v[100:103]
    v_bfi_b32 v116, 1, s31, v116
    v_mfma_f32_16x16x32_bf16 v[104:107], v[76:79], a[152:155], v[104:107]
    v_cvt_pk_bf16_f32 v120, v98, v99
    v_mfma_f32_16x16x32_bf16 v[100:103], v[48:51], a[156:159], v[100:103]
    v_bfi_b32 v120, 1, s31, v120
    v_mfma_f32_16x16x32_bf16 v[104:107], v[80:83], a[156:159], v[104:107]
    v_mfma_f32_16x16x32_bf16 v[92:95], v[20:23], a[160:163], 0
    v_mfma_f32_16x16x32_bf16 v[96:99], v[52:55], a[160:163], 0
    v_mfma_f32_16x16x32_bf16 v[92:95], v[24:27], a[164:167], v[92:95]
    v_mfma_f32_16x16x32_bf16 v[96:99], v[56:59], a[164:167], v[96:99]
    v_mfma_f32_16x16x32_bf16 v[92:95], v[28:31], a[168:171], v[92:95]
    s_nop 0
    v_cvt_pk_bf16_f32 v109, v100, v101
    v_mfma_f32_16x16x32_bf16 v[96:99], v[60:63], a[168:171], v[96:99]
    v_cvt_pk_bf16_f32 v113, v102, v103
    v_mfma_f32_16x16x32_bf16 v[92:95], v[32:35], a[172:175], v[92:95]
    v_cvt_pk_bf16_f32 v117, v104, v105
    v_mfma_f32_16x16x32_bf16 v[96:99], v[64:67], a[172:175], v[96:99]
    v_cvt_pk_bf16_f32 v121, v106, v107
    v_mfma_f32_16x16x32_bf16 v[92:95], v[36:39], a[176:179], v[92:95]
    v_mfma_f32_16x16x32_bf16 v[96:99], v[68:71], a[176:179], v[96:99]
    v_mfma_f32_16x16x32_bf16 v[92:95], v[40:43], a[180:183], v[92:95]
    v_mfma_f32_16x16x32_bf16 v[96:99], v[72:75], a[180:183], v[96:99]
    v_mfma_f32_16x16x32_bf16 v[92:95], v[44:47], a[184:187], v[92:95]
    v_mfma_f32_16x16x32_bf16 v[96:99], v[76:79], a[184:187], v[96:99]
    v_mfma_f32_16x16x32_bf16 v[92:95], v[48:51], a[188:191], v[92:95]
    v_mfma_f32_16x16x32_bf16 v[96:99], v[80:83], a[188:191], v[96:99]
    v_mfma_f32_16x16x32_bf16 v[100:103], v[20:23], a[192:195], 0
    v_mfma_f32_16x16x32_bf16 v[104:107], v[52:55], a[192:195], 0
    buffer_load_dwordx4 v[180:183], v0, s[12:15], s34 offen sc1
    buffer_load_ushort v184, v8, s[12:15], s34 offen offset:1024 sc1
    v_mfma_f32_16x16x32_bf16 v[100:103], v[24:27], a[196:199], v[100:103]
    v_mfma_f32_16x16x32_bf16 v[104:107], v[56:59], a[196:199], v[104:107]
    v_mfma_f32_16x16x32_bf16 v[100:103], v[28:31], a[200:203], v[100:103]
    v_cvt_pk_bf16_f32 v110, v92, v93
    v_mfma_f32_16x16x32_bf16 v[104:107], v[60:63], a[200:203], v[104:107]
    v_cvt_pk_bf16_f32 v114, v94, v95
    v_mfma_f32_16x16x32_bf16 v[100:103], v[32:35], a[204:207], v[100:103]
    v_cvt_pk_bf16_f32 v118, v96, v97
    v_mfma_f32_16x16x32_bf16 v[104:107], v[64:67], a[204:207], v[104:107]
    v_cvt_pk_bf16_f32 v122, v98, v99
    v_mfma_f32_16x16x32_bf16 v[100:103], v[36:39], a[208:211], v[100:103]
    v_mfma_f32_16x16x32_bf16 v[104:107], v[68:71], a[208:211], v[104:107]
    v_mfma_f32_16x16x32_bf16 v[100:103], v[40:43], a[212:215], v[100:103]
    v_mfma_f32_16x16x32_bf16 v[104:107], v[72:75], a[212:215], v[104:107]
    v_mfma_f32_16x16x32_bf16 v[100:103], v[44:47], a[216:219], v[100:103]
    v_mfma_f32_16x16x32_bf16 v[104:107], v[76:79], a[216:219], v[104:107]
    v_mfma_f32_16x16x32_bf16 v[100:103], v[48:51], a[220:223], v[100:103]
    v_mfma_f32_16x16x32_bf16 v[104:107], v[80:83], a[220:223], v[104:107]
    v_mfma_f32_16x16x32_bf16 v[92:95], v[20:23], a[224:227], 0
    v_mfma_f32_16x16x32_bf16 v[96:99], v[52:55], a[224:227], 0
    v_mfma_f32_16x16x32_bf16 v[92:95], v[24:27], a[228:231], v[92:95]
    v_mfma_f32_16x16x32_bf16 v[96:99], v[56:59], a[228:231], v[96:99]
    v_mfma_f32_16x16x32_bf16 v[92:95], v[28:31], a[232:235], v[92:95]
    s_nop 1
    v_cvt_pk_bf16_f32 v111, v100, v101
    v_mfma_f32_16x16x32_bf16 v[96:99], v[60:63], a[232:235], v[96:99]
    buffer_store_dwordx4 v[108:111], v1, s[4:7], s32 offen offset:256
    v_mfma_f32_16x16x32_bf16 v[92:95], v[32:35], a[236:239], v[92:95]
    v_mfma_f32_16x16x32_bf16 v[96:99], v[64:67], a[236:239], v[96:99]
    v_cvt_pk_bf16_f32 v115, v102, v103
    v_mfma_f32_16x16x32_bf16 v[92:95], v[36:39], a[240:243], v[92:95]
    buffer_store_dwordx4 v[112:115], v1, s[4:7], s61 offen offset:256
    v_mfma_f32_16x16x32_bf16 v[96:99], v[68:71], a[240:243], v[96:99]
    v_mfma_f32_16x16x32_bf16 v[92:95], v[40:43], a[244:247], v[92:95]
    v_cvt_pk_bf16_f32 v119, v104, v105
    v_mfma_f32_16x16x32_bf16 v[96:99], v[72:75], a[244:247], v[96:99]
    buffer_store_dwordx4 v[116:119], v1, s[4:7], s62 offen offset:256
    v_mfma_f32_16x16x32_bf16 v[92:95], v[44:47], a[248:251], v[92:95]
    v_mfma_f32_16x16x32_bf16 v[96:99], v[76:79], a[248:251], v[96:99]
    v_cvt_pk_bf16_f32 v123, v106, v107
    v_mfma_f32_16x16x32_bf16 v[92:95], v[48:51], a[252:255], v[92:95]
    buffer_store_dwordx4 v[120:123], v1, s[4:7], s63 offen offset:256
    v_mfma_f32_16x16x32_bf16 v[96:99], v[80:83], a[252:255], v[96:99]
    s_mov_b32 s51, s31
    s_mov_b32 s67, s32
    s_mov_b32 s23, 32768
    s_xor_b32 s32, s32, s53
    s_nop 2
    s_branch L_oproj_end
L_oproj_carry:
    s_barrier
    ds_read_b128 v[20:23], v14 offset:0
    ds_read_b128 v[52:55], v14 offset:8192
    ds_read_b128 v[24:27], v14 offset:1024
    ds_read_b128 v[56:59], v14 offset:9216
    ds_read_b128 v[28:31], v14 offset:2048
    ds_read_b128 v[60:63], v14 offset:10240
    ds_read_b128 v[32:35], v14 offset:3072
    ds_read_b128 v[64:67], v14 offset:11264
    s_cmp_eq_u32 s10, 0
    s_cbranch_scc1 L_kt_29
    v_cvt_pk_bf16_f32 v124, v92, v93
    v_bfi_b32 v124, 1, s51, v124
    buffer_store_dword v124, v2, s[4:7], s67 offen offset:512
    v_cvt_pk_bf16_f32 v125, v94, v95
    v_bfi_b32 v125, 1, s51, v125
    buffer_store_dword v125, v2, s[4:7], s61 offen offset:512
    v_cvt_pk_bf16_f32 v126, v96, v97
    v_bfi_b32 v126, 1, s51, v126
    buffer_store_dword v126, v2, s[4:7], s62 offen offset:512
    v_cvt_pk_bf16_f32 v127, v98, v99
    v_bfi_b32 v127, 1, s51, v127
    buffer_store_dword v127, v2, s[4:7], s63 offen offset:512
L_kt_29:
    s_nop 1
    s_waitcnt lgkmcnt(6)
    v_mfma_f32_16x16x32_bf16 v[92:95], v[20:23], v[224:227], 0
    ds_read_b128 v[36:39], v14 offset:4096
    s_lshr_b32 s31, s30, 1
    v_mfma_f32_16x16x32_bf16 v[96:99], v[52:55], v[224:227], 0
    ds_read_b128 v[68:71], v14 offset:12288
    s_waitcnt lgkmcnt(6)
    v_mfma_f32_16x16x32_bf16 v[92:95], v[24:27], v[228:231], v[92:95]
    ds_read_b128 v[40:43], v14 offset:5120
    s_add_u32 s61, s32, 36864
    v_mfma_f32_16x16x32_bf16 v[96:99], v[56:59], v[228:231], v[96:99]
    ds_read_b128 v[72:75], v14 offset:13312
    s_waitcnt lgkmcnt(6)
    buffer_load_dwordx4 v[128:131], v3, s[4:7], s33 offen offset:0 sc1
    v_mfma_f32_16x16x32_bf16 v[92:95], v[28:31], v[232:235], v[92:95]
    ds_read_b128 v[44:47], v14 offset:6144
    s_add_u32 s62, s32, 294912
    v_mfma_f32_16x16x32_bf16 v[96:99], v[60:63], v[232:235], v[96:99]
    ds_read_b128 v[76:79], v14 offset:14336
    s_waitcnt lgkmcnt(6)
    v_mfma_f32_16x16x32_bf16 v[92:95], v[32:35], v[236:239], v[92:95]
    ds_read_b128 v[48:51], v14 offset:7168
    s_add_u32 s63, s32, 331776
    v_mfma_f32_16x16x32_bf16 v[96:99], v[64:67], v[236:239], v[96:99]
    ds_read_b128 v[80:83], v14 offset:15360
    s_waitcnt lgkmcnt(6)
    buffer_load_dwordx4 v[132:135], v3, s[4:7], s64 offen offset:0 sc1
    v_mfma_f32_16x16x32_bf16 v[92:95], v[36:39], v[240:243], v[92:95]
    s_add_u32 s37, s37, 4
    s_add_u32 s38, s38, 262144
    v_mfma_f32_16x16x32_bf16 v[96:99], v[68:71], v[240:243], v[96:99]
    s_waitcnt lgkmcnt(4)
    s_add_u32 s43, s43, s44
    v_mfma_f32_16x16x32_bf16 v[92:95], v[40:43], v[244:247], v[92:95]
    s_cmp_eq_u32 s30, 63
    s_cselect_b32 s47, 0, s6
    v_mfma_f32_16x16x32_bf16 v[96:99], v[72:75], v[244:247], v[96:99]
    s_waitcnt lgkmcnt(2)
    buffer_load_dwordx4 v[136:139], v3, s[4:7], s65 offen offset:0 sc1
    v_mfma_f32_16x16x32_bf16 v[92:95], v[44:47], v[248:251], v[92:95]
    v_mfma_f32_16x16x32_bf16 v[96:99], v[76:79], v[248:251], v[96:99]
    s_waitcnt lgkmcnt(1)
    v_mfma_f32_16x16x32_bf16 v[92:95], v[48:51], v[252:255], v[92:95]
    s_waitcnt lgkmcnt(0)
    v_mfma_f32_16x16x32_bf16 v[96:99], v[80:83], v[252:255], v[96:99]
    buffer_load_dwordx4 v[140:143], v3, s[4:7], s66 offen offset:0 sc1
    v_mfma_f32_16x16x32_bf16 v[100:103], v[20:23], a[0:3], 0
    v_mfma_f32_16x16x32_bf16 v[104:107], v[52:55], a[0:3], 0
    v_mfma_f32_16x16x32_bf16 v[100:103], v[24:27], a[4:7], v[100:103]
    v_mfma_f32_16x16x32_bf16 v[104:107], v[56:59], a[4:7], v[104:107]
    buffer_load_dwordx4 v[144:147], v3, s[4:7], s33 offen offset:256 sc1
    v_mfma_f32_16x16x32_bf16 v[100:103], v[28:31], a[8:11], v[100:103]
    v_cvt_pk_bf16_f32 v108, v92, v93
    v_mfma_f32_16x16x32_bf16 v[104:107], v[60:63], a[8:11], v[104:107]
    v_bfi_b32 v108, 1, s31, v108
    v_mfma_f32_16x16x32_bf16 v[100:103], v[32:35], a[12:15], v[100:103]
    v_cvt_pk_bf16_f32 v112, v94, v95
    v_mfma_f32_16x16x32_bf16 v[104:107], v[64:67], a[12:15], v[104:107]
    buffer_load_dwordx4 v[148:151], v3, s[4:7], s64 offen offset:256 sc1
    v_mfma_f32_16x16x32_bf16 v[100:103], v[36:39], a[16:19], v[100:103]
    v_bfi_b32 v112, 1, s31, v112
    v_mfma_f32_16x16x32_bf16 v[104:107], v[68:71], a[16:19], v[104:107]
    v_cvt_pk_bf16_f32 v116, v96, v97
    v_mfma_f32_16x16x32_bf16 v[100:103], v[40:43], a[20:23], v[100:103]
    v_bfi_b32 v116, 1, s31, v116
    v_mfma_f32_16x16x32_bf16 v[104:107], v[72:75], a[20:23], v[104:107]
    buffer_load_dwordx4 v[152:155], v3, s[4:7], s65 offen offset:256 sc1
    v_mfma_f32_16x16x32_bf16 v[100:103], v[44:47], a[24:27], v[100:103]
    v_cvt_pk_bf16_f32 v120, v98, v99
    v_mfma_f32_16x16x32_bf16 v[104:107], v[76:79], a[24:27], v[104:107]
L_rsc_31:
    s_waitcnt vmcnt(3)
    v_mfma_f32_16x16x32_bf16 v[164:167], v[16:19], v[128:131], 0
    v_bitop3_b32 v176, v128, v132, s51 bitop3:0x7e
    v_bitop3_b32 v177, v136, v140, s51 bitop3:0x7e
    v_mfma_f32_16x16x32_bf16 v[164:167], v[16:19], v[132:135], v[164:167]
    v_bitop3_b32 v176, v176, v177, 1 bitop3:0xa8
    v_cmp_ne_u32 vcc, 0, v176
    v_mfma_f32_16x16x32_bf16 v[164:167], v[16:19], v[136:139], v[164:167]
    v_mfma_f32_16x16x32_bf16 v[164:167], v[16:19], v[140:143], v[164:167]
    s_cbranch_vccnz L_rsr_30
    v_mfma_f32_16x16x32_bf16 v[100:103], v[48:51], a[28:31], v[100:103]
    v_bfi_b32 v120, 1, s31, v120
    v_mfma_f32_16x16x32_bf16 v[104:107], v[80:83], a[28:31], v[104:107]
    buffer_load_dwordx4 v[156:159], v3, s[4:7], s66 offen offset:256 sc1
    v_mfma_f32_16x16x32_bf16 v[92:95], v[20:23], a[32:35], 0
    v_mfma_f32_16x16x32_bf16 v[96:99], v[52:55], a[32:35], 0
    s_nop 0
    ds_write_b32 v5, v164 offset:0
    ds_write_b32 v5, v165 offset:2304
    v_mfma_f32_16x16x32_bf16 v[92:95], v[24:27], a[36:39], v[92:95]
    ds_write_b32 v5, v166 offset:64
    ds_write_b32 v5, v167 offset:2368
    v_mfma_f32_16x16x32_bf16 v[96:99], v[56:59], a[36:39], v[96:99]
    buffer_load_dwordx4 v[160:163], v4, s[4:7], s33 offen offset:512 sc1
    v_mfma_f32_16x16x32_bf16 v[92:95], v[28:31], a[40:43], v[92:95]
    v_cvt_pk_bf16_f32 v109, v100, v101
    v_mfma_f32_16x16x32_bf16 v[96:99], v[60:63], a[40:43], v[96:99]
    v_cvt_pk_bf16_f32 v113, v102, v103
    v_mfma_f32_16x16x32_bf16 v[92:95], v[32:35], a[44:47], v[92:95]
    v_cvt_pk_bf16_f32 v117, v104, v105
    v_mfma_f32_16x16x32_bf16 v[96:99], v[64:67], a[44:47], v[96:99]
    v_cvt_pk_bf16_f32 v121, v106, v107
    v_mfma_f32_16x16x32_bf16 v[92:95], v[36:39], a[48:51], v[92:95]
    v_mfma_f32_16x16x32_bf16 v[96:99], v[68:71], a[48:51], v[96:99]
    v_mfma_f32_16x16x32_bf16 v[92:95], v[40:43], a[52:55], v[92:95]
    v_mfma_f32_16x16x32_bf16 v[96:99], v[72:75], a[52:55], v[96:99]
    v_mfma_f32_16x16x32_bf16 v[92:95], v[44:47], a[56:59], v[92:95]
    v_mfma_f32_16x16x32_bf16 v[96:99], v[76:79], a[56:59], v[96:99]
    buffer_load_dword v10, v9, s[4:7], s37 offen offset:0 sc1
    v_mfma_f32_16x16x32_bf16 v[92:95], v[48:51], a[60:63], v[92:95]
L_rsc_33:
    s_waitcnt vmcnt(1)
    v_mfma_f32_16x16x32_bf16 v[168:171], v[16:19], v[144:147], 0
    v_bitop3_b32 v176, v144, v148, s51 bitop3:0x7e
    v_bitop3_b32 v177, v152, v156, s51 bitop3:0x7e
    v_mfma_f32_16x16x32_bf16 v[168:171], v[16:19], v[148:151], v[168:171]
    v_bitop3_b32 v178, v160, v161, s51 bitop3:0x7e
    v_bitop3_b32 v179, v162, v163, s51 bitop3:0x7e
    v_mfma_f32_16x16x32_bf16 v[168:171], v[16:19], v[152:155], v[168:171]
    v_or3_b32 v177, v177, v178, v179
    v_bitop3_b32 v176, v176, v177, 1 bitop3:0xa8
    v_mfma_f32_16x16x32_bf16 v[168:171], v[16:19], v[156:159], v[168:171]
    v_cmp_ne_u32 vcc, 0, v176
    v_mfma_f32_16x16x32_bf16 v[172:175], v[16:19], v[160:163], 0
    s_cbranch_vccnz L_rsr_32
    v_mfma_f32_16x16x32_bf16 v[96:99], v[80:83], a[60:63], v[96:99]
    v_mfma_f32_16x16x32_bf16 v[100:103], v[20:23], a[64:67], 0
    s_nop 2
    ds_write_b32 v5, v168 offset:256
    v_mfma_f32_16x16x32_bf16 v[104:107], v[52:55], a[64:67], 0
    ds_write_b32 v5, v169 offset:2560
    ds_write_b32 v5, v170 offset:320
    ds_write_b32 v5, v171 offset:2624
    v_mfma_f32_16x16x32_bf16 v[100:103], v[24:27], a[68:71], v[100:103]
    v_add_f32_dpp v172, v172, v172 row_ror:4 row_mask:0xf bank_mask:0xf
    v_add_f32_dpp v173, v173, v173 row_ror:4 row_mask:0xf bank_mask:0xf
    v_add_f32_dpp v174, v174, v174 row_ror:4 row_mask:0xf bank_mask:0xf
    v_mfma_f32_16x16x32_bf16 v[104:107], v[56:59], a[68:71], v[104:107]
    v_add_f32_dpp v175, v175, v175 row_ror:4 row_mask:0xf bank_mask:0xf
    v_add_f32_dpp v172, v172, v172 row_ror:8 row_mask:0xf bank_mask:0xf
    v_add_f32_dpp v173, v173, v173 row_ror:8 row_mask:0xf bank_mask:0xf
    v_mfma_f32_16x16x32_bf16 v[100:103], v[28:31], a[72:75], v[100:103]
    v_cvt_pk_bf16_f32 v110, v92, v93
    v_add_f32_dpp v174, v174, v174 row_ror:8 row_mask:0xf bank_mask:0xf
    v_add_f32_dpp v175, v175, v175 row_ror:8 row_mask:0xf bank_mask:0xf
    v_mfma_f32_16x16x32_bf16 v[104:107], v[60:63], a[72:75], v[104:107]
    v_cvt_pk_bf16_f32 v114, v94, v95
    ds_write_b32 v6, v172 offset:512
    ds_write_b32 v6, v173 offset:2816
    v_mfma_f32_16x16x32_bf16 v[100:103], v[32:35], a[76:79], v[100:103]
    v_cvt_pk_bf16_f32 v118, v96, v97
    ds_write_b32 v6, v174 offset:516
    ds_write_b32 v6, v175 offset:2820
    v_mfma_f32_16x16x32_bf16 v[104:107], v[64:67], a[76:79], v[104:107]
    v_cvt_pk_bf16_f32 v122, v98, v99
    v_mfma_f32_16x16x32_bf16 v[100:103], v[36:39], a[80:83], v[100:103]
    s_waitcnt lgkmcnt(0)
    s_barrier
    v_mfma_f32_16x16x32_bf16 v[104:107], v[68:71], a[80:83], v[104:107]
    ds_read_b128 v[154:157], v7
    ds_read_b128 v[158:161], v7 offset:16
    ds_read_b32 v162, v11
    v_mfma_f32_16x16x32_bf16 v[100:103], v[40:43], a[84:87], v[100:103]
    v_lshlrev_b32 v144, 16, v180
    v_and_b32 v145, 0xffff0000, v180
    v_lshlrev_b32 v146, 16, v181
    v_mfma_f32_16x16x32_bf16 v[104:107], v[72:75], a[84:87], v[104:107]
    v_and_b32 v147, 0xffff0000, v181
    v_lshlrev_b32 v148, 16, v182
    v_and_b32 v149, 0xffff0000, v182
    v_mfma_f32_16x16x32_bf16 v[100:103], v[44:47], a[88:91], v[100:103]
    v_lshlrev_b32 v150, 16, v183
    v_and_b32 v151, 0xffff0000, v183
    v_lshlrev_b32 v152, 16, v184
    v_mfma_f32_16x16x32_bf16 v[104:107], v[76:79], a[88:91], v[104:107]
    s_waitcnt lgkmcnt(2)
    v_add_f32 v154, v154, v144
    v_add_f32 v155, v155, v145
    v_mfma_f32_16x16x32_bf16 v[100:103], v[48:51], a[92:95], v[100:103]
    v_add_f32 v156, v156, v146
    v_add_f32 v157, v157, v147
    s_waitcnt lgkmcnt(1)
    v_add_f32 v158, v158, v148
    v_mfma_f32_16x16x32_bf16 v[104:107], v[80:83], a[92:95], v[104:107]
    v_add_f32 v159, v159, v149
    v_add_f32 v160, v160, v150
    v_add_f32 v161, v161, v151
    v_mfma_f32_16x16x32_bf16 v[92:95], v[20:23], a[96:99], 0
    s_waitcnt lgkmcnt(0)
    v_add_f32 v162, v162, v152
    v_add_f32 v176, v154, v155
    v_mfma_f32_16x16x32_bf16 v[96:99], v[52:55], a[96:99], 0
    v_mul_f32 v177, v154, v154
    v_fmac_f32 v177, v155, v155
    v_add_f32 v176, v176, v156
    v_mfma_f32_16x16x32_bf16 v[92:95], v[24:27], a[100:103], v[92:95]
    v_fmac_f32 v177, v156, v156
    v_add_f32 v176, v176, v157
    v_fmac_f32 v177, v157, v157
    v_mfma_f32_16x16x32_bf16 v[96:99], v[56:59], a[100:103], v[96:99]
    v_add_f32 v176, v176, v158
    v_fmac_f32 v177, v158, v158
    v_add_f32 v176, v176, v159
    v_mfma_f32_16x16x32_bf16 v[92:95], v[28:31], a[104:107], v[92:95]
    v_cvt_pk_bf16_f32 v111, v100, v101
    v_fmac_f32 v177, v159, v159
    v_add_f32 v176, v176, v160
    v_mfma_f32_16x16x32_bf16 v[96:99], v[60:63], a[104:107], v[96:99]
    buffer_store_dwordx4 v[108:111], v1, s[4:7], s32 offen offset:0
    v_mfma_f32_16x16x32_bf16 v[92:95], v[32:35], a[108:111], v[92:95]
    v_fmac_f32 v177, v160, v160
    v_add_f32 v176, v176, v161
    v_fmac_f32 v177, v161, v161
    v_mfma_f32_16x16x32_bf16 v[96:99], v[64:67], a[108:111], v[96:99]
    v_cvt_pk_bf16_f32 v115, v102, v103
    v_add_f32 v176, v176, v162
    v_fmac_f32 v177, v162, v162
    v_mfma_f32_16x16x32_bf16 v[92:95], v[36:39], a[112:115], v[92:95]
    buffer_store_dwordx4 v[112:115], v1, s[4:7], s61 offen offset:0
    v_mfma_f32_16x16x32_bf16 v[96:99], v[68:71], a[112:115], v[96:99]
    v_add_f32_dpp v176, v176, v176 quad_perm:[1,0,3,2] row_mask:0xf bank_mask:0xf
    v_add_f32_dpp v177, v177, v177 quad_perm:[1,0,3,2] row_mask:0xf bank_mask:0xf
    s_nop 0
    v_add_f32_dpp v176, v176, v176 quad_perm:[2,3,0,1] row_mask:0xf bank_mask:0xf
    v_mfma_f32_16x16x32_bf16 v[92:95], v[40:43], a[116:119], v[92:95]
    v_cvt_pk_bf16_f32 v119, v104, v105
    v_add_f32_dpp v177, v177, v177 quad_perm:[2,3,0,1] row_mask:0xf bank_mask:0xf
    v_add_f32_dpp v176, v176, v176 row_half_mirror row_mask:0xf bank_mask:0xf
    v_mfma_f32_16x16x32_bf16 v[96:99], v[72:75], a[116:119], v[96:99]
    buffer_store_dwordx4 v[116:119], v1, s[4:7], s62 offen offset:0
    v_mfma_f32_16x16x32_bf16 v[92:95], v[44:47], a[120:123], v[92:95]
    v_add_f32_dpp v177, v177, v177 row_half_mirror row_mask:0xf bank_mask:0xf
    v_add_f32_dpp v176, v176, v176 row_mirror row_mask:0xf bank_mask:0xf
    s_nop 0
    v_add_f32_dpp v177, v177, v177 row_mirror row_mask:0xf bank_mask:0xf
    v_mfma_f32_16x16x32_bf16 v[96:99], v[76:79], a[120:123], v[96:99]
    v_cvt_pk_bf16_f32 v123, v106, v107
    v_mov_b32 v179, 0x3727c5ac
    v_permlane16_swap_b32 v176, v177
    v_mfma_f32_16x16x32_bf16 v[92:95], v[48:51], a[124:127], v[92:95]
    buffer_store_dwordx4 v[120:123], v1, s[4:7], s63 offen offset:0
    v_mfma_f32_16x16x32_bf16 v[96:99], v[80:83], a[124:127], v[96:99]
    s_waitcnt vmcnt(4)
    v_cmp_eq_u32 vcc, 0, v10
    s_nop 0
    s_cmp_eq_u64 vcc, 0
    s_cselect_b32 s10, s47, 0
    v_mfma_f32_16x16x32_bf16 v[100:103], v[20:23], a[128:131], 0
    s_mov_b32 m0, s43
    v_add_f32 v176, v176, v177
    v_mov_b32 v178, v176
    v_mfma_f32_16x16x32_bf16 v[104:107], v[52:55], a[128:131], 0
    buffer_load_dwordx4 v0, s[8:11], s38 offen offset:0 sc1 lds
    v_mfma_f32_16x16x32_bf16 v[100:103], v[24:27], a[132:135], v[100:103]
    s_add_u32 s34, s34, 36864
    v_permlane32_swap_b32 v176, v178
    v_add_f32 v176, v176, v178
    v_mfma_f32_16x16x32_bf16 v[104:107], v[56:59], a[132:135], v[104:107]
    v_mul_f32 v176, 0x3ae38e39, v176
    s_nop 0
    v_readlane_b32 s60, v176, 0
    v_mfma_f32_16x16x32_bf16 v[100:103], v[28:31], a[136:139], v[100:103]
    buffer_load_dwordx4 v0, s[8:11], s38 offen offset:1024 sc1 lds
    v_mfma_f32_16x16x32_bf16 v[104:107], v[60:63], a[136:139], v[104:107]
    v_cvt_pk_bf16_f32 v108, v92, v93
    v_readlane_b32 s28, v176, 16
    s_nop 1
    v_add_f32 v179, s28, v179
    v_mfma_f32_16x16x32_bf16 v[100:103], v[32:35], a[140:143], v[100:103]
    v_bfi_b32 v108, 1, s31, v108
    v_fma_f32 v179, -v176, s60, v179
    v_mfma_f32_16x16x32_bf16 v[104:107], v[64:67], a[140:143], v[104:107]
    buffer_load_dwordx4 v0, s[8:11], s38 offen offset:2048 sc1 lds
    v_mfma_f32_16x16x32_bf16 v[100:103], v[36:39], a[144:147], v[100:103]
    v_cvt_pk_bf16_f32 v112, v94, v95
    v_rsq_f32 v179, v179
    v_mfma_f32_16x16x32_bf16 v[104:107], v[68:71], a[144:147], v[104:107]
    v_bfi_b32 v112, 1, s31, v112
    s_andn2_b32 s60, s60, s58
    v_readlane_b32 s28, v179, 0
    v_mfma_f32_16x16x32_bf16 v[100:103], v[40:43], a[148:151], v[100:103]
    buffer_load_dwordx4 v0, s[8:11], s38 offen offset:3072 sc1 lds
    v_mfma_f32_16x16x32_bf16 v[104:107], v[72:75], a[148:151], v[104:107]
    v_cvt_pk_bf16_f32 v116, v96, v97
    s_andn2_b32 s28, s28, s58
    s_or_b32 s28, s28, s59
    v_mfma_f32_16x16x32_bf16 v[100:103], v[44:47], a[152:155], v[100:103]
    v_bfi_b32 v116, 1, s31, v116
    v_mov_b32 v178, s28
    v_mul_f32 v179, s60, v178
    v_mfma_f32_16x16x32_bf16 v[104:107], v[76:79], a[152:155], v[104:107]
    v_cvt_pk_bf16_f32 v120, v98, v99
    v_fma_f32 v154, v154, v178, -v179
    v_fma_f32 v155, v155, v178, -v179
    v_mfma_f32_16x16x32_bf16 v[100:103], v[48:51], a[156:159], v[100:103]
    v_bfi_b32 v120, 1, s31, v120
    v_fma_f32 v156, v156, v178, -v179
    v_fma_f32 v157, v157, v178, -v179
    v_mfma_f32_16x16x32_bf16 v[104:107], v[80:83], a[156:159], v[104:107]
    v_fma_f32 v158, v158, v178, -v179
    v_fma_f32 v159, v159, v178, -v179
    v_fma_f32 v160, v160, v178, -v179
    v_mfma_f32_16x16x32_bf16 v[92:95], v[20:23], a[160:163], 0
    v_fma_f32 v161, v161, v178, -v179
    v_fma_f32 v162, v162, v178, -v179
    v_cvt_pk_bf16_f32 v144, v154, v155
    v_mfma_f32_16x16x32_bf16 v[96:99], v[52:55], a[160:163], 0
    v_cvt_pk_bf16_f32 v145, v156, v157
    v_cvt_pk_bf16_f32 v146, v158, v159
    v_cvt_pk_bf16_f32 v147, v160, v161
    v_mfma_f32_16x16x32_bf16 v[92:95], v[24:27], a[164:167], v[92:95]
    v_cvt_pk_bf16_f32 v148, v162, 0
    buffer_store_dwordx4 v[144:147], v0, s[4:7], s35 offen sc1
    v_mfma_f32_16x16x32_bf16 v[96:99], v[56:59], a[164:167], v[96:99]
    buffer_store_short v148, v8, s[4:7], s35 offen offset:1024 sc1
    v_mfma_f32_16x16x32_bf16 v[92:95], v[28:31], a[168:171], v[92:95]
    v_cvt_pk_bf16_f32 v109, v100, v101
    s_add_u32 s35, s35, 36864
    s_xor_b32 s33, s33, s41
    v_mfma_f32_16x16x32_bf16 v[96:99], v[60:63], a[168:171], v[96:99]
    v_cvt_pk_bf16_f32 v113, v102, v103
    s_add_u32 s64, s33, 9216
    s_add_u32 s65, s33, 18432
    v_mfma_f32_16x16x32_bf16 v[92:95], v[32:35], a[172:175], v[92:95]
    v_cvt_pk_bf16_f32 v117, v104, v105
    s_add_u32 s66, s33, 27648
    v_mfma_f32_16x16x32_bf16 v[96:99], v[64:67], a[172:175], v[96:99]
    v_cvt_pk_bf16_f32 v121, v106, v107
    v_mfma_f32_16x16x32_bf16 v[92:95], v[36:39], a[176:179], v[92:95]
    v_mfma_f32_16x16x32_bf16 v[96:99], v[68:71], a[176:179], v[96:99]
    v_mfma_f32_16x16x32_bf16 v[92:95], v[40:43], a[180:183], v[92:95]
    v_mfma_f32_16x16x32_bf16 v[96:99], v[72:75], a[180:183], v[96:99]
    v_mfma_f32_16x16x32_bf16 v[92:95], v[44:47], a[184:187], v[92:95]
    v_mfma_f32_16x16x32_bf16 v[96:99], v[76:79], a[184:187], v[96:99]
    v_mfma_f32_16x16x32_bf16 v[92:95], v[48:51], a[188:191], v[92:95]
    v_mfma_f32_16x16x32_bf16 v[96:99], v[80:83], a[188:191], v[96:99]
    v_mfma_f32_16x16x32_bf16 v[100:103], v[20:23], a[192:195], 0
    v_mfma_f32_16x16x32_bf16 v[104:107], v[52:55], a[192:195], 0
    buffer_load_dwordx4 v[180:183], v0, s[12:15], s34 offen sc1
    buffer_load_ushort v184, v8, s[12:15], s34 offen offset:1024 sc1
    v_mfma_f32_16x16x32_bf16 v[100:103], v[24:27], a[196:199], v[100:103]
    v_mfma_f32_16x16x32_bf16 v[104:107], v[56:59], a[196:199], v[104:107]
    v_mfma_f32_16x16x32_bf16 v[100:103], v[28:31], a[200:203], v[100:103]
    v_cvt_pk_bf16_f32 v110, v92, v93
    v_mfma_f32_16x16x32_bf16 v[104:107], v[60:63], a[200:203], v[104:107]
    v_cvt_pk_bf16_f32 v114, v94, v95
    v_mfma_f32_16x16x32_bf16 v[100:103], v[32:35], a[204:207], v[100:103]
    v_cvt_pk_bf16_f32 v118, v96, v97
    v_mfma_f32_16x16x32_bf16 v[104:107], v[64:67], a[204:207], v[104:107]
    v_cvt_pk_bf16_f32 v122, v98, v99
    v_mfma_f32_16x16x32_bf16 v[100:103], v[36:39], a[208:211], v[100:103]
    v_mfma_f32_16x16x32_bf16 v[104:107], v[68:71], a[208:211], v[104:107]
    v_mfma_f32_16x16x32_bf16 v[100:103], v[40:43], a[212:215], v[100:103]
    v_mfma_f32_16x16x32_bf16 v[104:107], v[72:75], a[212:215], v[104:107]
    v_mfma_f32_16x16x32_bf16 v[100:103], v[44:47], a[216:219], v[100:103]
    v_mfma_f32_16x16x32_bf16 v[104:107], v[76:79], a[216:219], v[104:107]
    v_mfma_f32_16x16x32_bf16 v[100:103], v[48:51], a[220:223], v[100:103]
    v_mfma_f32_16x16x32_bf16 v[104:107], v[80:83], a[220:223], v[104:107]
    v_mfma_f32_16x16x32_bf16 v[92:95], v[20:23], a[224:227], 0
    v_mfma_f32_16x16x32_bf16 v[96:99], v[52:55], a[224:227], 0
    v_mfma_f32_16x16x32_bf16 v[92:95], v[24:27], a[228:231], v[92:95]
    v_mfma_f32_16x16x32_bf16 v[96:99], v[56:59], a[228:231], v[96:99]
    v_mfma_f32_16x16x32_bf16 v[92:95], v[28:31], a[232:235], v[92:95]
    s_nop 1
    v_cvt_pk_bf16_f32 v111, v100, v101
    v_mfma_f32_16x16x32_bf16 v[96:99], v[60:63], a[232:235], v[96:99]
    buffer_store_dwordx4 v[108:111], v1, s[4:7], s32 offen offset:256
    v_mfma_f32_16x16x32_bf16 v[92:95], v[32:35], a[236:239], v[92:95]
    v_mfma_f32_16x16x32_bf16 v[96:99], v[64:67], a[236:239], v[96:99]
    v_cvt_pk_bf16_f32 v115, v102, v103
    v_mfma_f32_16x16x32_bf16 v[92:95], v[36:39], a[240:243], v[92:95]
    buffer_store_dwordx4 v[112:115], v1, s[4:7], s61 offen offset:256
    v_mfma_f32_16x16x32_bf16 v[96:99], v[68:71], a[240:243], v[96:99]
    v_mfma_f32_16x16x32_bf16 v[92:95], v[40:43], a[244:247], v[92:95]
    v_cvt_pk_bf16_f32 v119, v104, v105
    v_mfma_f32_16x16x32_bf16 v[96:99], v[72:75], a[244:247], v[96:99]
    buffer_store_dwordx4 v[116:119], v1, s[4:7], s62 offen offset:256
    v_mfma_f32_16x16x32_bf16 v[92:95], v[44:47], a[248:251], v[92:95]
    v_mfma_f32_16x16x32_bf16 v[96:99], v[76:79], a[248:251], v[96:99]
    v_cvt_pk_bf16_f32 v123, v106, v107
    v_mfma_f32_16x16x32_bf16 v[92:95], v[48:51], a[252:255], v[92:95]
    buffer_store_dwordx4 v[120:123], v1, s[4:7], s63 offen offset:256
    v_mfma_f32_16x16x32_bf16 v[96:99], v[80:83], a[252:255], v[96:99]
    s_waitcnt vmcnt(6)
    s_mov_b64 exec, 1
    buffer_store_dword v7, off, s[4:7], s36 sc1
    s_mov_b64 exec, -1
    s_add_u32 s36, s36, 4
    s_mov_b32 s51, s31
    s_mov_b32 s67, s32
    s_mov_b32 s23, 32768
    s_xor_b32 s32, s32, s53
L_oproj_end:
    v_add_u32 v14, s44, v14
    s_sub_u32 s44, 0, s44
    s_waitcnt vmcnt(6)
    s_add_u32 s30, s30, 1
    s_cmp_lg_u32 s10, 0
    s_cbranch_scc1 L_oproj_carry
    v_cvt_pk_bf16_f32 v124, v92, v93
    v_bfi_b32 v124, 1, s51, v124
    buffer_store_dword v124, v2, s[4:7], s67 offen offset:512
    v_cvt_pk_bf16_f32 v125, v94, v95
    v_bfi_b32 v125, 1, s51, v125
    buffer_store_dword v125, v2, s[4:7], s61 offen offset:512
    v_cvt_pk_bf16_f32 v126, v96, v97
    v_bfi_b32 v126, 1, s51, v126
    buffer_store_dword v126, v2, s[4:7], s62 offen offset:512
    v_cvt_pk_bf16_f32 v127, v98, v99
    v_bfi_b32 v127, 1, s51, v127
    buffer_store_dword v127, v2, s[4:7], s63 offen offset:512
    s_cmp_eq_u32 s30, 64
    s_cbranch_scc1 L_oproj_last
    s_mov_b32 s23, 32768
    s_mov_b32 s29, 11
L_spin_34:
    s_sub_u32 s23, s23, 1
    s_cbranch_scc1 L_abort
    s_sleep 2
    buffer_load_dword v10, v9, s[4:7], s37 offen offset:0 sc1
    s_waitcnt vmcnt(0)
    v_cmp_eq_u32 vcc, 0, v10
    s_cbranch_vccnz L_spin_34
    s_mov_b32 m0, s43
    s_nop 0
    buffer_load_dwordx4 v0, s[4:7], s38 offen offset:0 sc1 lds
    buffer_load_dwordx4 v0, s[4:7], s38 offen offset:1024 sc1 lds
    buffer_load_dwordx4 v0, s[4:7], s38 offen offset:2048 sc1 lds
    buffer_load_dwordx4 v0, s[4:7], s38 offen offset:3072 sc1 lds
    s_waitcnt vmcnt(0)
    s_branch L_oproj_carry
L_oproj_last:
    s_barrier
    buffer_load_dwordx4 v[128:131], v3, s[4:7], s33 offen offset:0 sc1
    buffer_load_dwordx4 v[132:135], v3, s[4:7], s64 offen offset:0 sc1
    buffer_load_dwordx4 v[136:139], v3, s[4:7], s65 offen offset:0 sc1
    buffer_load_dwordx4 v[140:143], v3, s[4:7], s66 offen offset:0 sc1
L_rsc_36:
    s_waitcnt vmcnt(0)
    v_mfma_f32_16x16x32_bf16 v[164:167], v[16:19], v[128:131], 0
    v_bitop3_b32 v176, v128, v132, s51 bitop3:0x7e
    v_bitop3_b32 v177, v136, v140, s51 bitop3:0x7e
    v_mfma_f32_16x16x32_bf16 v[164:167], v[16:19], v[132:135], v[164:167]
    v_bitop3_b32 v176, v176, v177, 1 bitop3:0xa8
    v_cmp_ne_u32 vcc, 0, v176
    v_mfma_f32_16x16x32_bf16 v[164:167], v[16:19], v[136:139], v[164:167]
    v_mfma_f32_16x16x32_bf16 v[164:167], v[16:19], v[140:143], v[164:167]
    s_cbranch_vccnz L_rsr_35
    buffer_load_dwordx4 v[144:147], v3, s[4:7], s33 offen offset:256 sc1
    buffer_load_dwordx4 v[148:151], v3, s[4:7], s64 offen offset:256 sc1
    buffer_load_dwordx4 v[152:155], v3, s[4:7], s65 offen offset:256 sc1
    buffer_load_dwordx4 v[156:159], v3, s[4:7], s66 offen offset:256 sc1
    buffer_load_dwordx4 v[160:163], v4, s[4:7], s33 offen offset:512 sc1
    s_nop 1
    ds_write_b32 v5, v164 offset:0
    ds_write_b32 v5, v165 offset:2304
    ds_write_b32 v5, v166 offset:64
    ds_write_b32 v5, v167 offset:2368
L_rsc_38:
    s_waitcnt vmcnt(0)
    v_mfma_f32_16x16x32_bf16 v[168:171], v[16:19], v[144:147], 0
    v_bitop3_b32 v176, v144, v148, s51 bitop3:0x7e
    v_bitop3_b32 v177, v152, v156, s51 bitop3:0x7e
    v_mfma_f32_16x16x32_bf16 v[168:171], v[16:19], v[148:151], v[168:171]
    v_bitop3_b32 v178, v160, v161, s51 bitop3:0x7e
    v_bitop3_b32 v179, v162, v163, s51 bitop3:0x7e
    v_mfma_f32_16x16x32_bf16 v[168:171], v[16:19], v[152:155], v[168:171]
    v_or3_b32 v177, v177, v178, v179
    v_bitop3_b32 v176, v176, v177, 1 bitop3:0xa8
    v_mfma_f32_16x16x32_bf16 v[168:171], v[16:19], v[156:159], v[168:171]
    v_cmp_ne_u32 vcc, 0, v176
    v_mfma_f32_16x16x32_bf16 v[172:175], v[16:19], v[160:163], 0
    s_cbranch_vccnz L_rsr_37
    s_nop 4
    ds_write_b32 v5, v168 offset:256
    ds_write_b32 v5, v169 offset:2560
    ds_write_b32 v5, v170 offset:320
    ds_write_b32 v5, v171 offset:2624
    v_add_f32_dpp v172, v172, v172 row_ror:4 row_mask:0xf bank_mask:0xf
    v_add_f32_dpp v173, v173, v173 row_ror:4 row_mask:0xf bank_mask:0xf
    v_add_f32_dpp v174, v174, v174 row_ror:4 row_mask:0xf bank_mask:0xf
    v_add_f32_dpp v175, v175, v175 row_ror:4 row_mask:0xf bank_mask:0xf
    v_add_f32_dpp v172, v172, v172 row_ror:8 row_mask:0xf bank_mask:0xf
    v_add_f32_dpp v173, v173, v173 row_ror:8 row_mask:0xf bank_mask:0xf
    v_add_f32_dpp v174, v174, v174 row_ror:8 row_mask:0xf bank_mask:0xf
    v_add_f32_dpp v175, v175, v175 row_ror:8 row_mask:0xf bank_mask:0xf
    ds_write_b32 v6, v172 offset:512
    ds_write_b32 v6, v173 offset:2816
    ds_write_b32 v6, v174 offset:516
    ds_write_b32 v6, v175 offset:2820
    s_waitcnt lgkmcnt(0)
    s_barrier
    ds_read_b128 v[154:157], v7
    ds_read_b128 v[158:161], v7 offset:16
    ds_read_b32 v162, v11
    v_lshlrev_b32 v144, 16, v180
    v_and_b32 v145, 0xffff0000, v180
    v_lshlrev_b32 v146, 16, v181
    v_and_b32 v147, 0xffff0000, v181
    v_lshlrev_b32 v148, 16, v182
    v_and_b32 v149, 0xffff0000, v182
    v_lshlrev_b32 v150, 16, v183
    v_and_b32 v151, 0xffff0000, v183
    v_lshlrev_b32 v152, 16, v184
    s_waitcnt lgkmcnt(2)
    v_pk_add_f32 v[154:155], v[154:155], v[144:145]
    v_pk_add_f32 v[156:157], v[156:157], v[146:147]
    s_waitcnt lgkmcnt(1)
    v_pk_add_f32 v[158:159], v[158:159], v[148:149]
    v_pk_add_f32 v[160:161], v[160:161], v[150:151]
    s_waitcnt lgkmcnt(0)
    v_add_f32 v162, v162, v152
    v_pk_add_f32 v[144:145], v[154:155], v[156:157]
    v_pk_add_f32 v[146:147], v[158:159], v[160:161]
    v_pk_mul_f32 v[148:149], v[154:155], v[154:155]
    v_pk_add_f32 v[144:145], v[144:145], v[146:147]
    v_pk_fma_f32 v[148:149], v[156:157], v[156:157], v[148:149]
    v_pk_fma_f32 v[148:149], v[158:159], v[158:159], v[148:149]
    v_pk_fma_f32 v[148:149], v[160:161], v[160:161], v[148:149]
    v_add_f32 v176, v144, v145
    v_fma_f32 v177, v162, v162, v148
    v_add_f32 v176, v176, v162
    v_add_f32 v177, v177, v149
    s_nop 0
    v_add_f32_dpp v176, v176, v176 quad_perm:[1,0,3,2] row_mask:0xf bank_mask:0xf
    v_add_f32_dpp v177, v177, v177 quad_perm:[1,0,3,2] row_mask:0xf bank_mask:0xf
    s_nop 0
    v_add_f32_dpp v176, v176, v176 quad_perm:[2,3,0,1] row_mask:0xf bank_mask:0xf
    v_add_f32_dpp v177, v177, v177 quad_perm:[2,3,0,1] row_mask:0xf bank_mask:0xf
    s_nop 0
    v_add_f32_dpp v176, v176, v176 row_half_mirror row_mask:0xf bank_mask:0xf
    v_add_f32_dpp v177, v177, v177 row_half_mirror row_mask:0xf bank_mask:0xf
    s_nop 0
    v_add_f32_dpp v176, v176, v176 row_mirror row_mask:0xf bank_mask:0xf
    v_add_f32_dpp v177, v177, v177 row_mirror row_mask:0xf bank_mask:0xf
    v_mov_b32 v179, 0x3727c5ac
    s_nop 0
    v_permlane16_swap_b32 v176, v177
    v_add_f32 v176, v176, v177
    v_mov_b32 v178, v176
    s_add_u32 s34, s34, 36864
    s_nop 0
    v_permlane32_swap_b32 v176, v178
    v_add_f32 v176, v176, v178
    v_mul_f32 v176, 0x3ae38e39, v176
    s_nop 0
    v_readlane_b32 s60, v176, 0
    v_readlane_b32 s28, v176, 16
    s_nop 1
    v_add_f32 v179, s28, v179
    v_fma_f32 v179, -v176, s60, v179
    v_rsq_f32 v179, v179
    s_andn2_b32 s60, s60, s58
    v_readlane_b32 s28, v179, 0
    s_nop 0
    s_andn2_b32 s28, s28, s58
    s_or_b32 s28, s28, s59
    v_mov_b32 v178, s28
    v_mul_f32 v179, s60, v178
    v_pk_fma_f32 v[154:155], v[154:155], v[178:179], v[178:179] op_sel:[0,0,1] op_sel_hi:[1,0,1] neg_lo:[0,0,1] neg_hi:[0,0,1]
    v_pk_fma_f32 v[156:157], v[156:157], v[178:179], v[178:179] op_sel:[0,0,1] op_sel_hi:[1,0,1] neg_lo:[0,0,1] neg_hi:[0,0,1]
    v_pk_fma_f32 v[158:159], v[158:159], v[178:179], v[178:179] op_sel:[0,0,1] op_sel_hi:[1,0,1] neg_lo:[0,0,1] neg_hi:[0,0,1]
    v_pk_fma_f32 v[160:161], v[160:161], v[178:179], v[178:179] op_sel:[0,0,1] op_sel_hi:[1,0,1] neg_lo:[0,0,1] neg_hi:[0,0,1]
    v_fma_f32 v162, v162, v178, -v179
    v_cvt_pk_bf16_f32 v144, v154, v155
    v_cvt_pk_bf16_f32 v145, v156, v157
    v_cvt_pk_bf16_f32 v146, v158, v159
    v_cvt_pk_bf16_f32 v147, v160, v161
    v_cvt_pk_bf16_f32 v148, v162, 0
    buffer_store_dwordx4 v[144:147], v0, s[4:7], s35 offen sc1
    buffer_store_short v148, v8, s[4:7], s35 offen offset:1024 sc1
    s_add_u32 s35, s35, 36864
    s_waitcnt vmcnt(0)
    s_mov_b64 exec, 1
    buffer_store_dword v7, off, s[4:7], s36 sc1
    s_mov_b64 exec, -1
    s_add_u32 s36, s36, 4
    s_endpgm
L_rsr_30:
    s_mov_b32 s29, 12
    s_sub_u32 s23, s23, 1
    s_cbranch_scc1 L_abort
    s_nop 7
    buffer_load_dwordx4 v[128:131], v3, s[4:7], s33 offen offset:0 sc1
    buffer_load_dwordx4 v[132:135], v3, s[4:7], s64 offen offset:0 sc1
    buffer_load_dwordx4 v[136:139], v3, s[4:7], s65 offen offset:0 sc1
    buffer_load_dwordx4 v[140:143], v3, s[4:7], s66 offen offset:0 sc1
    s_waitcnt vmcnt(0)
    s_branch L_rsc_31
L_rsr_32:
    s_mov_b32 s29, 12
    s_sub_u32 s23, s23, 1
    s_cbranch_scc1 L_abort
    s_nop 7
    buffer_load_dwordx4 v[144:147], v3, s[4:7], s33 offen offset:256 sc1
    buffer_load_dwordx4 v[148:151], v3, s[4:7], s64 offen offset:256 sc1
    buffer_load_dwordx4 v[152:155], v3, s[4:7], s65 offen offset:256 sc1
    buffer_load_dwordx4 v[156:159], v3, s[4:7], s66 offen offset:256 sc1
    buffer_load_dwordx4 v[160:163], v4, s[4:7], s33 offen offset:512 sc1
    s_waitcnt vmcnt(0)
    s_branch L_rsc_33
L_rsr_35:
    s_mov_b32 s29, 12
    s_sub_u32 s23, s23, 1
    s_cbranch_scc1 L_abort
    s_nop 7
    buffer_load_dwordx4 v[128:131], v3, s[4:7], s33 offen offset:0 sc1
    buffer_load_dwordx4 v[132:135], v3, s[4:7], s64 offen offset:0 sc1
    buffer_load_dwordx4 v[136:139], v3, s[4:7], s65 offen offset:0 sc1
    buffer_load_dwordx4 v[140:143], v3, s[4:7], s66 offen offset:0 sc1
    s_waitcnt vmcnt(0)
    s_branch L_rsc_36
L_rsr_37:
    s_mov_b32 s29, 12
    s_sub_u32 s23, s23, 1
    s_cbranch_scc1 L_abort
    s_nop 7
    buffer_load_dwordx4 v[144:147], v3, s[4:7], s33 offen offset:256 sc1
    buffer_load_dwordx4 v[148:151], v3, s[4:7], s64 offen offset:256 sc1
    buffer_load_dwordx4 v[152:155], v3, s[4:7], s65 offen offset:256 sc1
    buffer_load_dwordx4 v[156:159], v3, s[4:7], s66 offen offset:256 sc1
    buffer_load_dwordx4 v[160:163], v4, s[4:7], s33 offen offset:512 sc1
    s_waitcnt vmcnt(0)
    s_branch L_rsc_38
L_up:
    s_waitcnt vmcnt(0)
    s_barrier
    s_cmp_lg_u32 s20, 0
    s_cbranch_scc1 L_arr_39
    s_mov_b64 exec, 1
    v_mov_b32 v2, 1
    buffer_atomic_add v2, off, s[16:19], 0 offset:16 sc1
    s_mov_b64 exec, -1
L_arr_39:
    s_lshl_b32 s35, s20, 10
    s_mul_i32 s36, s20, 9216
    s_load_dwordx2 s[12:13], s[0:1], 0
    s_mov_b32 s14, 2359296
    s_mov_b32 s15, 0x20000
    s_waitcnt lgkmcnt(0)
    s_lshl_b32 s60, s24, 5
    s_add_u32 s60, s60, s21
    s_add_u32 s60, s60, 0
    s_mul_i32 s61, s60, 36864
    s_mul_i32 s28, s20, 9216
    s_add_u32 s61, s61, s28
    v_lshrrev_b32 v140, 3, v0
    v_mul_u32_u24 v140, 1152, v140
    v_and_b32 v141, 7, v0
    v_lshl_add_u32 v140, v141, 4, v140
    buffer_load_dwordx4 v[16:19], v140, s[12:15], s61 offen offset:0
    buffer_load_dwordx4 v[20:23], v140, s[12:15], s61 offen offset:128
    buffer_load_dwordx4 v[24:27], v140, s[12:15], s61 offen offset:256
    buffer_load_dwordx4 v[28:31], v140, s[12:15], s61 offen offset:384
    buffer_load_dwordx4 v[32:35], v140, s[12:15], s61 offen offset:512
    buffer_load_dwordx4 v[36:39], v140, s[12:15], s61 offen offset:640
    buffer_load_dwordx4 v[40:43], v140, s[12:15], s61 offen offset:768
    buffer_load_dwordx4 v[44:47], v140, s[12:15], s61 offen offset:896
    buffer_load_dwordx4 v[48:51], v140, s[12:15], s61 offen offset:1024
    s_waitcnt vmcnt(8)
    v_lshlrev_b32 v64, 16, v16
    v_and_b32 v65, 0xffff0000, v16
    v_lshlrev_b32 v66, 16, v17
    v_and_b32 v67, 0xffff0000, v17
    v_lshlrev_b32 v68, 16, v18
    v_and_b32 v69, 0xffff0000, v18
    v_lshlrev_b32 v70, 16, v19
    v_and_b32 v71, 0xffff0000, v19
    s_waitcnt vmcnt(7)
    v_lshlrev_b32 v72, 16, v20
    v_and_b32 v73, 0xffff0000, v20
    v_lshlrev_b32 v74, 16, v21
    v_and_b32 v75, 0xffff0000, v21
    v_lshlrev_b32 v76, 16, v22
    v_and_b32 v77, 0xffff0000, v22
    v_lshlrev_b32 v78, 16, v23
    v_and_b32 v79, 0xffff0000, v23
    s_waitcnt vmcnt(6)
    v_lshlrev_b32 v80, 16, v24
    v_and_b32 v81, 0xffff0000, v24
    v_lshlrev_b32 v82, 16, v25
    v_and_b32 v83, 0xffff0000, v25
    v_lshlrev_b32 v84, 16, v26
    v_and_b32 v85, 0xffff0000, v26
    v_lshlrev_b32 v86, 16, v27
    v_and_b32 v87, 0xffff0000, v27
    s_waitcnt vmcnt(5)
    v_lshlrev_b32 v88, 16, v28
    v_and_b32 v89, 0xffff0000, v28
    v_lshlrev_b32 v90, 16, v29
    v_and_b32 v91, 0xffff0000, v29
    v_lshlrev_b32 v92, 16, v30
    v_and_b32 v93, 0xffff0000, v30
    v_lshlrev_b32 v94, 16, v31
    v_and_b32 v95, 0xffff0000, v31
    s_waitcnt vmcnt(4)
    v_lshlrev_b32 v96, 16, v32
    v_and_b32 v97, 0xffff0000, v32
    v_lshlrev_b32 v98, 16, v33
    v_and_b32 v99, 0xffff0000, v33
    v_lshlrev_b32 v100, 16, v34
    v_and_b32 v101, 0xffff0000, v34
    v_lshlrev_b32 v102, 16, v35
    v_and_b32 v103, 0xffff0000, v35
    s_waitcnt vmcnt(3)
    v_lshlrev_b32 v104, 16, v36
    v_and_b32 v105, 0xffff0000, v36
    v_lshlrev_b32 v106, 16, v37
    v_and_b32 v107, 0xffff0000, v37
    v_lshlrev_b32 v108, 16, v38
    v_and_b32 v109, 0xffff0000, v38
    v_lshlrev_b32 v110, 16, v39
    v_and_b32 v111, 0xffff0000, v39
    s_waitcnt vmcnt(2)
    v_lshlrev_b32 v112, 16, v40
    v_and_b32 v113, 0xffff0000, v40
    v_lshlrev_b32 v114, 16, v41
    v_and_b32 v115, 0xffff0000, v41
    v_lshlrev_b32 v116, 16, v42
    v_and_b32 v117, 0xffff0000, v42
    v_lshlrev_b32 v118, 16, v43
    v_and_b32 v119, 0xffff0000, v43
    s_waitcnt vmcnt(1)
    v_lshlrev_b32 v120, 16, v44
    v_and_b32 v121, 0xffff0000, v44
    v_lshlrev_b32 v122, 16, v45
    v_and_b32 v123, 0xffff0000, v45
    v_lshlrev_b32 v124, 16, v46
    v_and_b32 v125, 0xffff0000, v46
    v_lshlrev_b32 v126, 16, v47
    v_and_b32 v127, 0xffff0000, v47
    s_waitcnt vmcnt(0)
    v_lshlrev_b32 v128, 16, v48
    v_and_b32 v129, 0xffff0000, v48
    v_lshlrev_b32 v130, 16, v49
    v_and_b32 v131, 0xffff0000, v49
    v_lshlrev_b32 v132, 16, v50
    v_and_b32 v133, 0xffff0000, v50
    v_lshlrev_b32 v134, 16, v51
    v_and_b32 v135, 0xffff0000, v51
    v_add_f32 v142, v64, v65
    v_add_f32 v142, v142, v66
    v_add_f32 v142, v142, v67
    v_add_f32 v142, v142, v68
    v_add_f32 v142, v142, v69
    v_add_f32 v142, v142, v70
    v_add_f32 v142, v142, v71
    v_add_f32 v142, v142, v72
    v_add_f32 v142, v142, v73
    v_add_f32 v142, v142, v74
    v_add_f32 v142, v142, v75
    v_add_f32 v142, v142, v76
    v_add_f32 v142, v142, v77
    v_add_f32 v142, v142, v78
    v_add_f32 v142, v142, v79
    v_add_f32 v142, v142, v80
    v_add_f32 v142, v142, v81
    v_add_f32 v142, v142, v82
    v_add_f32 v142, v142, v83
    v_add_f32 v142, v142, v84
    v_add_f32 v142, v142, v85
    v_add_f32 v142, v142, v86
    v_add_f32 v142, v142, v87
    v_add_f32 v142, v142, v88
    v_add_f32 v142, v142, v89
    v_add_f32 v142, v142, v90
    v_add_f32 v142, v142, v91
    v_add_f32 v142, v142, v92
    v_add_f32 v142, v142, v93
    v_add_f32 v142, v142, v94
    v_add_f32 v142, v142, v95
    v_add_f32 v142, v142, v96
    v_add_f32 v142, v142, v97
    v_add_f32 v142, v142, v98
    v_add_f32 v142, v142, v99
    v_add_f32 v142, v142, v100
    v_add_f32 v142, v142, v101
    v_add_f32 v142, v142, v102
    v_add_f32 v142, v142, v103
    v_add_f32 v142, v142, v104
    v_add_f32 v142, v142, v105
    v_add_f32 v142, v142, v106
    v_add_f32 v142, v142, v107
    v_add_f32 v142, v142, v108
    v_add_f32 v142, v142, v109
    v_add_f32 v142, v142, v110
    v_add_f32 v142, v142, v111
    v_add_f32 v142, v142, v112
    v_add_f32 v142, v142, v113
    v_add_f32 v142, v142, v114
    v_add_f32 v142, v142, v115
    v_add_f32 v142, v142, v116
    v_add_f32 v142, v142, v117
    v_add_f32 v142, v142, v118
    v_add_f32 v142, v142, v119
    v_add_f32 v142, v142, v120
    v_add_f32 v142, v142, v121
    v_add_f32 v142, v142, v122
    v_add_f32 v142, v142, v123
    v_add_f32 v142, v142, v124
    v_add_f32 v142, v142, v125
    v_add_f32 v142, v142, v126
    v_add_f32 v142, v142, v127
    v_add_f32 v142, v142, v128
    v_add_f32 v142, v142, v129
    v_add_f32 v142, v142, v130
    v_add_f32 v142, v142, v131
    v_add_f32 v142, v142, v132
    v_add_f32 v142, v142, v133
    v_add_f32 v142, v142, v134
    v_add_f32 v142, v142, v135
    s_nop 1
    v_add_f32_dpp v142, v142, v142 quad_perm:[1,0,3,2] row_mask:0xf bank_mask:0xf
    s_nop 1
    v_add_f32_dpp v142, v142, v142 quad_perm:[2,3,0,1] row_mask:0xf bank_mask:0xf
    s_nop 1
    v_add_f32_dpp v142, v142, v142 row_half_mirror row_mask:0xf bank_mask:0xf
    v_mul_f32 v142, 0x3ae38e39, v142
    v_sub_f32 v64, v64, v142
    v_sub_f32 v65, v65, v142
    v_sub_f32 v66, v66, v142
    v_sub_f32 v67, v67, v142
    v_sub_f32 v68, v68, v142
    v_sub_f32 v69, v69, v142
    v_sub_f32 v70, v70, v142
    v_sub_f32 v71, v71, v142
    v_sub_f32 v72, v72, v142
    v_sub_f32 v73, v73, v142
    v_sub_f32 v74, v74, v142
    v_sub_f32 v75, v75, v142
    v_sub_f32 v76, v76, v142
    v_sub_f32 v77, v77, v142
    v_sub_f32 v78, v78, v142
    v_sub_f32 v79, v79, v142
    v_sub_f32 v80, v80, v142
    v_sub_f32 v81, v81, v142
    v_sub_f32 v82, v82, v142
    v_sub_f32 v83, v83, v142
    v_sub_f32 v84, v84, v142
    v_sub_f32 v85, v85, v142
    v_sub_f32 v86, v86, v142
    v_sub_f32 v87, v87, v142
    v_sub_f32 v88, v88, v142
    v_sub_f32 v89, v89, v142
    v_sub_f32 v90, v90, v142
    v_sub_f32 v91, v91, v142
    v_sub_f32 v92, v92, v142
    v_sub_f32 v93, v93, v142
    v_sub_f32 v94, v94, v142
    v_sub_f32 v95, v95, v142
    v_sub_f32 v96, v96, v142
    v_sub_f32 v97, v97, v142
    v_sub_f32 v98, v98, v142
    v_sub_f32 v99, v99, v142
    v_sub_f32 v100, v100, v142
    v_sub_f32 v101, v101, v142
    v_sub_f32 v102, v102, v142
    v_sub_f32 v103, v103, v142
    v_sub_f32 v104, v104, v142
    v_sub_f32 v105, v105, v142
    v_sub_f32 v106, v106, v142
    v_sub_f32 v107, v107, v142
    v_sub_f32 v108, v108, v142
    v_sub_f32 v109, v109, v142
    v_sub_f32 v110, v110, v142
    v_sub_f32 v111, v111, v142
    v_sub_f32 v112, v112, v142
    v_sub_f32 v113, v113, v142
    v_sub_f32 v114, v114, v142
    v_sub_f32 v115, v115, v142
    v_sub_f32 v116, v116, v142
    v_sub_f32 v117, v117, v142
    v_sub_f32 v118, v118, v142
    v_sub_f32 v119, v119, v142
    v_sub_f32 v120, v120, v142
    v_sub_f32 v121, v121, v142
    v_sub_f32 v122, v122, v142
    v_sub_f32 v123, v123, v142
    v_sub_f32 v124, v124, v142
    v_sub_f32 v125, v125, v142
    v_sub_f32 v126, v126, v142
    v_sub_f32 v127, v127, v142
    v_sub_f32 v128, v128, v142
    v_sub_f32 v129, v129, v142
    v_sub_f32 v130, v130, v142
    v_sub_f32 v131, v131, v142
    v_sub_f32 v132, v132, v142
    v_sub_f32 v133, v133, v142
    v_sub_f32 v134, v134, v142
    v_sub_f32 v135, v135, v142
    v_mul_f32 v143, v64, v64
    v_fmac_f32 v143, v65, v65
    v_fmac_f32 v143, v66, v66
    v_fmac_f32 v143, v67, v67
    v_fmac_f32 v143, v68, v68
    v_fmac_f32 v143, v69, v69
    v_fmac_f32 v143, v70, v70
    v_fmac_f32 v143, v71, v71
    v_fmac_f32 v143, v72, v72
    v_fmac_f32 v143, v73, v73
    v_fmac_f32 v143, v74, v74
    v_fmac_f32 v143, v75, v75
    v_fmac_f32 v143, v76, v76
    v_fmac_f32 v143, v77, v77
    v_fmac_f32 v143, v78, v78
    v_fmac_f32 v143, v79, v79
    v_fmac_f32 v143, v80, v80
    v_fmac_f32 v143, v81, v81
    v_fmac_f32 v143, v82, v82
    v_fmac_f32 v143, v83, v83
    v_fmac_f32 v143, v84, v84
    v_fmac_f32 v143, v85, v85
    v_fmac_f32 v143, v86, v86
    v_fmac_f32 v143, v87, v87
    v_fmac_f32 v143, v88, v88
    v_fmac_f32 v143, v89, v89
    v_fmac_f32 v143, v90, v90
    v_fmac_f32 v143, v91, v91
    v_fmac_f32 v143, v92, v92
    v_fmac_f32 v143, v93, v93
    v_fmac_f32 v143, v94, v94
    v_fmac_f32 v143, v95, v95
    v_fmac_f32 v143, v96, v96
    v_fmac_f32 v143, v97, v97
    v_fmac_f32 v143, v98, v98
    v_fmac_f32 v143, v99, v99
    v_fmac_f32 v143, v100, v100
    v_fmac_f32 v143, v101, v101
    v_fmac_f32 v143, v102, v102
    v_fmac_f32 v143, v103, v103
    v_fmac_f32 v143, v104, v104
    v_fmac_f32 v143, v105, v105
    v_fmac_f32 v143, v106, v106
    v_fmac_f32 v143, v107, v107
    v_fmac_f32 v143, v108, v108
    v_fmac_f32 v143, v109, v109
    v_fmac_f32 v143, v110, v110
    v_fmac_f32 v143, v111, v111
    v_fmac_f32 v143, v112, v112
    v_fmac_f32 v143, v113, v113
    v_fmac_f32 v143, v114, v114
    v_fmac_f32 v143, v115, v115
    v_fmac_f32 v143, v116, v116
    v_fmac_f32 v143, v117, v117
    v_fmac_f32 v143, v118, v118
    v_fmac_f32 v143, v119, v119
    v_fmac_f32 v143, v120, v120
    v_fmac_f32 v143, v121, v121
    v_fmac_f32 v143, v122, v122
    v_fmac_f32 v143, v123, v123
    v_fmac_f32 v143, v124, v124
    v_fmac_f32 v143, v125, v125
    v_fmac_f32 v143, v126, v126
    v_fmac_f32 v143, v127, v127
    v_fmac_f32 v143, v128, v128
    v_fmac_f32 v143, v129, v129
    v_fmac_f32 v143, v130, v130
    v_fmac_f32 v143, v131, v131
    v_fmac_f32 v143, v132, v132
    v_fmac_f32 v143, v133, v133
    v_fmac_f32 v143, v134, v134
    v_fmac_f32 v143, v135, v135
    s_nop 1
    v_add_f32_dpp v143, v143, v143 quad_perm:[1,0,3,2] row_mask:0xf bank_mask:0xf
    s_nop 1
    v_add_f32_dpp v143, v143, v143 quad_perm:[2,3,0,1] row_mask:0xf bank_mask:0xf
    s_nop 1
    v_add_f32_dpp v143, v143, v143 row_half_mirror row_mask:0xf bank_mask:0xf
    v_mov_b32 v142, 0x3727c5ac
    v_fmac_f32 v142, 0x3ae38e39, v143
    v_rsq_f32 v142, v142
    s_nop 0
    v_mul_f32 v64, v64, v142
    v_mul_f32 v65, v65, v142
    v_mul_f32 v66, v66, v142
    v_mul_f32 v67, v67, v142
    v_mul_f32 v68, v68, v142
    v_mul_f32 v69, v69, v142
    v_mul_f32 v70, v70, v142
    v_mul_f32 v71, v71, v142
    v_mul_f32 v72, v72, v142
    v_mul_f32 v73, v73, v142
    v_mul_f32 v74, v74, v142
    v_mul_f32 v75, v75, v142
    v_mul_f32 v76, v76, v142
    v_mul_f32 v77, v77, v142
    v_mul_f32 v78, v78, v142
    v_mul_f32 v79, v79, v142
    v_mul_f32 v80, v80, v142
    v_mul_f32 v81, v81, v142
    v_mul_f32 v82, v82, v142
    v_mul_f32 v83, v83, v142
    v_mul_f32 v84, v84, v142
    v_mul_f32 v85, v85, v142
    v_mul_f32 v86, v86, v142
    v_mul_f32 v87, v87, v142
    v_mul_f32 v88, v88, v142
    v_mul_f32 v89, v89, v142
    v_mul_f32 v90, v90, v142
    v_mul_f32 v91, v91, v142
    v_mul_f32 v92, v92, v142
    v_mul_f32 v93, v93, v142
    v_mul_f32 v94, v94, v142
    v_mul_f32 v95, v95, v142
    v_mul_f32 v96, v96, v142
    v_mul_f32 v97, v97, v142
    v_mul_f32 v98, v98, v142
    v_mul_f32 v99, v99, v142
    v_mul_f32 v100, v100, v142
    v_mul_f32 v101, v101, v142
    v_mul_f32 v102, v102, v142
    v_mul_f32 v103, v103, v142
    v_mul_f32 v104, v104, v142
    v_mul_f32 v105, v105, v142
    v_mul_f32 v106, v106, v142
    v_mul_f32 v107, v107, v142
    v_mul_f32 v108, v108, v142
    v_mul_f32 v109, v109, v142
    v_mul_f32 v110, v110, v142
    v_mul_f32 v111, v111, v142
    v_mul_f32 v112, v112, v142
    v_mul_f32 v113, v113, v142
    v_mul_f32 v114, v114, v142
    v_mul_f32 v115, v115, v142
    v_mul_f32 v116, v116, v142
    v_mul_f32 v117, v117, v142
    v_mul_f32 v118, v118, v142
    v_mul_f32 v119, v119, v142
    v_mul_f32 v120, v120, v142
    v_mul_f32 v121, v121, v142
    v_mul_f32 v122, v122, v142
    v_mul_f32 v123, v123, v142
    v_mul_f32 v124, v124, v142
    v_mul_f32 v125, v125, v142
    v_mul_f32 v126, v126, v142
    v_mul_f32 v127, v127, v142
    v_mul_f32 v128, v128, v142
    v_mul_f32 v129, v129, v142
    v_mul_f32 v130, v130, v142
    v_mul_f32 v131, v131, v142
    v_mul_f32 v132, v132, v142
    v_mul_f32 v133, v133, v142
    v_mul_f32 v134, v134, v142
    v_mul_f32 v135, v135, v142
    v_cvt_pk_bf16_f32 v16, v64, v65
    v_cvt_pk_bf16_f32 v17, v66, v67
    v_cvt_pk_bf16_f32 v18, v68, v69
    v_cvt_pk_bf16_f32 v19, v70, v71
    v_cvt_pk_bf16_f32 v20, v72, v73
    v_cvt_pk_bf16_f32 v21, v74, v75
    v_cvt_pk_bf16_f32 v22, v76, v77
    v_cvt_pk_bf16_f32 v23, v78, v79
    v_cvt_pk_bf16_f32 v24, v80, v81
    v_cvt_pk_bf16_f32 v25, v82, v83
    v_cvt_pk_bf16_f32 v26, v84, v85
    v_cvt_pk_bf16_f32 v27, v86, v87
    v_cvt_pk_bf16_f32 v28, v88, v89
    v_cvt_pk_bf16_f32 v29, v90, v91
    v_cvt_pk_bf16_f32 v30, v92, v93
    v_cvt_pk_bf16_f32 v31, v94, v95
    v_cvt_pk_bf16_f32 v32, v96, v97
    v_cvt_pk_bf16_f32 v33, v98, v99
    v_cvt_pk_bf16_f32 v34, v100, v101
    v_cvt_pk_bf16_f32 v35, v102, v103
    v_cvt_pk_bf16_f32 v36, v104, v105
    v_cvt_pk_bf16_f32 v37, v106, v107
    v_cvt_pk_bf16_f32 v38, v108, v109
    v_cvt_pk_bf16_f32 v39, v110, v111
    v_cvt_pk_bf16_f32 v40, v112, v113
    v_cvt_pk_bf16_f32 v41, v114, v115
    v_cvt_pk_bf16_f32 v42, v116, v117
    v_cvt_pk_bf16_f32 v43, v118, v119
    v_cvt_pk_bf16_f32 v44, v120, v121
    v_cvt_pk_bf16_f32 v45, v122, v123
    v_cvt_pk_bf16_f32 v46, v124, v125
    v_cvt_pk_bf16_f32 v47, v126, v127
    v_cvt_pk_bf16_f32 v48, v128, v129
    v_cvt_pk_bf16_f32 v49, v130, v131
    v_cvt_pk_bf16_f32 v50, v132, v133
    v_cvt_pk_bf16_f32 v51, v134, v135
    s_add_u32 s61, s61, 1048576
    buffer_store_dwordx4 v[16:19], v140, s[4:7], s61 offen offset:0 sc1
    buffer_store_dwordx4 v[20:23], v140, s[4:7], s61 offen offset:128 sc1
    buffer_store_dwordx4 v[24:27], v140, s[4:7], s61 offen offset:256 sc1
    buffer_store_dwordx4 v[28:31], v140, s[4:7], s61 offen offset:384 sc1
    buffer_store_dwordx4 v[32:35], v140, s[4:7], s61 offen offset:512 sc1
    buffer_store_dwordx4 v[36:39], v140, s[4:7], s61 offen offset:640 sc1
    buffer_store_dwordx4 v[40:43], v140, s[4:7], s61 offen offset:768 sc1
    buffer_store_dwordx4 v[44:47], v140, s[4:7], s61 offen offset:896 sc1
    buffer_store_dwordx4 v[48:51], v140, s[4:7], s61 offen offset:1024 sc1
    s_mov_b32 s23, 32768
    s_mov_b32 s29, 1
L_spin_40:
    s_sub_u32 s23, s23, 1
    s_cbranch_scc1 L_abort
    s_sleep 2
    s_sleep 4
    buffer_load_dword v141, off, s[16:19], 0 offset:16 sc1
    s_waitcnt vmcnt(0)
    v_cmp_gt_u32 vcc, 256, v141
    s_nop 3
    s_cbranch_vccnz L_spin_40
    v_and_b32 v140, 15, v0
    v_lshlrev_b32 v140, 9, v140
    s_lshl_b32 s61, s20, 13
    s_lshl_b32 s60, s60, 2
    s_add_u32 s61, s61, s60
    v_mov_b32 v141, 1
    s_mov_b64 exec, 0xffff
    buffer_store_dword v141, v140, s[4:7], s61 offen offset:0 sc1
    s_mov_b64 exec, -1
    s_mov_b32 s23, 32768
    s_mov_b32 s29, 1
L_spin_42:
    s_sub_u32 s23, s23, 1
    s_cbranch_scc1 L_abort
    s_sleep 2
    s_sleep 4
    buffer_load_dword v2, off, s[16:19], 0 offset:16 sc1
    s_waitcnt vmcnt(0)
    v_cmp_gt_u32 vcc, 256, v2
    s_nop 3
    s_cbranch_vccnz L_spin_42
    s_lshl_b32 s60, s24, 9
    s_add_u32 s60, s60, 114688
    s_mov_b32 s23, 32768
    s_mov_b32 s29, 30
L_spin_43:
    s_sub_u32 s23, s23, 1
    s_cbranch_scc1 L_abort
    s_sleep 2
    s_sleep 16
    buffer_load_dword v2, off, s[4:7], s60 sc1
    s_waitcnt vmcnt(0)
    v_cmp_eq_u32 vcc, 0, v2
    s_nop 3
    s_cbranch_vccnz L_spin_43
L_hold_41:
    s_lshl_b32 s28, s20, 3
    v_add_u32 v32, 0, v0
    v_mul_u32_u24 v30, 2731, v32
    v_lshrrev_b32 v30, 16, v30
    v_mul_u32_u24 v31, 24, v30
    v_sub_u32 v32, v32, v31
    v_add_u32 v30, s28, v30
    v_lshrrev_b32 v20, 1, v30
    v_and_b32 v20, 1, v20
    v_lshlrev_b32 v20, 1, v20
    v_lshrrev_b32 v31, 3, v30
    v_and_b32 v31, 1, v31
    v_lshl_or_b32 v20, v31, 2, v20
    v_xor_b32 v20, v20, v32
    v_lshlrev_b32 v20, 4, v20
    v_mul_u32_u24 v30, 9216, v30
    v_add_u32 v20, v20, v30
    v_add_u32 v32, 64, v0
    v_mul_u32_u24 v30, 2731, v32
    v_lshrrev_b32 v30, 16, v30
    v_mul_u32_u24 v31, 24, v30
    v_sub_u32 v32, v32, v31
    v_add_u32 v30, s28, v30
    v_lshrrev_b32 v21, 1, v30
    v_and_b32 v21, 1, v21
    v_lshlrev_b32 v21, 1, v21
    v_lshrrev_b32 v31, 3, v30
    v_and_b32 v31, 1, v31
    v_lshl_or_b32 v21, v31, 2, v21
    v_xor_b32 v21, v21, v32
    v_lshlrev_b32 v21, 4, v21
    v_mul_u32_u24 v30, 9216, v30
    v_add_u32 v21, v21, v30
    v_add_u32 v32, 128, v0
    v_mul_u32_u24 v30, 2731, v32
    v_lshrrev_b32 v30, 16, v30
    v_mul_u32_u24 v31, 24, v30
    v_sub_u32 v32, v32, v31
    v_add_u32 v30, s28, v30
    v_lshrrev_b32 v22, 1, v30
    v_and_b32 v22, 1, v22
    v_lshlrev_b32 v22, 1, v22
    v_lshrrev_b32 v31, 3, v30
    v_and_b32 v31, 1, v31
    v_lshl_or_b32 v22, v31, 2, v22
    v_xor_b32 v22, v22, v32
    v_lshlrev_b32 v22, 4, v22
    v_mul_u32_u24 v30, 9216, v30
    v_add_u32 v22, v22, v30
    s_mul_i32 s62, s20, 6
    v_lshrrev_b32 v30, 2, v0
    v_and_b32 v30, 3, v30
    v_lshrrev_b32 v31, 5, v0
    v_and_b32 v31, 1, v31
    v_lshl_or_b32 v30, v31, 3, v30
    v_lshrrev_b32 v32, 1, v30
    v_and_b32 v32, 1, v32
    v_lshlrev_b32 v32, 1, v32
    v_lshrrev_b32 v31, 3, v30
    v_and_b32 v31, 1, v31
    v_lshl_or_b32 v32, v31, 2, v32
    v_mul_u32_u24 v30, 384, v30
    v_bfe_u32 v31, v0, 4, 1
    v_mul_u32_u24 v31, 36864, v31
    v_add_u32 v30, v30, v31
    v_and_b32 v31, 2, v0
    v_lshl_add_u32 v30, v31, 2, v30
    v_and_b32 v31, 1, v0
    v_add_u32 v31, s62, v31
    v_add_u32 v31, 0, v31
    v_xor_b32 v31, v31, v32
    v_lshl_add_u32 v23, v31, 4, v30
    v_and_b32 v31, 1, v0
    v_add_u32 v31, s62, v31
    v_add_u32 v31, 2, v31
    v_xor_b32 v31, v31, v32
    v_lshl_add_u32 v24, v31, 4, v30
    v_and_b32 v31, 1, v0
    v_add_u32 v31, s62, v31
    v_add_u32 v31, 4, v31
    v_xor_b32 v31, v31, v32
    v_lshl_add_u32 v25, v31, 4, v30
    s_mul_i32 s60, s20, 3072
    s_mul_i32 s61, s21, 384
    s_load_dwordx2 s[8:9], s[0:1], 64
    s_mov_b32 s10, 5308416
    s_mov_b32 s11, 0x20000
    s_waitcnt lgkmcnt(0)
    s_add_u32 m0, s60, 0
    s_add_u32 s28, s61, 0
    buffer_load_dwordx4 v20, s[8:11], s28 offen lds
    s_add_u32 m0, s60, 1024
    s_add_u32 s28, s61, 0
    buffer_load_dwordx4 v21, s[8:11], s28 offen lds
    s_add_u32 m0, s60, 2048
    s_add_u32 s28, s61, 0
    buffer_load_dwordx4 v22, s[8:11], s28 offen lds
    s_add_u32 m0, s60, 12288
    s_add_u32 s28, s61, 294912
    buffer_load_dwordx4 v20, s[8:11], s28 offen lds
    s_add_u32 m0, s60, 13312
    s_add_u32 s28, s61, 294912
    buffer_load_dwordx4 v21, s[8:11], s28 offen lds
    s_add_u32 m0, s60, 14336
    s_add_u32 s28, s61, 294912
    buffer_load_dwordx4 v22, s[8:11], s28 offen lds
    s_add_u32 m0, s60, 24576
    s_add_u32 s28, s61, 589824
    buffer_load_dwordx4 v20, s[8:11], s28 offen lds
    s_add_u32 m0, s60, 25600
    s_add_u32 s28, s61, 589824
    buffer_load_dwordx4 v21, s[8:11], s28 offen lds
    s_add_u32 m0, s60, 26624
    s_add_u32 s28, s61, 589824
    buffer_load_dwordx4 v22, s[8:11], s28 offen lds
    s_load_dwordx2 s[8:9], s[0:1], 72
    s_mov_b32 s10, 5308416
    s_mov_b32 s11, 0x20000
    s_waitcnt lgkmcnt(0)
    s_add_u32 m0, s60, 36864
    s_add_u32 s28, s61, 0
    buffer_load_dwordx4 v20, s[8:11], s28 offen lds
    s_add_u32 m0, s60, 37888
    s_add_u32 s28, s61, 0
    buffer_load_dwordx4 v21, s[8:11], s28 offen lds
    s_add_u32 m0, s60, 38912
    s_add_u32 s28, s61, 0
    buffer_load_dwordx4 v22, s[8:11], s28 offen lds
    s_add_u32 m0, s60, 49152
    s_add_u32 s28, s61, 294912
    buffer_load_dwordx4 v20, s[8:11], s28 offen lds
    s_add_u32 m0, s60, 50176
    s_add_u32 s28, s61, 294912
    buffer_load_dwordx4 v21, s[8:11], s28 offen lds
    s_add_u32 m0, s60, 51200
    s_add_u32 s28, s61, 294912
    buffer_load_dwordx4 v22, s[8:11], s28 offen lds
    s_add_u32 m0, s60, 61440
    s_add_u32 s28, s61, 589824
    buffer_load_dwordx4 v20, s[8:11], s28 offen lds
    s_add_u32 m0, s60, 62464
    s_add_u32 s28, s61, 589824
    buffer_load_dwordx4 v21, s[8:11], s28 offen lds
    s_add_u32 m0, s60, 63488
    s_add_u32 s28, s61, 589824
    buffer_load_dwordx4 v22, s[8:11], s28 offen lds
    s_load_dwordx2 s[8:9], s[0:1], 64
    s_mov_b32 s10, 5308416
    s_mov_b32 s11, 0x20000
    s_waitcnt lgkmcnt(0)
    s_add_u32 m0, s60, 73728
    s_add_u32 s28, s61, 884736
    buffer_load_dwordx4 v20, s[8:11], s28 offen lds
    s_add_u32 m0, s60, 74752
    s_add_u32 s28, s61, 884736
    buffer_load_dwordx4 v21, s[8:11], s28 offen lds
    s_add_u32 m0, s60, 75776
    s_add_u32 s28, s61, 884736
    buffer_load_dwordx4 v22, s[8:11], s28 offen lds
    s_add_u32 m0, s60, 86016
    s_add_u32 s28, s61, 1179648
    buffer_load_dwordx4 v20, s[8:11], s28 offen lds
    s_add_u32 m0, s60, 87040
    s_add_u32 s28, s61, 1179648
    buffer_load_dwordx4 v21, s[8:11], s28 offen lds
    s_add_u32 m0, s60, 88064
    s_add_u32 s28, s61, 1179648
    buffer_load_dwordx4 v22, s[8:11], s28 offen lds
    s_add_u32 m0, s60, 98304
    s_add_u32 s28, s61, 1474560
    buffer_load_dwordx4 v20, s[8:11], s28 offen lds
    s_add_u32 m0, s60, 99328
    s_add_u32 s28, s61, 1474560
    buffer_load_dwordx4 v21, s[8:11], s28 offen lds
    s_add_u32 m0, s60, 100352
    s_add_u32 s28, s61, 1474560
    buffer_load_dwordx4 v22, s[8:11], s28 offen lds
    s_load_dwordx2 s[8:9], s[0:1], 72
    s_mov_b32 s10, 5308416
    s_mov_b32 s11, 0x20000
    s_waitcnt lgkmcnt(0)
    s_add_u32 m0, s60, 110592
    s_add_u32 s28, s61, 884736
    buffer_load_dwordx4 v20, s[8:11], s28 offen lds
    s_add_u32 m0, s60, 111616
    s_add_u32 s28, s61, 884736
    buffer_load_dwordx4 v21, s[8:11], s28 offen lds
    s_add_u32 m0, s60, 112640
    s_add_u32 s28, s61, 884736
    buffer_load_dwordx4 v22, s[8:11], s28 offen lds
    s_add_u32 m0, s60, 122880
    s_add_u32 s28, s61, 1179648
    buffer_load_dwordx4 v20, s[8:11], s28 offen lds
    s_add_u32 m0, s60, 123904
    s_add_u32 s28, s61, 1179648
    buffer_load_dwordx4 v21, s[8:11], s28 offen lds
    s_add_u32 m0, s60, 124928
    s_add_u32 s28, s61, 1179648
    buffer_load_dwordx4 v22, s[8:11], s28 offen lds
    s_add_u32 m0, s60, 135168
    s_add_u32 s28, s61, 1474560
    buffer_load_dwordx4 v20, s[8:11], s28 offen lds
    s_add_u32 m0, s60, 136192
    s_add_u32 s28, s61, 1474560
    buffer_load_dwordx4 v21, s[8:11], s28 offen lds
    s_add_u32 m0, s60, 137216
    s_add_u32 s28, s61, 1474560
    buffer_load_dwordx4 v22, s[8:11], s28 offen lds
    s_waitcnt vmcnt(18)
    s_barrier
    ds_read_b64_tr_b16 v[80:81], v23 offset:0
    ds_read_b64_tr_b16 v[82:83], v23 offset:1536
    ds_read_b64_tr_b16 v[92:93], v23 offset:6144
    ds_read_b64_tr_b16 v[94:95], v23 offset:7680
    ds_read_b64_tr_b16 v[104:105], v23 offset:12288
    ds_read_b64_tr_b16 v[106:107], v23 offset:13824
    ds_read_b64_tr_b16 v[116:117], v23 offset:18432
    ds_read_b64_tr_b16 v[118:119], v23 offset:19968
    ds_read_b64_tr_b16 v[128:129], v23 offset:24576
    ds_read_b64_tr_b16 v[130:131], v23 offset:26112
    ds_read_b64_tr_b16 v[140:141], v23 offset:30720
    ds_read_b64_tr_b16 v[142:143], v23 offset:32256
    ds_read_b64_tr_b16 v[84:85], v24 offset:0
    ds_read_b64_tr_b16 v[86:87], v24 offset:1536
    ds_read_b64_tr_b16 v[96:97], v24 offset:6144
    ds_read_b64_tr_b16 v[98:99], v24 offset:7680
    ds_read_b64_tr_b16 v[108:109], v24 offset:12288
    ds_read_b64_tr_b16 v[110:111], v24 offset:13824
    ds_read_b64_tr_b16 v[120:121], v24 offset:18432
    ds_read_b64_tr_b16 v[122:123], v24 offset:19968
    ds_read_b64_tr_b16 v[132:133], v24 offset:24576
    ds_read_b64_tr_b16 v[134:135], v24 offset:26112
    ds_read_b64_tr_b16 v[144:145], v24 offset:30720
    ds_read_b64_tr_b16 v[146:147], v24 offset:32256
    ds_read_b64_tr_b16 v[88:89], v25 offset:0
    ds_read_b64_tr_b16 v[90:91], v25 offset:1536
    ds_read_b64_tr_b16 v[100:101], v25 offset:6144
    ds_read_b64_tr_b16 v[102:103], v25 offset:7680
    ds_read_b64_tr_b16 v[112:113], v25 offset:12288
    ds_read_b64_tr_b16 v[114:115], v25 offset:13824
    ds_read_b64_tr_b16 v[124:125], v25 offset:18432
    ds_read_b64_tr_b16 v[126:127], v25 offset:19968
    ds_read_b64_tr_b16 v[136:137], v25 offset:24576
    ds_read_b64_tr_b16 v[138:139], v25 offset:26112
    ds_read_b64_tr_b16 v[148:149], v25 offset:30720
    ds_read_b64_tr_b16 v[150:151], v25 offset:32256
    s_waitcnt lgkmcnt(0)
    s_barrier
    s_load_dwordx2 s[8:9], s[0:1], 64
    s_mov_b32 s10, 5308416
    s_mov_b32 s11, 0x20000
    s_waitcnt lgkmcnt(0)
    s_add_u32 m0, s60, 0
    s_add_u32 s28, s61, 1769472
    buffer_load_dwordx4 v20, s[8:11], s28 offen lds
    s_add_u32 m0, s60, 1024
    s_add_u32 s28, s61, 1769472
    buffer_load_dwordx4 v21, s[8:11], s28 offen lds
    s_add_u32 m0, s60, 2048
    s_add_u32 s28, s61, 1769472
    buffer_load_dwordx4 v22, s[8:11], s28 offen lds
    s_add_u32 m0, s60, 12288
    s_add_u32 s28, s61, 2064384
    buffer_load_dwordx4 v20, s[8:11], s28 offen lds
    s_add_u32 m0, s60, 13312
    s_add_u32 s28, s61, 2064384
    buffer_load_dwordx4 v21, s[8:11], s28 offen lds
    s_add_u32 m0, s60, 14336
    s_add_u32 s28, s61, 2064384
    buffer_load_dwordx4 v22, s[8:11], s28 offen lds
    s_add_u32 m0, s60, 24576
    s_add_u32 s28, s61, 2359296
    buffer_load_dwordx4 v20, s[8:11], s28 offen lds
    s_add_u32 m0, s60, 25600
    s_add_u32 s28, s61, 2359296
    buffer_load_dwordx4 v21, s[8:11], s28 offen lds
    s_add_u32 m0, s60, 26624
    s_add_u32 s28, s61, 2359296
    buffer_load_dwordx4 v22, s[8:11], s28 offen lds
    s_load_dwordx2 s[8:9], s[0:1], 72
    s_mov_b32 s10, 5308416
    s_mov_b32 s11, 0x20000
    s_waitcnt lgkmcnt(0)
    s_add_u32 m0, s60, 36864
    s_add_u32 s28, s61, 1769472
    buffer_load_dwordx4 v20, s[8:11], s28 offen lds
    s_add_u32 m0, s60, 37888
    s_add_u32 s28, s61, 1769472
    buffer_load_dwordx4 v21, s[8:11], s28 offen lds
    s_add_u32 m0, s60, 38912
    s_add_u32 s28, s61, 1769472
    buffer_load_dwordx4 v22, s[8:11], s28 offen lds
    s_add_u32 m0, s60, 49152
    s_add_u32 s28, s61, 2064384
    buffer_load_dwordx4 v20, s[8:11], s28 offen lds
    s_add_u32 m0, s60, 50176
    s_add_u32 s28, s61, 2064384
    buffer_load_dwordx4 v21, s[8:11], s28 offen lds
    s_add_u32 m0, s60, 51200
    s_add_u32 s28, s61, 2064384
    buffer_load_dwordx4 v22, s[8:11], s28 offen lds
    s_add_u32 m0, s60, 61440
    s_add_u32 s28, s61, 2359296
    buffer_load_dwordx4 v20, s[8:11], s28 offen lds
    s_add_u32 m0, s60, 62464
    s_add_u32 s28, s61, 2359296
    buffer_load_dwordx4 v21, s[8:11], s28 offen lds
    s_add_u32 m0, s60, 63488
    s_add_u32 s28, s61, 2359296
    buffer_load_dwordx4 v22, s[8:11], s28 offen lds
    s_waitcnt vmcnt(18)
    s_barrier
    v_add_u32 v26, 65536, v23
    ds_read_b64_tr_b16 v[152:153], v26 offset:8192
    ds_read_b64_tr_b16 v[154:155], v26 offset:9728
    ds_read_b64_tr_b16 v[164:165], v26 offset:14336
    ds_read_b64_tr_b16 v[166:167], v26 offset:15872
    ds_read_b64_tr_b16 v[176:177], v26 offset:20480
    ds_read_b64_tr_b16 v[178:179], v26 offset:22016
    ds_read_b64_tr_b16 v[188:189], v26 offset:26624
    ds_read_b64_tr_b16 v[190:191], v26 offset:28160
    ds_read_b64_tr_b16 v[200:201], v26 offset:32768
    ds_read_b64_tr_b16 v[202:203], v26 offset:34304
    ds_read_b64_tr_b16 v[212:213], v26 offset:38912
    ds_read_b64_tr_b16 v[214:215], v26 offset:40448
    v_add_u32 v26, 65536, v24
    ds_read_b64_tr_b16 v[156:157], v26 offset:8192
    ds_read_b64_tr_b16 v[158:159], v26 offset:9728
    ds_read_b64_tr_b16 v[168:169], v26 offset:14336
    ds_read_b64_tr_b16 v[170:171], v26 offset:15872
    ds_read_b64_tr_b16 v[180:181], v26 offset:20480
    ds_read_b64_tr_b16 v[182:183], v26 offset:22016
    ds_read_b64_tr_b16 v[192:193], v26 offset:26624
    ds_read_b64_tr_b16 v[194:195], v26 offset:28160
    ds_read_b64_tr_b16 v[204:205], v26 offset:32768
    ds_read_b64_tr_b16 v[206:207], v26 offset:34304
    ds_read_b64_tr_b16 v[216:217], v26 offset:38912
    ds_read_b64_tr_b16 v[218:219], v26 offset:40448
    v_add_u32 v26, 65536, v25
    ds_read_b64_tr_b16 v[160:161], v26 offset:8192
    ds_read_b64_tr_b16 v[162:163], v26 offset:9728
    ds_read_b64_tr_b16 v[172:173], v26 offset:14336
    ds_read_b64_tr_b16 v[174:175], v26 offset:15872
    ds_read_b64_tr_b16 v[184:185], v26 offset:20480
    ds_read_b64_tr_b16 v[186:187], v26 offset:22016
    ds_read_b64_tr_b16 v[196:197], v26 offset:26624
    ds_read_b64_tr_b16 v[198:199], v26 offset:28160
    ds_read_b64_tr_b16 v[208:209], v26 offset:32768
    ds_read_b64_tr_b16 v[210:211], v26 offset:34304
    ds_read_b64_tr_b16 v[220:221], v26 offset:38912
    ds_read_b64_tr_b16 v[222:223], v26 offset:40448
    s_waitcnt lgkmcnt(0)
    s_barrier
    s_load_dwordx2 s[8:9], s[0:1], 64
    s_mov_b32 s10, 5308416
    s_mov_b32 s11, 0x20000
    s_waitcnt lgkmcnt(0)
    s_add_u32 m0, s60, 73728
    s_add_u32 s28, s61, 2654208
    buffer_load_dwordx4 v20, s[8:11], s28 offen lds
    s_add_u32 m0, s60, 74752
    s_add_u32 s28, s61, 2654208
    buffer_load_dwordx4 v21, s[8:11], s28 offen lds
    s_add_u32 m0, s60, 75776
    s_add_u32 s28, s61, 2654208
    buffer_load_dwordx4 v22, s[8:11], s28 offen lds
    s_add_u32 m0, s60, 86016
    s_add_u32 s28, s61, 2949120
    buffer_load_dwordx4 v20, s[8:11], s28 offen lds
    s_add_u32 m0, s60, 87040
    s_add_u32 s28, s61, 2949120
    buffer_load_dwordx4 v21, s[8:11], s28 offen lds
    s_add_u32 m0, s60, 88064
    s_add_u32 s28, s61, 2949120
    buffer_load_dwordx4 v22, s[8:11], s28 offen lds
    s_add_u32 m0, s60, 98304
    s_add_u32 s28, s61, 3244032
    buffer_load_dwordx4 v20, s[8:11], s28 offen lds
    s_add_u32 m0, s60, 99328
    s_add_u32 s28, s61, 3244032
    buffer_load_dwordx4 v21, s[8:11], s28 offen lds
    s_add_u32 m0, s60, 100352
    s_add_u32 s28, s61, 3244032
    buffer_load_dwordx4 v22, s[8:11], s28 offen lds
    s_load_dwordx2 s[8:9], s[0:1], 72
    s_mov_b32 s10, 5308416
    s_mov_b32 s11, 0x20000
    s_waitcnt lgkmcnt(0)
    s_add_u32 m0, s60, 110592
    s_add_u32 s28, s61, 2654208
    buffer_load_dwordx4 v20, s[8:11], s28 offen lds
    s_add_u32 m0, s60, 111616
    s_add_u32 s28, s61, 2654208
    buffer_load_dwordx4 v21, s[8:11], s28 offen lds
    s_add_u32 m0, s60, 112640
    s_add_u32 s28, s61, 2654208
    buffer_load_dwordx4 v22, s[8:11], s28 offen lds
    s_add_u32 m0, s60, 122880
    s_add_u32 s28, s61, 2949120
    buffer_load_dwordx4 v20, s[8:11], s28 offen lds
    s_add_u32 m0, s60, 123904
    s_add_u32 s28, s61, 2949120
    buffer_load_dwordx4 v21, s[8:11], s28 offen lds
    s_add_u32 m0, s60, 124928
    s_add_u32 s28, s61, 2949120
    buffer_load_dwordx4 v22, s[8:11], s28 offen lds
    s_add_u32 m0, s60, 135168
    s_add_u32 s28, s61, 3244032
    buffer_load_dwordx4 v20, s[8:11], s28 offen lds
    s_add_u32 m0, s60, 136192
    s_add_u32 s28, s61, 3244032
    buffer_load_dwordx4 v21, s[8:11], s28 offen lds
    s_add_u32 m0, s60, 137216
    s_add_u32 s28, s61, 3244032
    buffer_load_dwordx4 v22, s[8:11], s28 offen lds
    s_waitcnt vmcnt(18)
    s_barrier
    ds_read_b64_tr_b16 v[224:225], v23 offset:0
    ds_read_b64_tr_b16 v[226:227], v23 offset:1536
    ds_read_b64_tr_b16 v[236:237], v23 offset:6144
    ds_read_b64_tr_b16 v[238:239], v23 offset:7680
    ds_read_b64_tr_b16 v[248:249], v23 offset:12288
    ds_read_b64_tr_b16 v[250:251], v23 offset:13824
    ds_read_b64_tr_b16 a[4:5], v23 offset:18432
    ds_read_b64_tr_b16 a[6:7], v23 offset:19968
    ds_read_b64_tr_b16 a[16:17], v23 offset:24576
    ds_read_b64_tr_b16 a[18:19], v23 offset:26112
    ds_read_b64_tr_b16 a[28:29], v23 offset:30720
    ds_read_b64_tr_b16 a[30:31], v23 offset:32256
    ds_read_b64_tr_b16 v[228:229], v24 offset:0
    ds_read_b64_tr_b16 v[230:231], v24 offset:1536
    ds_read_b64_tr_b16 v[240:241], v24 offset:6144
    ds_read_b64_tr_b16 v[242:243], v24 offset:7680
    ds_read_b64_tr_b16 v[252:253], v24 offset:12288
    ds_read_b64_tr_b16 v[254:255], v24 offset:13824
    ds_read_b64_tr_b16 a[8:9], v24 offset:18432
    ds_read_b64_tr_b16 a[10:11], v24 offset:19968
    ds_read_b64_tr_b16 a[20:21], v24 offset:24576
    ds_read_b64_tr_b16 a[22:23], v24 offset:26112
    ds_read_b64_tr_b16 a[32:33], v24 offset:30720
    ds_read_b64_tr_b16 a[34:35], v24 offset:32256
    ds_read_b64_tr_b16 v[232:233], v25 offset:0
    ds_read_b64_tr_b16 v[234:235], v25 offset:1536
    ds_read_b64_tr_b16 v[244:245], v25 offset:6144
    ds_read_b64_tr_b16 v[246:247], v25 offset:7680
    ds_read_b64_tr_b16 a[0:1], v25 offset:12288
    ds_read_b64_tr_b16 a[2:3], v25 offset:13824
    ds_read_b64_tr_b16 a[12:13], v25 offset:18432
    ds_read_b64_tr_b16 a[14:15], v25 offset:19968
    ds_read_b64_tr_b16 a[24:25], v25 offset:24576
    ds_read_b64_tr_b16 a[26:27], v25 offset:26112
    ds_read_b64_tr_b16 a[36:37], v25 offset:30720
    ds_read_b64_tr_b16 a[38:39], v25 offset:32256
    s_waitcnt lgkmcnt(0)
    s_barrier
    s_load_dwordx2 s[8:9], s[0:1], 64
    s_mov_b32 s10, 5308416
    s_mov_b32 s11, 0x20000
    s_waitcnt lgkmcnt(0)
    s_add_u32 m0, s60, 0
    s_add_u32 s28, s61, 3538944
    buffer_load_dwordx4 v20, s[8:11], s28 offen lds
    s_add_u32 m0, s60, 1024
    s_add_u32 s28, s61, 3538944
    buffer_load_dwordx4 v21, s[8:11], s28 offen lds
    s_add_u32 m0, s60, 2048
    s_add_u32 s28, s61, 3538944
    buffer_load_dwordx4 v22, s[8:11], s28 offen lds
    s_add_u32 m0, s60, 12288
    s_add_u32 s28, s61, 3833856
    buffer_load_dwordx4 v20, s[8:11], s28 offen lds
    s_add_u32 m0, s60, 13312
    s_add_u32 s28, s61, 3833856
    buffer_load_dwordx4 v21, s[8:11], s28 offen lds
    s_add_u32 m0, s60, 14336
    s_add_u32 s28, s61, 3833856
    buffer_load_dwordx4 v22, s[8:11], s28 offen lds
    s_add_u32 m0, s60, 24576
    s_add_u32 s28, s61, 4128768
    buffer_load_dwordx4 v20, s[8:11], s28 offen lds
    s_add_u32 m0, s60, 25600
    s_add_u32 s28, s61, 4128768
    buffer_load_dwordx4 v21, s[8:11], s28 offen lds
    s_add_u32 m0, s60, 26624
    s_add_u32 s28, s61, 4128768
    buffer_load_dwordx4 v22, s[8:11], s28 offen lds
    s_load_dwordx2 s[8:9], s[0:1], 72
    s_mov_b32 s10, 5308416
    s_mov_b32 s11, 0x20000
    s_waitcnt lgkmcnt(0)
    s_add_u32 m0, s60, 36864
    s_add_u32 s28, s61, 3538944
    buffer_load_dwordx4 v20, s[8:11], s28 offen lds
    s_add_u32 m0, s60, 37888
    s_add_u32 s28, s61, 3538944
    buffer_load_dwordx4 v21, s[8:11], s28 offen lds
    s_add_u32 m0, s60, 38912
    s_add_u32 s28, s61, 3538944
    buffer_load_dwordx4 v22, s[8:11], s28 offen lds
    s_add_u32 m0, s60, 49152
    s_add_u32 s28, s61, 3833856
    buffer_load_dwordx4 v20, s[8:11], s28 offen lds
    s_add_u32 m0, s60, 50176
    s_add_u32 s28, s61, 3833856
    buffer_load_dwordx4 v21, s[8:11], s28 offen lds
    s_add_u32 m0, s60, 51200
    s_add_u32 s28, s61, 3833856
    buffer_load_dwordx4 v22, s[8:11], s28 offen lds
    s_add_u32 m0, s60, 61440
    s_add_u32 s28, s61, 4128768
    buffer_load_dwordx4 v20, s[8:11], s28 offen lds
    s_add_u32 m0, s60, 62464
    s_add_u32 s28, s61, 4128768
    buffer_load_dwordx4 v21, s[8:11], s28 offen lds
    s_add_u32 m0, s60, 63488
    s_add_u32 s28, s61, 4128768
    buffer_load_dwordx4 v22, s[8:11], s28 offen lds
    s_waitcnt vmcnt(18)
    s_barrier
    v_add_u32 v26, 65536, v23
    ds_read_b64_tr_b16 a[40:41], v26 offset:8192
    ds_read_b64_tr_b16 a[42:43], v26 offset:9728
    ds_read_b64_tr_b16 a[52:53], v26 offset:14336
    ds_read_b64_tr_b16 a[54:55], v26 offset:15872
    ds_read_b64_tr_b16 a[64:65], v26 offset:20480
    ds_read_b64_tr_b16 a[66:67], v26 offset:22016
    ds_read_b64_tr_b16 a[76:77], v26 offset:26624
    ds_read_b64_tr_b16 a[78:79], v26 offset:28160
    ds_read_b64_tr_b16 a[88:89], v26 offset:32768
    ds_read_b64_tr_b16 a[90:91], v26 offset:34304
    ds_read_b64_tr_b16 a[100:101], v26 offset:38912
    ds_read_b64_tr_b16 a[102:103], v26 offset:40448
    v_add_u32 v26, 65536, v24
    ds_read_b64_tr_b16 a[44:45], v26 offset:8192
    ds_read_b64_tr_b16 a[46:47], v26 offset:9728
    ds_read_b64_tr_b16 a[56:57], v26 offset:14336
    ds_read_b64_tr_b16 a[58:59], v26 offset:15872
    ds_read_b64_tr_b16 a[68:69], v26 offset:20480
    ds_read_b64_tr_b16 a[70:71], v26 offset:22016
    ds_read_b64_tr_b16 a[80:81], v26 offset:26624
    ds_read_b64_tr_b16 a[82:83], v26 offset:28160
    ds_read_b64_tr_b16 a[92:93], v26 offset:32768
    ds_read_b64_tr_b16 a[94:95], v26 offset:34304
    ds_read_b64_tr_b16 a[104:105], v26 offset:38912
    ds_read_b64_tr_b16 a[106:107], v26 offset:40448
    v_add_u32 v26, 65536, v25
    ds_read_b64_tr_b16 a[48:49], v26 offset:8192
    ds_read_b64_tr_b16 a[50:51], v26 offset:9728
    ds_read_b64_tr_b16 a[60:61], v26 offset:14336
    ds_read_b64_tr_b16 a[62:63], v26 offset:15872
    ds_read_b64_tr_b16 a[72:73], v26 offset:20480
    ds_read_b64_tr_b16 a[74:75], v26 offset:22016
    ds_read_b64_tr_b16 a[84:85], v26 offset:26624
    ds_read_b64_tr_b16 a[86:87], v26 offset:28160
    ds_read_b64_tr_b16 a[96:97], v26 offset:32768
    ds_read_b64_tr_b16 a[98:99], v26 offset:34304
    ds_read_b64_tr_b16 a[108:109], v26 offset:38912
    ds_read_b64_tr_b16 a[110:111], v26 offset:40448
    s_waitcnt lgkmcnt(0)
    s_barrier
    s_load_dwordx2 s[8:9], s[0:1], 64
    s_mov_b32 s10, 5308416
    s_mov_b32 s11, 0x20000
    s_waitcnt lgkmcnt(0)
    s_add_u32 m0, s60, 73728
    s_add_u32 s28, s61, 4423680
    buffer_load_dwordx4 v20, s[8:11], s28 offen lds
    s_add_u32 m0, s60, 74752
    s_add_u32 s28, s61, 4423680
    buffer_load_dwordx4 v21, s[8:11], s28 offen lds
    s_add_u32 m0, s60, 75776
    s_add_u32 s28, s61, 4423680
    buffer_load_dwordx4 v22, s[8:11], s28 offen lds
    s_add_u32 m0, s60, 86016
    s_add_u32 s28, s61, 4718592
    buffer_load_dwordx4 v20, s[8:11], s28 offen lds
    s_add_u32 m0, s60, 87040
    s_add_u32 s28, s61, 4718592
    buffer_load_dwordx4 v21, s[8:11], s28 offen lds
    s_add_u32 m0, s60, 88064
    s_add_u32 s28, s61, 4718592
    buffer_load_dwordx4 v22, s[8:11], s28 offen lds
    s_add_u32 m0, s60, 98304
    s_add_u32 s28, s61, 5013504
    buffer_load_dwordx4 v20, s[8:11], s28 offen lds
    s_add_u32 m0, s60, 99328
    s_add_u32 s28, s61, 5013504
    buffer_load_dwordx4 v21, s[8:11], s28 offen lds
    s_add_u32 m0, s60, 100352
    s_add_u32 s28, s61, 5013504
    buffer_load_dwordx4 v22, s[8:11], s28 offen lds
    s_load_dwordx2 s[8:9], s[0:1], 72
    s_mov_b32 s10, 5308416
    s_mov_b32 s11, 0x20000
    s_waitcnt lgkmcnt(0)
    s_add_u32 m0, s60, 110592
    s_add_u32 s28, s61, 4423680
    buffer_load_dwordx4 v20, s[8:11], s28 offen lds
    s_add_u32 m0, s60, 111616
    s_add_u32 s28, s61, 4423680
    buffer_load_dwordx4 v21, s[8:11], s28 offen lds
    s_add_u32 m0, s60, 112640
    s_add_u32 s28, s61, 4423680
    buffer_load_dwordx4 v22, s[8:11], s28 offen lds
    s_add_u32 m0, s60, 122880
    s_add_u32 s28, s61, 4718592
    buffer_load_dwordx4 v20, s[8:11], s28 offen lds
    s_add_u32 m0, s60, 123904
    s_add_u32 s28, s61, 4718592
    buffer_load_dwordx4 v21, s[8:11], s28 offen lds
    s_add_u32 m0, s60, 124928
    s_add_u32 s28, s61, 4718592
    buffer_load_dwordx4 v22, s[8:11], s28 offen lds
    s_add_u32 m0, s60, 135168
    s_add_u32 s28, s61, 5013504
    buffer_load_dwordx4 v20, s[8:11], s28 offen lds
    s_add_u32 m0, s60, 136192
    s_add_u32 s28, s61, 5013504
    buffer_load_dwordx4 v21, s[8:11], s28 offen lds
    s_add_u32 m0, s60, 137216
    s_add_u32 s28, s61, 5013504
    buffer_load_dwordx4 v22, s[8:11], s28 offen lds
    s_waitcnt vmcnt(18)
    s_barrier
    ds_read_b64_tr_b16 a[112:113], v23 offset:0
    ds_read_b64_tr_b16 a[114:115], v23 offset:1536
    ds_read_b64_tr_b16 a[124:125], v23 offset:6144
    ds_read_b64_tr_b16 a[126:127], v23 offset:7680
    ds_read_b64_tr_b16 a[136:137], v23 offset:12288
    ds_read_b64_tr_b16 a[138:139], v23 offset:13824
    ds_read_b64_tr_b16 a[148:149], v23 offset:18432
    ds_read_b64_tr_b16 a[150:151], v23 offset:19968
    ds_read_b64_tr_b16 a[160:161], v23 offset:24576
    ds_read_b64_tr_b16 a[162:163], v23 offset:26112
    ds_read_b64_tr_b16 a[172:173], v23 offset:30720
    ds_read_b64_tr_b16 a[174:175], v23 offset:32256
    ds_read_b64_tr_b16 a[116:117], v24 offset:0
    ds_read_b64_tr_b16 a[118:119], v24 offset:1536
    ds_read_b64_tr_b16 a[128:129], v24 offset:6144
    ds_read_b64_tr_b16 a[130:131], v24 offset:7680
    ds_read_b64_tr_b16 a[140:141], v24 offset:12288
    ds_read_b64_tr_b16 a[142:143], v24 offset:13824
    ds_read_b64_tr_b16 a[152:153], v24 offset:18432
    ds_read_b64_tr_b16 a[154:155], v24 offset:19968
    ds_read_b64_tr_b16 a[164:165], v24 offset:24576
    ds_read_b64_tr_b16 a[166:167], v24 offset:26112
    ds_read_b64_tr_b16 a[176:177], v24 offset:30720
    ds_read_b64_tr_b16 a[178:179], v24 offset:32256
    ds_read_b64_tr_b16 a[120:121], v25 offset:0
    ds_read_b64_tr_b16 a[122:123], v25 offset:1536
    ds_read_b64_tr_b16 a[132:133], v25 offset:6144
    ds_read_b64_tr_b16 a[134:135], v25 offset:7680
    ds_read_b64_tr_b16 a[144:145], v25 offset:12288
    ds_read_b64_tr_b16 a[146:147], v25 offset:13824
    ds_read_b64_tr_b16 a[156:157], v25 offset:18432
    ds_read_b64_tr_b16 a[158:159], v25 offset:19968
    ds_read_b64_tr_b16 a[168:169], v25 offset:24576
    ds_read_b64_tr_b16 a[170:171], v25 offset:26112
    ds_read_b64_tr_b16 a[180:181], v25 offset:30720
    ds_read_b64_tr_b16 a[182:183], v25 offset:32256
    s_waitcnt lgkmcnt(0)
    s_barrier
    s_waitcnt vmcnt(0)
    s_barrier
    v_add_u32 v26, 65536, v23
    ds_read_b64_tr_b16 a[184:185], v26 offset:8192
    ds_read_b64_tr_b16 a[186:187], v26 offset:9728
    ds_read_b64_tr_b16 a[196:197], v26 offset:14336
    ds_read_b64_tr_b16 a[198:199], v26 offset:15872
    ds_read_b64_tr_b16 a[208:209], v26 offset:20480
    ds_read_b64_tr_b16 a[210:211], v26 offset:22016
    ds_read_b64_tr_b16 a[220:221], v26 offset:26624
    ds_read_b64_tr_b16 a[222:223], v26 offset:28160
    ds_read_b64_tr_b16 a[232:233], v26 offset:32768
    ds_read_b64_tr_b16 a[234:235], v26 offset:34304
    ds_read_b64_tr_b16 a[244:245], v26 offset:38912
    ds_read_b64_tr_b16 a[246:247], v26 offset:40448
    v_add_u32 v26, 65536, v24
    ds_read_b64_tr_b16 a[188:189], v26 offset:8192
    ds_read_b64_tr_b16 a[190:191], v26 offset:9728
    ds_read_b64_tr_b16 a[200:201], v26 offset:14336
    ds_read_b64_tr_b16 a[202:203], v26 offset:15872
    ds_read_b64_tr_b16 a[212:213], v26 offset:20480
    ds_read_b64_tr_b16 a[214:215], v26 offset:22016
    ds_read_b64_tr_b16 a[224:225], v26 offset:26624
    ds_read_b64_tr_b16 a[226:227], v26 offset:28160
    ds_read_b64_tr_b16 a[236:237], v26 offset:32768
    ds_read_b64_tr_b16 a[238:239], v26 offset:34304
    ds_read_b64_tr_b16 a[248:249], v26 offset:38912
    ds_read_b64_tr_b16 a[250:251], v26 offset:40448
    v_add_u32 v26, 65536, v25
    ds_read_b64_tr_b16 a[192:193], v26 offset:8192
    ds_read_b64_tr_b16 a[194:195], v26 offset:9728
    ds_read_b64_tr_b16 a[204:205], v26 offset:14336
    ds_read_b64_tr_b16 a[206:207], v26 offset:15872
    ds_read_b64_tr_b16 a[216:217], v26 offset:20480
    ds_read_b64_tr_b16 a[218:219], v26 offset:22016
    ds_read_b64_tr_b16 a[228:229], v26 offset:26624
    ds_read_b64_tr_b16 a[230:231], v26 offset:28160
    ds_read_b64_tr_b16 a[240:241], v26 offset:32768
    ds_read_b64_tr_b16 a[242:243], v26 offset:34304
    ds_read_b64_tr_b16 a[252:253], v26 offset:38912
    ds_read_b64_tr_b16 a[254:255], v26 offset:40448
    s_waitcnt lgkmcnt(0)
    s_barrier
    v_lshrrev_b32 v5, 0, v0
    v_and_b32 v5, 15, v5
    v_lshlrev_b32 v5, 4, v5
    v_lshrrev_b32 v30, 5, v0
    v_and_b32 v30, 1, v30
    v_lshl_or_b32 v5, v30, 8, v5
    v_bfe_u32 v30, v0, 4, 1
    v_mul_u32_u24 v30, 147456, v30
    v_add_u32 v5, v5, v30
    v_and_b32 v33, 31, v0
    v_mul_u32_u24 v33, 1152, v33
    v_bfe_u32 v34, v0, 1, 3
    v_lshrrev_b32 v35, 5, v0
    v_xor_b32 v34, v34, v35
    s_lshl_b32 s28, s20, 3
    v_add_u32 v32, 0, v0
    v_mul_u32_u24 v30, 911, v32
    v_lshrrev_b32 v30, 16, v30
    v_mul_u32_u24 v31, 72, v30
    v_sub_u32 v32, v32, v31
    v_add_u32 v30, s28, v30
    v_lshrrev_b32 v6, 1, v30
    v_and_b32 v6, 7, v6
    v_xor_b32 v6, v6, v32
    v_lshlrev_b32 v6, 4, v6
    v_mul_u32_u24 v30, 1152, v30
    v_add_u32 v6, v6, v30
    v_add_u32 v32, 64, v0
    v_mul_u32_u24 v30, 911, v32
    v_lshrrev_b32 v30, 16, v30
    v_mul_u32_u24 v31, 72, v30
    v_sub_u32 v32, v32, v31
    v_add_u32 v30, s28, v30
    v_lshrrev_b32 v7, 1, v30
    v_and_b32 v7, 7, v7
    v_xor_b32 v7, v7, v32
    v_lshlrev_b32 v7, 4, v7
    v_mul_u32_u24 v30, 1152, v30
    v_add_u32 v7, v7, v30
    v_add_u32 v32, 128, v0
    v_mul_u32_u24 v30, 911, v32
    v_lshrrev_b32 v30, 16, v30
    v_mul_u32_u24 v31, 72, v30
    v_sub_u32 v32, v32, v31
    v_add_u32 v30, s28, v30
    v_lshrrev_b32 v8, 1, v30
    v_and_b32 v8, 7, v8
    v_xor_b32 v8, v8, v32
    v_lshlrev_b32 v8, 4, v8
    v_mul_u32_u24 v30, 1152, v30
    v_add_u32 v8, v8, v30
    v_add_u32 v32, 192, v0
    v_mul_u32_u24 v30, 911, v32
    v_lshrrev_b32 v30, 16, v30
    v_mul_u32_u24 v31, 72, v30
    v_sub_u32 v32, v32, v31
    v_add_u32 v30, s28, v30
    v_lshrrev_b32 v9, 1, v30
    v_and_b32 v9, 7, v9
    v_xor_b32 v9, v9, v32
    v_lshlrev_b32 v9, 4, v9
    v_mul_u32_u24 v30, 1152, v30
    v_add_u32 v9, v9, v30
    v_add_u32 v32, 256, v0
    v_mul_u32_u24 v30, 911, v32
    v_lshrrev_b32 v30, 16, v30
    v_mul_u32_u24 v31, 72, v30
    v_sub_u32 v32, v32, v31
    v_add_u32 v30, s28, v30
    v_lshrrev_b32 v10, 1, v30
    v_and_b32 v10, 7, v10
    v_xor_b32 v10, v10, v32
    v_lshlrev_b32 v10, 4, v10
    v_mul_u32_u24 v30, 1152, v30
    v_add_u32 v10, v10, v30
    v_add_u32 v32, 320, v0
    v_mul_u32_u24 v30, 911, v32
    v_lshrrev_b32 v30, 16, v30
    v_mul_u32_u24 v31, 72, v30
    v_sub_u32 v32, v32, v31
    v_add_u32 v30, s28, v30
    v_lshrrev_b32 v11, 1, v30
    v_and_b32 v11, 7, v11
    v_xor_b32 v11, v11, v32
    v_lshlrev_b32 v11, 4, v11
    v_mul_u32_u24 v30, 1152, v30
    v_add_u32 v11, v11, v30
    v_add_u32 v32, 384, v0
    v_mul_u32_u24 v30, 911, v32
    v_lshrrev_b32 v30, 16, v30
    v_mul_u32_u24 v31, 72, v30
    v_sub_u32 v32, v32, v31
    v_add_u32 v30, s28, v30
    v_lshrrev_b32 v12, 1, v30
    v_and_b32 v12, 7, v12
    v_xor_b32 v12, v12, v32
    v_lshlrev_b32 v12, 4, v12
    v_mul_u32_u24 v30, 1152, v30
    v_add_u32 v12, v12, v30
    v_add_u32 v32, 448, v0
    v_mul_u32_u24 v30, 911, v32
    v_lshrrev_b32 v30, 16, v30
    v_mul_u32_u24 v31, 72, v30
    v_sub_u32 v32, v32, v31
    v_add_u32 v30, s28, v30
    v_lshrrev_b32 v13, 1, v30
    v_and_b32 v13, 7, v13
    v_xor_b32 v13, v13, v32
    v_lshlrev_b32 v13, 4, v13
    v_mul_u32_u24 v30, 1152, v30
    v_add_u32 v13, v13, v30
    v_add_u32 v32, 512, v0
    v_mul_u32_u24 v30, 911, v32
    v_lshrrev_b32 v30, 16, v30
    v_mul_u32_u24 v31, 72, v30
    v_sub_u32 v32, v32, v31
    v_add_u32 v30, s28, v30
    v_lshrrev_b32 v14, 1, v30
    v_and_b32 v14, 7, v14
    v_xor_b32 v14, v14, v32
    v_lshlrev_b32 v14, 4, v14
    v_mul_u32_u24 v30, 1152, v30
    v_add_u32 v14, v14, v30
    v_add_u32 v6, 4096, v6
    v_add_u32 v7, 3072, v7
    v_add_u32 v8, 2048, v8
    v_add_u32 v9, 1024, v9
    v_add_u32 v10, 4096, v10
    v_add_u32 v11, 3072, v11
    v_add_u32 v12, 2048, v12
    v_add_u32 v13, 1024, v13
    v_add_u32 v14, 4096, v14
    v_and_b32 v30, 15, v0
    v_bfe_u32 v31, v0, 1, 3
    v_lshrrev_b32 v32, 4, v0
    v_xor_b32 v31, v31, v32
    v_mul_u32_u24 v30, 1152, v30
    v_lshl_add_u32 v1, v31, 4, v30
    v_xor_b32 v31, 4, v31
    v_lshl_add_u32 v2, v31, 4, v30
    v_and_b32 v3, 15, v0
    v_lshlrev_b32 v3, 9, v3
    s_mul_i32 s32, s24, 2359296
    s_add_u32 s32, s32, 6287360
    s_lshl_b32 s33, s20, 13
    s_lshl_b32 s28, s24, 8
    s_add_u32 s33, s33, s28
    s_add_u32 s33, s33, 32768
    s_mov_b32 s34, s36
    s_mov_b32 s30, 0
    s_mov_b32 s44, 36864
    s_mov_b32 s40, 1073741824
    s_load_dwordx2 s[8:9], s[0:1], 104
    s_mov_b32 s10, 0
    s_mov_b32 s11, 0x20000
    s_waitcnt lgkmcnt(0)
    v_lshlrev_b32 v0, 4, v0
    v_xor_b32 v35, 0, v34
    v_lshl_add_u32 v1, v35, 4, v33
    v_xor_b32 v35, 2, v34
    v_lshl_add_u32 v2, v35, 4, v33
    v_xor_b32 v35, 4, v34
    v_lshl_add_u32 v16, v35, 4, v33
    v_xor_b32 v35, 6, v34
    v_lshl_add_u32 v17, v35, 4, v33
    v_mov_b32 v15, 0xc0135761
    s_mov_b32 s42, 0xbdd2d3e8
    s_mul_i32 s37, s24, 18874368
    s_add_u32 s37, s37, 52428800
    s_mul_i32 s28, s21, 6144
    s_add_u32 s37, s37, s28
    s_mul_i32 s28, s20, 1536
    s_add_u32 s37, s37, s28
    s_lshl_b32 s39, s21, 11
    s_lshl_b32 s28, s20, 9
    s_add_u32 s39, s39, s28
    s_lshl_b32 s28, s24, 8
    s_add_u32 s39, s39, s28
    s_add_u32 s39, s39, 262140
    s_mov_b32 s23, 32768
    s_mov_b32 s29, 7
L_spin_44:
    s_sub_u32 s23, s23, 1
    s_cbranch_scc1 L_abort
    s_sleep 2
    buffer_load_dword v4, v3, s[4:7], s33 offen sc1
    s_waitcnt vmcnt(0)
    v_cmp_eq_u32 vcc, 0, v4
    s_cbranch_vccnz L_spin_44
    s_add_u32 m0, s34, 0
    s_nop 0
    buffer_load_dwordx4 v6, s[4:7], s32 offen offset:0 sc1 lds
    buffer_load_dwordx4 v7, s[4:7], s32 offen offset:1024 sc1 lds
    buffer_load_dwordx4 v8, s[4:7], s32 offen offset:2048 sc1 lds
    buffer_load_dwordx4 v9, s[4:7], s32 offen offset:3072 sc1 lds
    s_add_u32 m0, s34, 4096
    s_nop 0
    buffer_load_dwordx4 v10, s[4:7], s32 offen offset:0 sc1 lds
    buffer_load_dwordx4 v11, s[4:7], s32 offen offset:1024 sc1 lds
    buffer_load_dwordx4 v12, s[4:7], s32 offen offset:2048 sc1 lds
    buffer_load_dwordx4 v13, s[4:7], s32 offen offset:3072 sc1 lds
    s_add_u32 m0, s34, 8192
    s_nop 0
    buffer_load_dwordx4 v14, s[4:7], s32 offen offset:0 sc1 lds
    s_waitcnt vmcnt(0)
    v_mov_b32 v18, s42
    v_mov_b32 v19, v15
    s_mov_b32 s43, 0
L_up_0:
    s_barrier
    ds_read_b128 v[52:55], v1 offset:0
    ds_read_b128 v[56:59], v2 offset:0
    ds_read_b128 v[60:63], v16 offset:0
    ds_read_b128 v[64:67], v17 offset:0
    ds_read_b128 v[68:71], v1 offset:128
    s_add_u32 s32, s32, 36864
    s_add_u32 s33, s33, 4
    s_add_u32 s34, s34, s44
    s_waitcnt lgkmcnt(3)
    v_mfma_f32_32x32x16_bf16 v[20:35], v[80:83], v[52:55], 0
    ds_read_b128 v[52:55], v2 offset:128
    v_mfma_f32_32x32x16_bf16 v[20:35], v[92:95], v[56:59], v[20:35]
    ds_read_b128 v[56:59], v16 offset:128
    s_waitcnt lgkmcnt(3)
    v_mul_f32 v72, v36, v36
    v_mul_f32 v73, v37, v37
    v_mul_f32 v74, v38, v38
    v_mul_f32 v75, v39, v39
    v_mfma_f32_32x32x16_bf16 v[20:35], v[104:107], v[60:63], v[20:35]
    ds_read_b128 v[60:63], v17 offset:128
    v_mul_f32 v76, v40, v40
    v_mul_f32 v77, v41, v41
    v_mul_f32 v78, v42, v42
    v_mul_f32 v79, v43, v43
    v_fma_f32 v72, v72, s42, v15
    v_mfma_f32_32x32x16_bf16 v[20:35], v[116:119], v[64:67], v[20:35]
    ds_read_b128 v[64:67], v1 offset:256
    s_waitcnt lgkmcnt(3)
    v_fma_f32 v73, v73, s42, v15
    v_fma_f32 v74, v74, s42, v15
    v_fma_f32 v75, v75, s42, v15
    v_fma_f32 v76, v76, s42, v15
    v_mfma_f32_32x32x16_bf16 v[20:35], v[128:131], v[68:71], v[20:35]
    ds_read_b128 v[68:71], v2 offset:256
    v_fma_f32 v77, v77, s42, v15
    v_fma_f32 v78, v78, s42, v15
    v_fma_f32 v79, v79, s42, v15
    v_mul_f32 v72, v72, v36
    v_mul_f32 v73, v73, v37
    v_mfma_f32_32x32x16_bf16 v[20:35], v[140:143], v[52:55], v[20:35]
    ds_read_b128 v[52:55], v16 offset:256
    s_waitcnt lgkmcnt(3)
    v_mul_f32 v74, v74, v38
    v_mul_f32 v75, v75, v39
    v_mul_f32 v76, v76, v40
    v_mul_f32 v77, v77, v41
    v_mfma_f32_32x32x16_bf16 v[20:35], v[152:155], v[56:59], v[20:35]
    ds_read_b128 v[56:59], v17 offset:256
    v_mul_f32 v78, v78, v42
    v_mul_f32 v79, v79, v43
    v_exp_f32 v72, v72
    v_mfma_f32_32x32x16_bf16 v[20:35], v[164:167], v[60:63], v[20:35]
    ds_read_b128 v[60:63], v1 offset:384
    s_waitcnt lgkmcnt(3)
    v_exp_f32 v73, v73
    v_exp_f32 v74, v74
    v_mfma_f32_32x32x16_bf16 v[20:35], v[176:179], v[64:67], v[20:35]
    ds_read_b128 v[64:67], v2 offset:384
    v_exp_f32 v75, v75
    v_exp_f32 v76, v76
    v_mfma_f32_32x32x16_bf16 v[20:35], v[188:191], v[68:71], v[20:35]
    ds_read_b128 v[68:71], v16 offset:384
    s_waitcnt lgkmcnt(3)
    v_exp_f32 v77, v77
    v_exp_f32 v78, v78
    v_mfma_f32_32x32x16_bf16 v[20:35], v[200:203], v[52:55], v[20:35]
    ds_read_b128 v[52:55], v17 offset:384
    v_exp_f32 v79, v79
    v_mul_f32 v36, v36, v44
    v_mul_f32 v37, v37, v45
    v_mul_f32 v38, v38, v46
    v_mfma_f32_32x32x16_bf16 v[20:35], v[212:215], v[56:59], v[20:35]
    ds_read_b128 v[56:59], v1 offset:512
    s_waitcnt lgkmcnt(3)
    v_mul_f32 v39, v39, v47
    v_mul_f32 v40, v40, v48
    v_mul_f32 v41, v41, v49
    v_mul_f32 v42, v42, v50
    v_mfma_f32_32x32x16_bf16 v[20:35], v[224:227], v[60:63], v[20:35]
    ds_read_b128 v[60:63], v2 offset:512
    v_mul_f32 v43, v43, v51
    v_add_f32 v72, 1.0, v72
    v_add_f32 v73, 1.0, v73
    v_add_f32 v74, 1.0, v74
    v_add_f32 v75, 1.0, v75
    v_mfma_f32_32x32x16_bf16 v[20:35], v[236:239], v[64:67], v[20:35]
    ds_read_b128 v[64:67], v16 offset:512
    s_waitcnt lgkmcnt(3)
    v_add_f32 v76, 1.0, v76
    v_add_f32 v77, 1.0, v77
    v_add_f32 v78, 1.0, v78
    v_add_f32 v79, 1.0, v79
    v_mfma_f32_32x32x16_bf16 v[20:35], v[248:251], v[68:71], v[20:35]
    ds_read_b128 v[68:71], v17 offset:512
    v_rcp_f32 v72, v72
    v_rcp_f32 v73, v73
    v_mfma_f32_32x32x16_bf16 v[20:35], a[4:7], v[52:55], v[20:35]
    ds_read_b128 v[52:55], v1 offset:640
    s_waitcnt lgkmcnt(3)
    v_rcp_f32 v74, v74
    v_rcp_f32 v75, v75
    v_mfma_f32_32x32x16_bf16 v[20:35], a[16:19], v[56:59], v[20:35]
    ds_read_b128 v[56:59], v2 offset:640
    v_rcp_f32 v76, v76
    v_rcp_f32 v77, v77
    v_mfma_f32_32x32x16_bf16 v[20:35], a[28:31], v[60:63], v[20:35]
    ds_read_b128 v[60:63], v16 offset:640
    s_waitcnt lgkmcnt(3)
    v_rcp_f32 v78, v78
    v_rcp_f32 v79, v79
    v_mfma_f32_32x32x16_bf16 v[20:35], a[40:43], v[64:67], v[20:35]
    ds_read_b128 v[64:67], v17 offset:640
    v_mul_f32 v36, v36, v72
    v_mul_f32 v37, v37, v73
    v_mul_f32 v38, v38, v74
    v_mul_f32 v39, v39, v75
    v_mul_f32 v40, v40, v76
    v_mfma_f32_32x32x16_bf16 v[20:35], a[52:55], v[68:71], v[20:35]
    ds_read_b128 v[68:71], v1 offset:768
    s_waitcnt lgkmcnt(3)
    v_mul_f32 v41, v41, v77
    v_mul_f32 v42, v42, v78
    v_mul_f32 v43, v43, v79
    v_cvt_pk_bf16_f32 v36, v36, v37
    v_mfma_f32_32x32x16_bf16 v[20:35], a[64:67], v[52:55], v[20:35]
    ds_read_b128 v[52:55], v2 offset:768
    v_cvt_pk_bf16_f32 v37, v38, v39
    v_cvt_pk_bf16_f32 v38, v40, v41
    v_cvt_pk_bf16_f32 v39, v42, v43
    buffer_store_dwordx4 v[36:39], v5, s[8:11], s43 offen offset:1024 sc1
    v_mfma_f32_32x32x16_bf16 v[20:35], a[76:79], v[56:59], v[20:35]
    ds_read_b128 v[56:59], v16 offset:768
    s_waitcnt lgkmcnt(3)
    v_mfma_f32_32x32x16_bf16 v[20:35], a[88:91], v[60:63], v[20:35]
    ds_read_b128 v[60:63], v17 offset:768
    v_mfma_f32_32x32x16_bf16 v[20:35], a[100:103], v[64:67], v[20:35]
    ds_read_b128 v[64:67], v1 offset:896
    s_waitcnt lgkmcnt(3)
    v_mfma_f32_32x32x16_bf16 v[20:35], a[112:115], v[68:71], v[20:35]
    ds_read_b128 v[68:71], v2 offset:896
    v_mfma_f32_32x32x16_bf16 v[20:35], a[124:127], v[52:55], v[20:35]
    ds_read_b128 v[52:55], v16 offset:896
    s_waitcnt lgkmcnt(3)
    v_mfma_f32_32x32x16_bf16 v[20:35], a[136:139], v[56:59], v[20:35]
    ds_read_b128 v[56:59], v17 offset:896
    v_mfma_f32_32x32x16_bf16 v[20:35], a[148:151], v[60:63], v[20:35]
    ds_read_b128 v[60:63], v1 offset:1024
    s_waitcnt lgkmcnt(3)
    v_mfma_f32_32x32x16_bf16 v[20:35], a[160:163], v[64:67], v[20:35]
    ds_read_b128 v[64:67], v2 offset:1024
    v_mfma_f32_32x32x16_bf16 v[20:35], a[172:175], v[68:71], v[20:35]
    ds_read_b128 v[68:71], v16 offset:1024
    s_waitcnt lgkmcnt(3)
    v_mfma_f32_32x32x16_bf16 v[20:35], a[184:187], v[52:55], v[20:35]
    ds_read_b128 v[52:55], v17 offset:1024
    v_mfma_f32_32x32x16_bf16 v[20:35], a[196:199], v[56:59], v[20:35]
    ds_read_b128 v[56:59], v1 offset:0
    s_waitcnt lgkmcnt(3)
    v_mfma_f32_32x32x16_bf16 v[20:35], a[208:211], v[60:63], v[20:35]
    ds_read_b128 v[60:63], v2 offset:0
    v_mfma_f32_32x32x16_bf16 v[20:35], a[220:223], v[64:67], v[20:35]
    ds_read_b128 v[64:67], v16 offset:0
    s_waitcnt lgkmcnt(3)
    v_mfma_f32_32x32x16_bf16 v[20:35], a[232:235], v[68:71], v[20:35]
    ds_read_b128 v[68:71], v17 offset:0
    v_mfma_f32_32x32x16_bf16 v[20:35], a[244:247], v[52:55], v[20:35]
    ds_read_b128 v[52:55], v1 offset:128
    s_waitcnt lgkmcnt(3)
    v_mfma_f32_32x32x16_bf16 v[36:51], v[84:87], v[56:59], 0
    ds_read_b128 v[56:59], v2 offset:128
    v_mfma_f32_32x32x16_bf16 v[36:51], v[96:99], v[60:63], v[36:51]
    ds_read_b128 v[60:63], v16 offset:128
    s_waitcnt lgkmcnt(3)
    v_mfma_f32_32x32x16_bf16 v[36:51], v[108:111], v[64:67], v[36:51]
    ds_read_b128 v[64:67], v17 offset:128
    v_mfma_f32_32x32x16_bf16 v[36:51], v[120:123], v[68:71], v[36:51]
    ds_read_b128 v[68:71], v1 offset:256
    s_waitcnt lgkmcnt(3)
    v_mul_f32 v72, v20, v20
    v_mul_f32 v73, v21, v21
    v_mul_f32 v74, v22, v22
    v_mul_f32 v75, v23, v23
    v_mfma_f32_32x32x16_bf16 v[36:51], v[132:135], v[52:55], v[36:51]
    ds_read_b128 v[52:55], v2 offset:256
    v_mul_f32 v76, v24, v24
    v_mul_f32 v77, v25, v25
    v_mul_f32 v78, v26, v26
    v_mul_f32 v79, v27, v27
    v_fma_f32 v72, v72, s42, v15
    v_mfma_f32_32x32x16_bf16 v[36:51], v[144:147], v[56:59], v[36:51]
    ds_read_b128 v[56:59], v16 offset:256
    s_waitcnt lgkmcnt(3)
    v_fma_f32 v73, v73, s42, v15
    v_fma_f32 v74, v74, s42, v15
    v_fma_f32 v75, v75, s42, v15
    v_fma_f32 v76, v76, s42, v15
    v_mfma_f32_32x32x16_bf16 v[36:51], v[156:159], v[60:63], v[36:51]
    ds_read_b128 v[60:63], v17 offset:256
    v_fma_f32 v77, v77, s42, v15
    v_fma_f32 v78, v78, s42, v15
    v_fma_f32 v79, v79, s42, v15
    v_mul_f32 v72, v72, v20
    v_mul_f32 v73, v73, v21
    v_mfma_f32_32x32x16_bf16 v[36:51], v[168:171], v[64:67], v[36:51]
    ds_read_b128 v[64:67], v1 offset:384
    s_waitcnt lgkmcnt(3)
    v_mul_f32 v74, v74, v22
    v_mul_f32 v75, v75, v23
    v_mul_f32 v76, v76, v24
    v_mul_f32 v77, v77, v25
    v_mfma_f32_32x32x16_bf16 v[36:51], v[180:183], v[68:71], v[36:51]
    ds_read_b128 v[68:71], v2 offset:384
    v_mul_f32 v78, v78, v26
    v_mul_f32 v79, v79, v27
    v_exp_f32 v72, v72
    v_mfma_f32_32x32x16_bf16 v[36:51], v[192:195], v[52:55], v[36:51]
    ds_read_b128 v[52:55], v16 offset:384
    s_waitcnt lgkmcnt(3)
    v_exp_f32 v73, v73
    v_exp_f32 v74, v74
    v_mfma_f32_32x32x16_bf16 v[36:51], v[204:207], v[56:59], v[36:51]
    ds_read_b128 v[56:59], v17 offset:384
    buffer_load_dword v4, v3, s[4:7], s33 offen sc1
    v_exp_f32 v75, v75
    v_mfma_f32_32x32x16_bf16 v[36:51], v[216:219], v[60:63], v[36:51]
    ds_read_b128 v[60:63], v1 offset:512
    s_waitcnt lgkmcnt(3)
    s_waitcnt vmcnt(1)
    s_or_b32 s28, s39, s40
    s_mov_b64 exec, 1
    buffer_store_dword v2, off, s[4:7], s28 sc1
    s_mov_b64 exec, -1
    v_mfma_f32_32x32x16_bf16 v[36:51], v[228:231], v[64:67], v[36:51]
    ds_read_b128 v[64:67], v2 offset:512
    v_exp_f32 v76, v76
    v_exp_f32 v77, v77
    v_mfma_f32_32x32x16_bf16 v[36:51], v[240:243], v[68:71], v[36:51]
    ds_read_b128 v[68:71], v16 offset:512
    s_waitcnt lgkmcnt(3)
    v_exp_f32 v78, v78
    v_exp_f32 v79, v79
    v_mfma_f32_32x32x16_bf16 v[36:51], v[252:255], v[52:55], v[36:51]
    ds_read_b128 v[52:55], v17 offset:512
    v_mul_f32 v20, v20, v28
    v_mul_f32 v21, v21, v29
    v_mul_f32 v22, v22, v30
    v_mul_f32 v23, v23, v31
    v_mul_f32 v24, v24, v32
    v_mfma_f32_32x32x16_bf16 v[36:51], a[8:11], v[56:59], v[36:51]
    ds_read_b128 v[56:59], v1 offset:640
    s_waitcnt lgkmcnt(3)
    v_mul_f32 v25, v25, v33
    v_mul_f32 v26, v26, v34
    v_mul_f32 v27, v27, v35
    v_add_f32 v72, 1.0, v72
    v_mfma_f32_32x32x16_bf16 v[36:51], a[20:23], v[60:63], v[36:51]
    ds_read_b128 v[60:63], v2 offset:640
    v_add_f32 v73, 1.0, v73
    v_add_f32 v74, 1.0, v74
    v_add_f32 v75, 1.0, v75
    v_add_f32 v76, 1.0, v76
    v_add_f32 v77, 1.0, v77
    v_mfma_f32_32x32x16_bf16 v[36:51], a[32:35], v[64:67], v[36:51]
    ds_read_b128 v[64:67], v16 offset:640
    s_waitcnt lgkmcnt(3)
    v_add_f32 v78, 1.0, v78
    v_add_f32 v79, 1.0, v79
    v_rcp_f32 v72, v72
    v_mfma_f32_32x32x16_bf16 v[36:51], a[44:47], v[68:71], v[36:51]
    ds_read_b128 v[68:71], v17 offset:640
    v_rcp_f32 v73, v73
    v_rcp_f32 v74, v74
    v_mfma_f32_32x32x16_bf16 v[36:51], a[56:59], v[52:55], v[36:51]
    ds_read_b128 v[52:55], v1 offset:768
    s_waitcnt lgkmcnt(3)
    v_rcp_f32 v75, v75
    v_rcp_f32 v76, v76
    v_mfma_f32_32x32x16_bf16 v[36:51], a[68:71], v[56:59], v[36:51]
    ds_read_b128 v[56:59], v2 offset:768
    v_rcp_f32 v77, v77
    v_rcp_f32 v78, v78
    v_mfma_f32_32x32x16_bf16 v[36:51], a[80:83], v[60:63], v[36:51]
    ds_read_b128 v[60:63], v16 offset:768
    s_waitcnt lgkmcnt(3)
    v_rcp_f32 v79, v79
    v_mul_f32 v20, v20, v72
    v_mul_f32 v21, v21, v73
    v_mfma_f32_32x32x16_bf16 v[36:51], a[92:95], v[64:67], v[36:51]
    ds_read_b128 v[64:67], v17 offset:768
    v_mul_f32 v22, v22, v74
    v_mul_f32 v23, v23, v75
    v_mul_f32 v24, v24, v76
    v_mul_f32 v25, v25, v77
    v_mul_f32 v26, v26, v78
    v_mfma_f32_32x32x16_bf16 v[36:51], a[104:107], v[68:71], v[36:51]
    ds_read_b128 v[68:71], v1 offset:896
    s_waitcnt lgkmcnt(3)
    v_mul_f32 v27, v27, v79
    v_cvt_pk_bf16_f32 v20, v20, v21
    v_cvt_pk_bf16_f32 v21, v22, v23
    v_cvt_pk_bf16_f32 v22, v24, v25
    v_mfma_f32_32x32x16_bf16 v[36:51], a[116:119], v[52:55], v[36:51]
    ds_read_b128 v[52:55], v2 offset:896
    v_cvt_pk_bf16_f32 v23, v26, v27
    buffer_store_dwordx4 v[20:23], v5, s[4:7], s37 offen offset:0 sc1
    v_mfma_f32_32x32x16_bf16 v[36:51], a[128:131], v[56:59], v[36:51]
    ds_read_b128 v[56:59], v16 offset:896
    s_waitcnt lgkmcnt(3)
    v_mfma_f32_32x32x16_bf16 v[36:51], a[140:143], v[60:63], v[36:51]
    ds_read_b128 v[60:63], v17 offset:896
    v_mfma_f32_32x32x16_bf16 v[36:51], a[152:155], v[64:67], v[36:51]
    ds_read_b128 v[64:67], v1 offset:1024
    s_waitcnt lgkmcnt(3)
    v_mfma_f32_32x32x16_bf16 v[36:51], a[164:167], v[68:71], v[36:51]
    ds_read_b128 v[68:71], v2 offset:1024
    v_mfma_f32_32x32x16_bf16 v[36:51], a[176:179], v[52:55], v[36:51]
    ds_read_b128 v[52:55], v16 offset:1024
    s_waitcnt lgkmcnt(3)
    v_mfma_f32_32x32x16_bf16 v[36:51], a[188:191], v[56:59], v[36:51]
    ds_read_b128 v[56:59], v17 offset:1024
    v_mfma_f32_32x32x16_bf16 v[36:51], a[200:203], v[60:63], v[36:51]
    ds_read_b128 v[60:63], v1 offset:0
    s_waitcnt lgkmcnt(3)
    v_mfma_f32_32x32x16_bf16 v[36:51], a[212:215], v[64:67], v[36:51]
    ds_read_b128 v[64:67], v2 offset:0
    v_mfma_f32_32x32x16_bf16 v[36:51], a[224:227], v[68:71], v[36:51]
    ds_read_b128 v[68:71], v16 offset:0
    s_waitcnt lgkmcnt(3)
    v_mfma_f32_32x32x16_bf16 v[36:51], a[236:239], v[52:55], v[36:51]
    ds_read_b128 v[52:55], v17 offset:0
    s_waitcnt vmcnt(2)
    v_cmp_eq_u32 vcc, 0, v4
    s_nop 0
    s_cmp_eq_u64 vcc, 0
    s_cselect_b32 s10, 268435456, 0
    s_cmp_eq_u32 s30, 63
    s_cselect_b32 s10, 0, s10
    v_mfma_f32_32x32x16_bf16 v[36:51], a[248:251], v[56:59], v[36:51]
    ds_read_b128 v[56:59], v1 offset:128
    s_waitcnt lgkmcnt(3)
    s_add_u32 m0, s34, 0
    s_nop 0
    buffer_load_dwordx4 v6, s[8:11], s32 offen offset:0 sc1 lds
    v_mfma_f32_32x32x16_bf16 v[20:35], v[88:91], v[60:63], 0
    ds_read_b128 v[60:63], v2 offset:128
    buffer_load_dwordx4 v7, s[8:11], s32 offen offset:1024 sc1 lds
    v_mfma_f32_32x32x16_bf16 v[20:35], v[100:103], v[64:67], v[20:35]
    ds_read_b128 v[64:67], v16 offset:128
    s_waitcnt lgkmcnt(3)
    buffer_load_dwordx4 v8, s[8:11], s32 offen offset:2048 sc1 lds
    v_mfma_f32_32x32x16_bf16 v[20:35], v[112:115], v[68:71], v[20:35]
    ds_read_b128 v[68:71], v17 offset:128
    buffer_load_dwordx4 v9, s[8:11], s32 offen offset:3072 sc1 lds
    v_mfma_f32_32x32x16_bf16 v[20:35], v[124:127], v[52:55], v[20:35]
    ds_read_b128 v[52:55], v1 offset:256
    s_waitcnt lgkmcnt(3)
    s_add_u32 m0, s34, 4096
    s_nop 0
    buffer_load_dwordx4 v10, s[8:11], s32 offen offset:0 sc1 lds
    v_mfma_f32_32x32x16_bf16 v[20:35], v[136:139], v[56:59], v[20:35]
    ds_read_b128 v[56:59], v2 offset:256
    buffer_load_dwordx4 v11, s[8:11], s32 offen offset:1024 sc1 lds
    v_mul_f32 v72, v36, v36
    v_mul_f32 v73, v37, v37
    v_mfma_f32_32x32x16_bf16 v[20:35], v[148:151], v[60:63], v[20:35]
    ds_read_b128 v[60:63], v16 offset:256
    s_waitcnt lgkmcnt(3)
    buffer_load_dwordx4 v12, s[8:11], s32 offen offset:2048 sc1 lds
    v_mul_f32 v74, v38, v38
    v_mfma_f32_32x32x16_bf16 v[20:35], v[160:163], v[64:67], v[20:35]
    ds_read_b128 v[64:67], v17 offset:256
    buffer_load_dwordx4 v13, s[8:11], s32 offen offset:3072 sc1 lds
    v_mul_f32 v75, v39, v39
    v_mul_f32 v76, v40, v40
    v_mfma_f32_32x32x16_bf16 v[20:35], v[172:175], v[68:71], v[20:35]
    ds_read_b128 v[68:71], v1 offset:384
    s_waitcnt lgkmcnt(3)
    s_add_u32 m0, s34, 8192
    s_nop 0
    buffer_load_dwordx4 v14, s[8:11], s32 offen offset:0 sc1 lds
    v_mfma_f32_32x32x16_bf16 v[20:35], v[184:187], v[52:55], v[20:35]
    ds_read_b128 v[52:55], v2 offset:384
    v_mul_f32 v77, v41, v41
    v_mul_f32 v78, v42, v42
    v_mul_f32 v79, v43, v43
    v_fma_f32 v72, v72, s42, v15
    v_fma_f32 v73, v73, s42, v15
    v_mfma_f32_32x32x16_bf16 v[20:35], v[196:199], v[56:59], v[20:35]
    ds_read_b128 v[56:59], v16 offset:384
    s_waitcnt lgkmcnt(3)
    v_fma_f32 v74, v74, s42, v15
    v_fma_f32 v75, v75, s42, v15
    v_fma_f32 v76, v76, s42, v15
    v_fma_f32 v77, v77, s42, v15
    v_mfma_f32_32x32x16_bf16 v[20:35], v[208:211], v[60:63], v[20:35]
    ds_read_b128 v[60:63], v17 offset:384
    v_fma_f32 v78, v78, s42, v15
    v_fma_f32 v79, v79, s42, v15
    v_mul_f32 v72, v72, v36
    v_mul_f32 v73, v73, v37
    v_mul_f32 v74, v74, v38
    v_mfma_f32_32x32x16_bf16 v[20:35], v[220:223], v[64:67], v[20:35]
    ds_read_b128 v[64:67], v1 offset:512
    s_waitcnt lgkmcnt(3)
    v_mul_f32 v75, v75, v39
    v_mul_f32 v76, v76, v40
    v_mul_f32 v77, v77, v41
    v_mul_f32 v78, v78, v42
    v_mfma_f32_32x32x16_bf16 v[20:35], v[232:235], v[68:71], v[20:35]
    ds_read_b128 v[68:71], v2 offset:512
    v_mul_f32 v79, v79, v43
    v_exp_f32 v72, v72
    v_exp_f32 v73, v73
    v_mfma_f32_32x32x16_bf16 v[20:35], v[244:247], v[52:55], v[20:35]
    ds_read_b128 v[52:55], v16 offset:512
    s_waitcnt lgkmcnt(3)
    v_exp_f32 v74, v74
    v_exp_f32 v75, v75
    v_mfma_f32_32x32x16_bf16 v[20:35], a[0:3], v[56:59], v[20:35]
    ds_read_b128 v[56:59], v17 offset:512
    v_exp_f32 v76, v76
    v_exp_f32 v77, v77
    v_mfma_f32_32x32x16_bf16 v[20:35], a[12:15], v[60:63], v[20:35]
    ds_read_b128 v[60:63], v1 offset:640
    s_waitcnt lgkmcnt(3)
    v_exp_f32 v78, v78
    v_exp_f32 v79, v79
    v_mfma_f32_32x32x16_bf16 v[20:35], a[24:27], v[64:67], v[20:35]
    ds_read_b128 v[64:67], v2 offset:640
    v_mul_f32 v36, v36, v44
    v_mul_f32 v37, v37, v45
    v_mul_f32 v38, v38, v46
    v_mul_f32 v39, v39, v47
    v_mul_f32 v40, v40, v48
    v_mfma_f32_32x32x16_bf16 v[20:35], a[36:39], v[68:71], v[20:35]
    ds_read_b128 v[68:71], v16 offset:640
    s_waitcnt lgkmcnt(3)
    v_mul_f32 v41, v41, v49
    v_mul_f32 v42, v42, v50
    v_mul_f32 v43, v43, v51
    v_add_f32 v72, 1.0, v72
    v_mfma_f32_32x32x16_bf16 v[20:35], a[48:51], v[52:55], v[20:35]
    ds_read_b128 v[52:55], v17 offset:640
    v_add_f32 v73, 1.0, v73
    v_add_f32 v74, 1.0, v74
    v_add_f32 v75, 1.0, v75
    v_add_f32 v76, 1.0, v76
    v_add_f32 v77, 1.0, v77
    v_mfma_f32_32x32x16_bf16 v[20:35], a[60:63], v[56:59], v[20:35]
    ds_read_b128 v[56:59], v1 offset:768
    s_waitcnt lgkmcnt(3)
    v_add_f32 v78, 1.0, v78
    v_add_f32 v79, 1.0, v79
    v_rcp_f32 v72, v72
    v_mfma_f32_32x32x16_bf16 v[20:35], a[72:75], v[60:63], v[20:35]
    ds_read_b128 v[60:63], v2 offset:768
    v_rcp_f32 v73, v73
    v_rcp_f32 v74, v74
    v_mfma_f32_32x32x16_bf16 v[20:35], a[84:87], v[64:67], v[20:35]
    ds_read_b128 v[64:67], v16 offset:768
    s_waitcnt lgkmcnt(3)
    v_rcp_f32 v75, v75
    v_rcp_f32 v76, v76
    v_mfma_f32_32x32x16_bf16 v[20:35], a[96:99], v[68:71], v[20:35]
    ds_read_b128 v[68:71], v17 offset:768
    v_rcp_f32 v77, v77
    v_rcp_f32 v78, v78
    v_mfma_f32_32x32x16_bf16 v[20:35], a[108:111], v[52:55], v[20:35]
    ds_read_b128 v[52:55], v1 offset:896
    s_waitcnt lgkmcnt(3)
    v_rcp_f32 v79, v79
    v_mul_f32 v36, v36, v72
    v_mul_f32 v37, v37, v73
    v_mfma_f32_32x32x16_bf16 v[20:35], a[120:123], v[56:59], v[20:35]
    ds_read_b128 v[56:59], v2 offset:896
    v_mul_f32 v38, v38, v74
    v_mul_f32 v39, v39, v75
    v_mul_f32 v40, v40, v76
    v_mul_f32 v41, v41, v77
    v_mul_f32 v42, v42, v78
    v_mfma_f32_32x32x16_bf16 v[20:35], a[132:135], v[60:63], v[20:35]
    ds_read_b128 v[60:63], v16 offset:896
    s_waitcnt lgkmcnt(3)
    v_mul_f32 v43, v43, v79
    v_cvt_pk_bf16_f32 v36, v36, v37
    v_cvt_pk_bf16_f32 v37, v38, v39
    v_cvt_pk_bf16_f32 v38, v40, v41
    v_mfma_f32_32x32x16_bf16 v[20:35], a[144:147], v[64:67], v[20:35]
    ds_read_b128 v[64:67], v17 offset:896
    v_cvt_pk_bf16_f32 v39, v42, v43
    buffer_store_dwordx4 v[36:39], v5, s[4:7], s37 offen offset:512 sc1
    v_mfma_f32_32x32x16_bf16 v[20:35], a[156:159], v[68:71], v[20:35]
    ds_read_b128 v[68:71], v1 offset:1024
    s_waitcnt lgkmcnt(3)
    v_mfma_f32_32x32x16_bf16 v[20:35], a[168:171], v[52:55], v[20:35]
    ds_read_b128 v[52:55], v2 offset:1024
    v_mfma_f32_32x32x16_bf16 v[20:35], a[180:183], v[56:59], v[20:35]
    ds_read_b128 v[56:59], v16 offset:1024
    s_waitcnt lgkmcnt(3)
    v_mfma_f32_32x32x16_bf16 v[20:35], a[192:195], v[60:63], v[20:35]
    ds_read_b128 v[60:63], v17 offset:1024
    v_mfma_f32_32x32x16_bf16 v[20:35], a[204:207], v[64:67], v[20:35]
    s_waitcnt lgkmcnt(2)
    s_add_u32 s39, s39, 4
    s_mov_b32 s40, 0
    v_add_u32 v1, s44, v1
    v_add_u32 v2, s44, v2
    v_add_u32 v16, s44, v16
    v_mfma_f32_32x32x16_bf16 v[20:35], a[216:219], v[68:71], v[20:35]
    v_add_u32 v17, s44, v17
    s_sub_u32 s44, 0, s44
    s_mov_b32 s43, s37
    s_add_u32 s37, s37, 294912
    v_mfma_f32_32x32x16_bf16 v[20:35], a[228:231], v[52:55], v[20:35]
    s_waitcnt lgkmcnt(1)
    v_mfma_f32_32x32x16_bf16 v[20:35], a[240:243], v[56:59], v[20:35]
    s_waitcnt lgkmcnt(0)
    v_mfma_f32_32x32x16_bf16 v[20:35], a[252:255], v[60:63], v[20:35]
    s_add_u32 s30, s30, 1
    s_cmp_lg_u32 s10, 0
    s_waitcnt vmcnt(1)
    s_cbranch_scc1 L_up_1
    s_nop 7
    v_pk_mul_f32 v[72:73], v[20:21], v[20:21]
    v_pk_mul_f32 v[74:75], v[22:23], v[22:23]
    v_pk_mul_f32 v[76:77], v[24:25], v[24:25]
    v_pk_mul_f32 v[78:79], v[26:27], v[26:27]
    v_pk_fma_f32 v[72:73], v[72:73], v[18:19], v[18:19] op_sel:[0,0,1] op_sel_hi:[1,0,1]
    v_pk_fma_f32 v[74:75], v[74:75], v[18:19], v[18:19] op_sel:[0,0,1] op_sel_hi:[1,0,1]
    v_pk_fma_f32 v[76:77], v[76:77], v[18:19], v[18:19] op_sel:[0,0,1] op_sel_hi:[1,0,1]
    v_pk_fma_f32 v[78:79], v[78:79], v[18:19], v[18:19] op_sel:[0,0,1] op_sel_hi:[1,0,1]
    v_pk_mul_f32 v[72:73], v[72:73], v[20:21]
    v_pk_mul_f32 v[74:75], v[74:75], v[22:23]
    v_pk_mul_f32 v[76:77], v[76:77], v[24:25]
    v_pk_mul_f32 v[78:79], v[78:79], v[26:27]
    v_exp_f32 v72, v72
    v_exp_f32 v73, v73
    v_exp_f32 v74, v74
    v_exp_f32 v75, v75
    v_exp_f32 v76, v76
    v_exp_f32 v77, v77
    v_exp_f32 v78, v78
    v_exp_f32 v79, v79
    v_pk_mul_f32 v[20:21], v[20:21], v[28:29]
    v_pk_mul_f32 v[22:23], v[22:23], v[30:31]
    v_pk_mul_f32 v[24:25], v[24:25], v[32:33]
    v_pk_mul_f32 v[26:27], v[26:27], v[34:35]
    v_pk_add_f32 v[72:73], v[72:73], 1.0 op_sel_hi:[1,0]
    v_pk_add_f32 v[74:75], v[74:75], 1.0 op_sel_hi:[1,0]
    v_pk_add_f32 v[76:77], v[76:77], 1.0 op_sel_hi:[1,0]
    v_pk_add_f32 v[78:79], v[78:79], 1.0 op_sel_hi:[1,0]
    v_rcp_f32 v72, v72
    v_rcp_f32 v73, v73
    v_rcp_f32 v74, v74
    v_rcp_f32 v75, v75
    v_rcp_f32 v76, v76
    v_rcp_f32 v77, v77
    v_rcp_f32 v78, v78
    v_rcp_f32 v79, v79
    v_pk_mul_f32 v[20:21], v[20:21], v[72:73]
    v_pk_mul_f32 v[22:23], v[22:23], v[74:75]
    v_pk_mul_f32 v[24:25], v[24:25], v[76:77]
    v_pk_mul_f32 v[26:27], v[26:27], v[78:79]
    v_cvt_pk_bf16_f32 v20, v20, v21
    v_cvt_pk_bf16_f32 v21, v22, v23
    v_cvt_pk_bf16_f32 v22, v24, v25
    v_cvt_pk_bf16_f32 v23, v26, v27
    buffer_store_dwordx4 v[20:23], v5, s[4:7], s43 offen offset:1024 sc1
    s_mov_b32 s23, 32768
    s_mov_b32 s29, 8
L_spin_45:
    s_sub_u32 s23, s23, 1
    s_cbranch_scc1 L_abort
    s_sleep 2
    buffer_load_dword v4, v3, s[4:7], s33 offen sc1
    s_waitcnt vmcnt(0)
    s_or_b32 s28, s39, s40
    s_mov_b64 exec, 1
    buffer_store_dword v2, off, s[4:7], s28 sc1
    s_mov_b64 exec, -1
    s_mov_b32 s40, 1073741824
    s_cmp_eq_u32 s30, 64
    s_cbranch_scc1 L_up_done
    v_cmp_eq_u32 vcc, 0, v4
    s_cbranch_vccnz L_spin_45
    s_add_u32 m0, s34, 0
    s_nop 0
    buffer_load_dwordx4 v6, s[4:7], s32 offen offset:0 sc1 lds
    buffer_load_dwordx4 v7, s[4:7], s32 offen offset:1024 sc1 lds
    buffer_load_dwordx4 v8, s[4:7], s32 offen offset:2048 sc1 lds
    buffer_load_dwordx4 v9, s[4:7], s32 offen offset:3072 sc1 lds
    s_add_u32 m0, s34, 4096
    s_nop 0
    buffer_load_dwordx4 v10, s[4:7], s32 offen offset:0 sc1 lds
    buffer_load_dwordx4 v11, s[4:7], s32 offen offset:1024 sc1 lds
    buffer_load_dwordx4 v12, s[4:7], s32 offen offset:2048 sc1 lds
    buffer_load_dwordx4 v13, s[4:7], s32 offen offset:3072 sc1 lds
    s_add_u32 m0, s34, 8192
    s_nop 0
    buffer_load_dwordx4 v14, s[4:7], s32 offen offset:0 sc1 lds
    s_waitcnt vmcnt(0)
    s_branch L_up_1
L_up_1:
    s_barrier
    ds_read_b128 v[52:55], v1 offset:0
    ds_read_b128 v[56:59], v2 offset:0
    ds_read_b128 v[60:63], v16 offset:0
    ds_read_b128 v[64:67], v17 offset:0
    ds_read_b128 v[68:71], v1 offset:128
    s_add_u32 s32, s32, 36864
    s_add_u32 s33, s33, 4
    s_add_u32 s34, s34, s44
    s_waitcnt lgkmcnt(3)
    v_mfma_f32_32x32x16_bf16 v[36:51], v[80:83], v[52:55], 0
    ds_read_b128 v[52:55], v2 offset:128
    v_mfma_f32_32x32x16_bf16 v[36:51], v[92:95], v[56:59], v[36:51]
    ds_read_b128 v[56:59], v16 offset:128
    s_waitcnt lgkmcnt(3)
    v_mul_f32 v72, v20, v20
    v_mul_f32 v73, v21, v21
    v_mul_f32 v74, v22, v22
    v_mul_f32 v75, v23, v23
    v_mfma_f32_32x32x16_bf16 v[36:51], v[104:107], v[60:63], v[36:51]
    ds_read_b128 v[60:63], v17 offset:128
    v_mul_f32 v76, v24, v24
    v_mul_f32 v77, v25, v25
    v_mul_f32 v78, v26, v26
    v_mul_f32 v79, v27, v27
    v_fma_f32 v72, v72, s42, v15
    v_mfma_f32_32x32x16_bf16 v[36:51], v[116:119], v[64:67], v[36:51]
    ds_read_b128 v[64:67], v1 offset:256
    s_waitcnt lgkmcnt(3)
    v_fma_f32 v73, v73, s42, v15
    v_fma_f32 v74, v74, s42, v15
    v_fma_f32 v75, v75, s42, v15
    v_fma_f32 v76, v76, s42, v15
    v_mfma_f32_32x32x16_bf16 v[36:51], v[128:131], v[68:71], v[36:51]
    ds_read_b128 v[68:71], v2 offset:256
    v_fma_f32 v77, v77, s42, v15
    v_fma_f32 v78, v78, s42, v15
    v_fma_f32 v79, v79, s42, v15
    v_mul_f32 v72, v72, v20
    v_mul_f32 v73, v73, v21
    v_mfma_f32_32x32x16_bf16 v[36:51], v[140:143], v[52:55], v[36:51]
    ds_read_b128 v[52:55], v16 offset:256
    s_waitcnt lgkmcnt(3)
    v_mul_f32 v74, v74, v22
    v_mul_f32 v75, v75, v23
    v_mul_f32 v76, v76, v24
    v_mul_f32 v77, v77, v25
    v_mfma_f32_32x32x16_bf16 v[36:51], v[152:155], v[56:59], v[36:51]
    ds_read_b128 v[56:59], v17 offset:256
    v_mul_f32 v78, v78, v26
    v_mul_f32 v79, v79, v27
    v_exp_f32 v72, v72
    v_mfma_f32_32x32x16_bf16 v[36:51], v[164:167], v[60:63], v[36:51]
    ds_read_b128 v[60:63], v1 offset:384
    s_waitcnt lgkmcnt(3)
    v_exp_f32 v73, v73
    v_exp_f32 v74, v74
    v_mfma_f32_32x32x16_bf16 v[36:51], v[176:179], v[64:67], v[36:51]
    ds_read_b128 v[64:67], v2 offset:384
    v_exp_f32 v75, v75
    v_exp_f32 v76, v76
    v_mfma_f32_32x32x16_bf16 v[36:51], v[188:191], v[68:71], v[36:51]
    ds_read_b128 v[68:71], v16 offset:384
    s_waitcnt lgkmcnt(3)
    v_exp_f32 v77, v77
    v_exp_f32 v78, v78
    v_mfma_f32_32x32x16_bf16 v[36:51], v[200:203], v[52:55], v[36:51]
    ds_read_b128 v[52:55], v17 offset:384
    v_exp_f32 v79, v79
    v_mul_f32 v20, v20, v28
    v_mul_f32 v21, v21, v29
    v_mul_f32 v22, v22, v30
    v_mfma_f32_32x32x16_bf16 v[36:51], v[212:215], v[56:59], v[36:51]
    ds_read_b128 v[56:59], v1 offset:512
    s_waitcnt lgkmcnt(3)
    v_mul_f32 v23, v23, v31
    v_mul_f32 v24, v24, v32
    v_mul_f32 v25, v25, v33
    v_mul_f32 v26, v26, v34
    v_mfma_f32_32x32x16_bf16 v[36:51], v[224:227], v[60:63], v[36:51]
    ds_read_b128 v[60:63], v2 offset:512
    v_mul_f32 v27, v27, v35
    v_add_f32 v72, 1.0, v72
    v_add_f32 v73, 1.0, v73
    v_add_f32 v74, 1.0, v74
    v_add_f32 v75, 1.0, v75
    v_mfma_f32_32x32x16_bf16 v[36:51], v[236:239], v[64:67], v[36:51]
    ds_read_b128 v[64:67], v16 offset:512
    s_waitcnt lgkmcnt(3)
    v_add_f32 v76, 1.0, v76
    v_add_f32 v77, 1.0, v77
    v_add_f32 v78, 1.0, v78
    v_add_f32 v79, 1.0, v79
    v_mfma_f32_32x32x16_bf16 v[36:51], v[248:251], v[68:71], v[36:51]
    ds_read_b128 v[68:71], v17 offset:512
    v_rcp_f32 v72, v72
    v_rcp_f32 v73, v73
    v_mfma_f32_32x32x16_bf16 v[36:51], a[4:7], v[52:55], v[36:51]
    ds_read_b128 v[52:55], v1 offset:640
    s_waitcnt lgkmcnt(3)
    v_rcp_f32 v74, v74
    v_rcp_f32 v75, v75
    v_mfma_f32_32x32x16_bf16 v[36:51], a[16:19], v[56:59], v[36:51]
    ds_read_b128 v[56:59], v2 offset:640
    v_rcp_f32 v76, v76
    v_rcp_f32 v77, v77
    v_mfma_f32_32x32x16_bf16 v[36:51], a[28:31], v[60:63], v[36:51]
    ds_read_b128 v[60:63], v16 offset:640
    s_waitcnt lgkmcnt(3)
    v_rcp_f32 v78, v78
    v_rcp_f32 v79, v79
    v_mfma_f32_32x32x16_bf16 v[36:51], a[40:43], v[64:67], v[36:51]
    ds_read_b128 v[64:67], v17 offset:640
    v_mul_f32 v20, v20, v72
    v_mul_f32 v21, v21, v73
    v_mul_f32 v22, v22, v74
    v_mul_f32 v23, v23, v75
    v_mul_f32 v24, v24, v76
    v_mfma_f32_32x32x16_bf16 v[36:51], a[52:55], v[68:71], v[36:51]
    ds_read_b128 v[68:71], v1 offset:768
    s_waitcnt lgkmcnt(3)
    v_mul_f32 v25, v25, v77
    v_mul_f32 v26, v26, v78
    v_mul_f32 v27, v27, v79
    v_cvt_pk_bf16_f32 v20, v20, v21
    v_mfma_f32_32x32x16_bf16 v[36:51], a[64:67], v[52:55], v[36:51]
    ds_read_b128 v[52:55], v2 offset:768
    v_cvt_pk_bf16_f32 v21, v22, v23
    v_cvt_pk_bf16_f32 v22, v24, v25
    v_cvt_pk_bf16_f32 v23, v26, v27
    buffer_store_dwordx4 v[20:23], v5, s[8:11], s43 offen offset:1024 sc1
    v_mfma_f32_32x32x16_bf16 v[36:51], a[76:79], v[56:59], v[36:51]
    ds_read_b128 v[56:59], v16 offset:768
    s_waitcnt lgkmcnt(3)
    v_mfma_f32_32x32x16_bf16 v[36:51], a[88:91], v[60:63], v[36:51]
    ds_read_b128 v[60:63], v17 offset:768
    v_mfma_f32_32x32x16_bf16 v[36:51], a[100:103], v[64:67], v[36:51]
    ds_read_b128 v[64:67], v1 offset:896
    s_waitcnt lgkmcnt(3)
    v_mfma_f32_32x32x16_bf16 v[36:51], a[112:115], v[68:71], v[36:51]
    ds_read_b128 v[68:71], v2 offset:896
    v_mfma_f32_32x32x16_bf16 v[36:51], a[124:127], v[52:55], v[36:51]
    ds_read_b128 v[52:55], v16 offset:896
    s_waitcnt lgkmcnt(3)
    v_mfma_f32_32x32x16_bf16 v[36:51], a[136:139], v[56:59], v[36:51]
    ds_read_b128 v[56:59], v17 offset:896
    v_mfma_f32_32x32x16_bf16 v[36:51], a[148:151], v[60:63], v[36:51]
    ds_read_b128 v[60:63], v1 offset:1024
    s_waitcnt lgkmcnt(3)
    v_mfma_f32_32x32x16_bf16 v[36:51], a[160:163], v[64:67], v[36:51]
    ds_read_b128 v[64:67], v2 offset:1024
    v_mfma_f32_32x32x16_bf16 v[36:51], a[172:175], v[68:71], v[36:51]
    ds_read_b128 v[68:71], v16 offset:1024
    s_waitcnt lgkmcnt(3)
    v_mfma_f32_32x32x16_bf16 v[36:51], a[184:187], v[52:55], v[36:51]
    ds_read_b128 v[52:55], v17 offset:1024
    v_mfma_f32_32x32x16_bf16 v[36:51], a[196:199], v[56:59], v[36:51]
    ds_read_b128 v[56:59], v1 offset:0
    s_waitcnt lgkmcnt(3)
    v_mfma_f32_32x32x16_bf16 v[36:51], a[208:211], v[60:63], v[36:51]
    ds_read_b128 v[60:63], v2 offset:0
    v_mfma_f32_32x32x16_bf16 v[36:51], a[220:223], v[64:67], v[36:51]
    ds_read_b128 v[64:67], v16 offset:0
    s_waitcnt lgkmcnt(3)
    v_mfma_f32_32x32x16_bf16 v[36:51], a[232:235], v[68:71], v[36:51]
    ds_read_b128 v[68:71], v17 offset:0
    v_mfma_f32_32x32x16_bf16 v[36:51], a[244:247], v[52:55], v[36:51]
    ds_read_b128 v[52:55], v1 offset:128
    s_waitcnt lgkmcnt(3)
    v_mfma_f32_32x32x16_bf16 v[20:35], v[84:87], v[56:59], 0
    ds_read_b128 v[56:59], v2 offset:128
    v_mfma_f32_32x32x16_bf16 v[20:35], v[96:99], v[60:63], v[20:35]
    ds_read_b128 v[60:63], v16 offset:128
    s_waitcnt lgkmcnt(3)
    v_mfma_f32_32x32x16_bf16 v[20:35], v[108:111], v[64:67], v[20:35]
    ds_read_b128 v[64:67], v17 offset:128
    v_mfma_f32_32x32x16_bf16 v[20:35], v[120:123], v[68:71], v[20:35]
    ds_read_b128 v[68:71], v1 offset:256
    s_waitcnt lgkmcnt(3)
    v_mul_f32 v72, v36, v36
    v_mul_f32 v73, v37, v37
    v_mul_f32 v74, v38, v38
    v_mul_f32 v75, v39, v39
    v_mfma_f32_32x32x16_bf16 v[20:35], v[132:135], v[52:55], v[20:35]
    ds_read_b128 v[52:55], v2 offset:256
    v_mul_f32 v76, v40, v40
    v_mul_f32 v77, v41, v41
    v_mul_f32 v78, v42, v42
    v_mul_f32 v79, v43, v43
    v_fma_f32 v72, v72, s42, v15
    v_mfma_f32_32x32x16_bf16 v[20:35], v[144:147], v[56:59], v[20:35]
    ds_read_b128 v[56:59], v16 offset:256
    s_waitcnt lgkmcnt(3)
    v_fma_f32 v73, v73, s42, v15
    v_fma_f32 v74, v74, s42, v15
    v_fma_f32 v75, v75, s42, v15
    v_fma_f32 v76, v76, s42, v15
    v_mfma_f32_32x32x16_bf16 v[20:35], v[156:159], v[60:63], v[20:35]
    ds_read_b128 v[60:63], v17 offset:256
    v_fma_f32 v77, v77, s42, v15
    v_fma_f32 v78, v78, s42, v15
    v_fma_f32 v79, v79, s42, v15
    v_mul_f32 v72, v72, v36
    v_mul_f32 v73, v73, v37
    v_mfma_f32_32x32x16_bf16 v[20:35], v[168:171], v[64:67], v[20:35]
    ds_read_b128 v[64:67], v1 offset:384
    s_waitcnt lgkmcnt(3)
    v_mul_f32 v74, v74, v38
    v_mul_f32 v75, v75, v39
    v_mul_f32 v76, v76, v40
    v_mul_f32 v77, v77, v41
    v_mfma_f32_32x32x16_bf16 v[20:35], v[180:183], v[68:71], v[20:35]
    ds_read_b128 v[68:71], v2 offset:384
    v_mul_f32 v78, v78, v42
    v_mul_f32 v79, v79, v43
    v_exp_f32 v72, v72
    v_mfma_f32_32x32x16_bf16 v[20:35], v[192:195], v[52:55], v[20:35]
    ds_read_b128 v[52:55], v16 offset:384
    s_waitcnt lgkmcnt(3)
    v_exp_f32 v73, v73
    v_exp_f32 v74, v74
    v_mfma_f32_32x32x16_bf16 v[20:35], v[204:207], v[56:59], v[20:35]
    ds_read_b128 v[56:59], v17 offset:384
    buffer_load_dword v4, v3, s[4:7], s33 offen sc1
    v_exp_f32 v75, v75
    v_mfma_f32_32x32x16_bf16 v[20:35], v[216:219], v[60:63], v[20:35]
    ds_read_b128 v[60:63], v1 offset:512
    s_waitcnt lgkmcnt(3)
    s_waitcnt vmcnt(1)
    s_or_b32 s28, s39, s40
    s_mov_b64 exec, 1
    buffer_store_dword v2, off, s[4:7], s28 sc1
    s_mov_b64 exec, -1
    v_mfma_f32_32x32x16_bf16 v[20:35], v[228:231], v[64:67], v[20:35]
    ds_read_b128 v[64:67], v2 offset:512
    v_exp_f32 v76, v76
    v_exp_f32 v77, v77
    v_mfma_f32_32x32x16_bf16 v[20:35], v[240:243], v[68:71], v[20:35]
    ds_read_b128 v[68:71], v16 offset:512
    s_waitcnt lgkmcnt(3)
    v_exp_f32 v78, v78
    v_exp_f32 v79, v79
    v_mfma_f32_32x32x16_bf16 v[20:35], v[252:255], v[52:55], v[20:35]
    ds_read_b128 v[52:55], v17 offset:512
    v_mul_f32 v36, v36, v44
    v_mul_f32 v37, v37, v45
    v_mul_f32 v38, v38, v46
    v_mul_f32 v39, v39, v47
    v_mul_f32 v40, v40, v48
    v_mfma_f32_32x32x16_bf16 v[20:35], a[8:11], v[56:59], v[20:35]
    ds_read_b128 v[56:59], v1 offset:640
    s_waitcnt lgkmcnt(3)
    v_mul_f32 v41, v41, v49
    v_mul_f32 v42, v42, v50
    v_mul_f32 v43, v43, v51
    v_add_f32 v72, 1.0, v72
    v_mfma_f32_32x32x16_bf16 v[20:35], a[20:23], v[60:63], v[20:35]
    ds_read_b128 v[60:63], v2 offset:640
    v_add_f32 v73, 1.0, v73
    v_add_f32 v74, 1.0, v74
    v_add_f32 v75, 1.0, v75
    v_add_f32 v76, 1.0, v76
    v_add_f32 v77, 1.0, v77
    v_mfma_f32_32x32x16_bf16 v[20:35], a[32:35], v[64:67], v[20:35]
    ds_read_b128 v[64:67], v16 offset:640
    s_waitcnt lgkmcnt(3)
    v_add_f32 v78, 1.0, v78
    v_add_f32 v79, 1.0, v79
    v_rcp_f32 v72, v72
    v_mfma_f32_32x32x16_bf16 v[20:35], a[44:47], v[68:71], v[20:35]
    ds_read_b128 v[68:71], v17 offset:640
    v_rcp_f32 v73, v73
    v_rcp_f32 v74, v74
    v_mfma_f32_32x32x16_bf16 v[20:35], a[56:59], v[52:55], v[20:35]
    ds_read_b128 v[52:55], v1 offset:768
    s_waitcnt lgkmcnt(3)
    v_rcp_f32 v75, v75
    v_rcp_f32 v76, v76
    v_mfma_f32_32x32x16_bf16 v[20:35], a[68:71], v[56:59], v[20:35]
    ds_read_b128 v[56:59], v2 offset:768
    v_rcp_f32 v77, v77
    v_rcp_f32 v78, v78
    v_mfma_f32_32x32x16_bf16 v[20:35], a[80:83], v[60:63], v[20:35]
    ds_read_b128 v[60:63], v16 offset:768
    s_waitcnt lgkmcnt(3)
    v_rcp_f32 v79, v79
    v_mul_f32 v36, v36, v72
    v_mul_f32 v37, v37, v73
    v_mfma_f32_32x32x16_bf16 v[20:35], a[92:95], v[64:67], v[20:35]
    ds_read_b128 v[64:67], v17 offset:768
    v_mul_f32 v38, v38, v74
    v_mul_f32 v39, v39, v75
    v_mul_f32 v40, v40, v76
    v_mul_f32 v41, v41, v77
    v_mul_f32 v42, v42, v78
    v_mfma_f32_32x32x16_bf16 v[20:35], a[104:107], v[68:71], v[20:35]
    ds_read_b128 v[68:71], v1 offset:896
    s_waitcnt lgkmcnt(3)
    v_mul_f32 v43, v43, v79
    v_cvt_pk_bf16_f32 v36, v36, v37
    v_cvt_pk_bf16_f32 v37, v38, v39
    v_cvt_pk_bf16_f32 v38, v40, v41
    v_mfma_f32_32x32x16_bf16 v[20:35], a[116:119], v[52:55], v[20:35]
    ds_read_b128 v[52:55], v2 offset:896
    v_cvt_pk_bf16_f32 v39, v42, v43
    buffer_store_dwordx4 v[36:39], v5, s[4:7], s37 offen offset:0 sc1
    v_mfma_f32_32x32x16_bf16 v[20:35], a[128:131], v[56:59], v[20:35]
    ds_read_b128 v[56:59], v16 offset:896
    s_waitcnt lgkmcnt(3)
    v_mfma_f32_32x32x16_bf16 v[20:35], a[140:143], v[60:63], v[20:35]
    ds_read_b128 v[60:63], v17 offset:896
    v_mfma_f32_32x32x16_bf16 v[20:35], a[152:155], v[64:67], v[20:35]
    ds_read_b128 v[64:67], v1 offset:1024
    s_waitcnt lgkmcnt(3)
    v_mfma_f32_32x32x16_bf16 v[20:35], a[164:167], v[68:71], v[20:35]
    ds_read_b128 v[68:71], v2 offset:1024
    v_mfma_f32_32x32x16_bf16 v[20:35], a[176:179], v[52:55], v[20:35]
    ds_read_b128 v[52:55], v16 offset:1024
    s_waitcnt lgkmcnt(3)
    v_mfma_f32_32x32x16_bf16 v[20:35], a[188:191], v[56:59], v[20:35]
    ds_read_b128 v[56:59], v17 offset:1024
    v_mfma_f32_32x32x16_bf16 v[20:35], a[200:203], v[60:63], v[20:35]
    ds_read_b128 v[60:63], v1 offset:0
    s_waitcnt lgkmcnt(3)
    v_mfma_f32_32x32x16_bf16 v[20:35], a[212:215], v[64:67], v[20:35]
    ds_read_b128 v[64:67], v2 offset:0
    v_mfma_f32_32x32x16_bf16 v[20:35], a[224:227], v[68:71], v[20:35]
    ds_read_b128 v[68:71], v16 offset:0
    s_waitcnt lgkmcnt(3)
    v_mfma_f32_32x32x16_bf16 v[20:35], a[236:239], v[52:55], v[20:35]
    ds_read_b128 v[52:55], v17 offset:0
    s_waitcnt vmcnt(2)
    v_cmp_eq_u32 vcc, 0, v4
    s_nop 0
    s_cmp_eq_u64 vcc, 0
    s_cselect_b32 s10, 268435456, 0
    s_cmp_eq_u32 s30, 63
    s_cselect_b32 s10, 0, s10
    v_mfma_f32_32x32x16_bf16 v[20:35], a[248:251], v[56:59], v[20:35]
    ds_read_b128 v[56:59], v1 offset:128
    s_waitcnt lgkmcnt(3)
    s_add_u32 m0, s34, 0
    s_nop 0
    buffer_load_dwordx4 v6, s[8:11], s32 offen offset:0 sc1 lds
    v_mfma_f32_32x32x16_bf16 v[36:51], v[88:91], v[60:63], 0
    ds_read_b128 v[60:63], v2 offset:128
    buffer_load_dwordx4 v7, s[8:11], s32 offen offset:1024 sc1 lds
    v_mfma_f32_32x32x16_bf16 v[36:51], v[100:103], v[64:67], v[36:51]
    ds_read_b128 v[64:67], v16 offset:128
    s_waitcnt lgkmcnt(3)
    buffer_load_dwordx4 v8, s[8:11], s32 offen offset:2048 sc1 lds
    v_mfma_f32_32x32x16_bf16 v[36:51], v[112:115], v[68:71], v[36:51]
    ds_read_b128 v[68:71], v17 offset:128
    buffer_load_dwordx4 v9, s[8:11], s32 offen offset:3072 sc1 lds
    v_mfma_f32_32x32x16_bf16 v[36:51], v[124:127], v[52:55], v[36:51]
    ds_read_b128 v[52:55], v1 offset:256
    s_waitcnt lgkmcnt(3)
    s_add_u32 m0, s34, 4096
    s_nop 0
    buffer_load_dwordx4 v10, s[8:11], s32 offen offset:0 sc1 lds
    v_mfma_f32_32x32x16_bf16 v[36:51], v[136:139], v[56:59], v[36:51]
    ds_read_b128 v[56:59], v2 offset:256
    buffer_load_dwordx4 v11, s[8:11], s32 offen offset:1024 sc1 lds
    v_mul_f32 v72, v20, v20
    v_mul_f32 v73, v21, v21
    v_mfma_f32_32x32x16_bf16 v[36:51], v[148:151], v[60:63], v[36:51]
    ds_read_b128 v[60:63], v16 offset:256
    s_waitcnt lgkmcnt(3)
    buffer_load_dwordx4 v12, s[8:11], s32 offen offset:2048 sc1 lds
    v_mul_f32 v74, v22, v22
    v_mfma_f32_32x32x16_bf16 v[36:51], v[160:163], v[64:67], v[36:51]
    ds_read_b128 v[64:67], v17 offset:256
    buffer_load_dwordx4 v13, s[8:11], s32 offen offset:3072 sc1 lds
    v_mul_f32 v75, v23, v23
    v_mul_f32 v76, v24, v24
    v_mfma_f32_32x32x16_bf16 v[36:51], v[172:175], v[68:71], v[36:51]
    ds_read_b128 v[68:71], v1 offset:384
    s_waitcnt lgkmcnt(3)
    s_add_u32 m0, s34, 8192
    s_nop 0
    buffer_load_dwordx4 v14, s[8:11], s32 offen offset:0 sc1 lds
    v_mfma_f32_32x32x16_bf16 v[36:51], v[184:187], v[52:55], v[36:51]
    ds_read_b128 v[52:55], v2 offset:384
    v_mul_f32 v77, v25, v25
    v_mul_f32 v78, v26, v26
    v_mul_f32 v79, v27, v27
    v_fma_f32 v72, v72, s42, v15
    v_fma_f32 v73, v73, s42, v15
    v_mfma_f32_32x32x16_bf16 v[36:51], v[196:199], v[56:59], v[36:51]
    ds_read_b128 v[56:59], v16 offset:384
    s_waitcnt lgkmcnt(3)
    v_fma_f32 v74, v74, s42, v15
    v_fma_f32 v75, v75, s42, v15
    v_fma_f32 v76, v76, s42, v15
    v_fma_f32 v77, v77, s42, v15
    v_mfma_f32_32x32x16_bf16 v[36:51], v[208:211], v[60:63], v[36:51]
    ds_read_b128 v[60:63], v17 offset:384
    v_fma_f32 v78, v78, s42, v15
    v_fma_f32 v79, v79, s42, v15
    v_mul_f32 v72, v72, v20
    v_mul_f32 v73, v73, v21
    v_mul_f32 v74, v74, v22
    v_mfma_f32_32x32x16_bf16 v[36:51], v[220:223], v[64:67], v[36:51]
    ds_read_b128 v[64:67], v1 offset:512
    s_waitcnt lgkmcnt(3)
    v_mul_f32 v75, v75, v23
    v_mul_f32 v76, v76, v24
    v_mul_f32 v77, v77, v25
    v_mul_f32 v78, v78, v26
    v_mfma_f32_32x32x16_bf16 v[36:51], v[232:235], v[68:71], v[36:51]
    ds_read_b128 v[68:71], v2 offset:512
    v_mul_f32 v79, v79, v27
    v_exp_f32 v72, v72
    v_exp_f32 v73, v73
    v_mfma_f32_32x32x16_bf16 v[36:51], v[244:247], v[52:55], v[36:51]
    ds_read_b128 v[52:55], v16 offset:512
    s_waitcnt lgkmcnt(3)
    v_exp_f32 v74, v74
    v_exp_f32 v75, v75
    v_mfma_f32_32x32x16_bf16 v[36:51], a[0:3], v[56:59], v[36:51]
    ds_read_b128 v[56:59], v17 offset:512
    v_exp_f32 v76, v76
    v_exp_f32 v77, v77
    v_mfma_f32_32x32x16_bf16 v[36:51], a[12:15], v[60:63], v[36:51]
    ds_read_b128 v[60:63], v1 offset:640
    s_waitcnt lgkmcnt(3)
    v_exp_f32 v78, v78
    v_exp_f32 v79, v79
    v_mfma_f32_32x32x16_bf16 v[36:51], a[24:27], v[64:67], v[36:51]
    ds_read_b128 v[64:67], v2 offset:640
    v_mul_f32 v20, v20, v28
    v_mul_f32 v21, v21, v29
    v_mul_f32 v22, v22, v30
    v_mul_f32 v23, v23, v31
    v_mul_f32 v24, v24, v32
    v_mfma_f32_32x32x16_bf16 v[36:51], a[36:39], v[68:71], v[36:51]
    ds_read_b128 v[68:71], v16 offset:640
    s_waitcnt lgkmcnt(3)
    v_mul_f32 v25, v25, v33
    v_mul_f32 v26, v26, v34
    v_mul_f32 v27, v27, v35
    v_add_f32 v72, 1.0, v72
    v_mfma_f32_32x32x16_bf16 v[36:51], a[48:51], v[52:55], v[36:51]
    ds_read_b128 v[52:55], v17 offset:640
    v_add_f32 v73, 1.0, v73
    v_add_f32 v74, 1.0, v74
    v_add_f32 v75, 1.0, v75
    v_add_f32 v76, 1.0, v76
    v_add_f32 v77, 1.0, v77
    v_mfma_f32_32x32x16_bf16 v[36:51], a[60:63], v[56:59], v[36:51]
    ds_read_b128 v[56:59], v1 offset:768
    s_waitcnt lgkmcnt(3)
    v_add_f32 v78, 1.0, v78
    v_add_f32 v79, 1.0, v79
    v_rcp_f32 v72, v72
    v_mfma_f32_32x32x16_bf16 v[36:51], a[72:75], v[60:63], v[36:51]
    ds_read_b128 v[60:63], v2 offset:768
    v_rcp_f32 v73, v73
    v_rcp_f32 v74, v74
    v_mfma_f32_32x32x16_bf16 v[36:51], a[84:87], v[64:67], v[36:51]
    ds_read_b128 v[64:67], v16 offset:768
    s_waitcnt lgkmcnt(3)
    v_rcp_f32 v75, v75
    v_rcp_f32 v76, v76
    v_mfma_f32_32x32x16_bf16 v[36:51], a[96:99], v[68:71], v[36:51]
    ds_read_b128 v[68:71], v17 offset:768
    v_rcp_f32 v77, v77
    v_rcp_f32 v78, v78
    v_mfma_f32_32x32x16_bf16 v[36:51], a[108:111], v[52:55], v[36:51]
    ds_read_b128 v[52:55], v1 offset:896
    s_waitcnt lgkmcnt(3)
    v_rcp_f32 v79, v79
    v_mul_f32 v20, v20, v72
    v_mul_f32 v21, v21, v73
    v_mfma_f32_32x32x16_bf16 v[36:51], a[120:123], v[56:59], v[36:51]
    ds_read_b128 v[56:59], v2 offset:896
    v_mul_f32 v22, v22, v74
    v_mul_f32 v23, v23, v75
    v_mul_f32 v24, v24, v76
    v_mul_f32 v25, v25, v77
    v_mul_f32 v26, v26, v78
    v_mfma_f32_32x32x16_bf16 v[36:51], a[132:135], v[60:63], v[36:51]
    ds_read_b128 v[60:63], v16 offset:896
    s_waitcnt lgkmcnt(3)
    v_mul_f32 v27, v27, v79
    v_cvt_pk_bf16_f32 v20, v20, v21
    v_cvt_pk_bf16_f32 v21, v22, v23
    v_cvt_pk_bf16_f32 v22, v24, v25
    v_mfma_f32_32x32x16_bf16 v[36:51], a[144:147], v[64:67], v[36:51]
    ds_read_b128 v[64:67], v17 offset:896
    v_cvt_pk_bf16_f32 v23, v26, v27
    buffer_store_dwordx4 v[20:23], v5, s[4:7], s37 offen offset:512 sc1
    v_mfma_f32_32x32x16_bf16 v[36:51], a[156:159], v[68:71], v[36:51]
    ds_read_b128 v[68:71], v1 offset:1024
    s_waitcnt lgkmcnt(3)
    v_mfma_f32_32x32x16_bf16 v[36:51], a[168:171], v[52:55], v[36:51]
    ds_read_b128 v[52:55], v2 offset:1024
    v_mfma_f32_32x32x16_bf16 v[36:51], a[180:183], v[56:59], v[36:51]
    ds_read_b128 v[56:59], v16 offset:1024
    s_waitcnt lgkmcnt(3)
    v_mfma_f32_32x32x16_bf16 v[36:51], a[192:195], v[60:63], v[36:51]
    ds_read_b128 v[60:63], v17 offset:1024
    v_mfma_f32_32x32x16_bf16 v[36:51], a[204:207], v[64:67], v[36:51]
    s_waitcnt lgkmcnt(2)
    s_add_u32 s39, s39, 4
    s_mov_b32 s40, 0
    v_add_u32 v1, s44, v1
    v_add_u32 v2, s44, v2
    v_add_u32 v16, s44, v16
    v_mfma_f32_32x32x16_bf16 v[36:51], a[216:219], v[68:71], v[36:51]
    v_add_u32 v17, s44, v17
    s_sub_u32 s44, 0, s44
    s_mov_b32 s43, s37
    s_add_u32 s37, s37, 294912
    v_mfma_f32_32x32x16_bf16 v[36:51], a[228:231], v[52:55], v[36:51]
    s_waitcnt lgkmcnt(1)
    v_mfma_f32_32x32x16_bf16 v[36:51], a[240:243], v[56:59], v[36:51]
    s_waitcnt lgkmcnt(0)
    v_mfma_f32_32x32x16_bf16 v[36:51], a[252:255], v[60:63], v[36:51]
    s_add_u32 s30, s30, 1
    s_cmp_lg_u32 s10, 0
    s_waitcnt vmcnt(1)
    s_cbranch_scc1 L_up_0
    s_nop 7
    v_pk_mul_f32 v[72:73], v[36:37], v[36:37]
    v_pk_mul_f32 v[74:75], v[38:39], v[38:39]
    v_pk_mul_f32 v[76:77], v[40:41], v[40:41]
    v_pk_mul_f32 v[78:79], v[42:43], v[42:43]
    v_pk_fma_f32 v[72:73], v[72:73], v[18:19], v[18:19] op_sel:[0,0,1] op_sel_hi:[1,0,1]
    v_pk_fma_f32 v[74:75], v[74:75], v[18:19], v[18:19] op_sel:[0,0,1] op_sel_hi:[1,0,1]
    v_pk_fma_f32 v[76:77], v[76:77], v[18:19], v[18:19] op_sel:[0,0,1] op_sel_hi:[1,0,1]
    v_pk_fma_f32 v[78:79], v[78:79], v[18:19], v[18:19] op_sel:[0,0,1] op_sel_hi:[1,0,1]
    v_pk_mul_f32 v[72:73], v[72:73], v[36:37]
    v_pk_mul_f32 v[74:75], v[74:75], v[38:39]
    v_pk_mul_f32 v[76:77], v[76:77], v[40:41]
    v_pk_mul_f32 v[78:79], v[78:79], v[42:43]
    v_exp_f32 v72, v72
    v_exp_f32 v73, v73
    v_exp_f32 v74, v74
    v_exp_f32 v75, v75
    v_exp_f32 v76, v76
    v_exp_f32 v77, v77
    v_exp_f32 v78, v78
    v_exp_f32 v79, v79
    v_pk_mul_f32 v[36:37], v[36:37], v[44:45]
    v_pk_mul_f32 v[38:39], v[38:39], v[46:47]
    v_pk_mul_f32 v[40:41], v[40:41], v[48:49]
    v_pk_mul_f32 v[42:43], v[42:43], v[50:51]
    v_pk_add_f32 v[72:73], v[72:73], 1.0 op_sel_hi:[1,0]
    v_pk_add_f32 v[74:75], v[74:75], 1.0 op_sel_hi:[1,0]
    v_pk_add_f32 v[76:77], v[76:77], 1.0 op_sel_hi:[1,0]
    v_pk_add_f32 v[78:79], v[78:79], 1.0 op_sel_hi:[1,0]
    v_rcp_f32 v72, v72
    v_rcp_f32 v73, v73
    v_rcp_f32 v74, v74
    v_rcp_f32 v75, v75
    v_rcp_f32 v76, v76
    v_rcp_f32 v77, v77
    v_rcp_f32 v78, v78
    v_rcp_f32 v79, v79
    v_pk_mul_f32 v[36:37], v[36:37], v[72:73]
    v_pk_mul_f32 v[38:39], v[38:39], v[74:75]
    v_pk_mul_f32 v[40:41], v[40:41], v[76:77]
    v_pk_mul_f32 v[42:43], v[42:43], v[78:79]
    v_cvt_pk_bf16_f32 v36, v36, v37
    v_cvt_pk_bf16_f32 v37, v38, v39
    v_cvt_pk_bf16_f32 v38, v40, v41
    v_cvt_pk_bf16_f32 v39, v42, v43
    buffer_store_dwordx4 v[36:39], v5, s[4:7], s43 offen offset:1024 sc1
    s_mov_b32 s23, 32768
    s_mov_b32 s29, 8
L_spin_46:
    s_sub_u32 s23, s23, 1
    s_cbranch_scc1 L_abort
    s_sleep 2
    buffer_load_dword v4, v3, s[4:7], s33 offen sc1
    s_waitcnt vmcnt(0)
    s_or_b32 s28, s39, s40
    s_mov_b64 exec, 1
    buffer_store_dword v2, off, s[4:7], s28 sc1
    s_mov_b64 exec, -1
    s_mov_b32 s40, 1073741824
    s_cmp_eq_u32 s30, 64
    s_cbranch_scc1 L_up_done
    v_cmp_eq_u32 vcc, 0, v4
    s_cbranch_vccnz L_spin_46
    s_add_u32 m0, s34, 0
    s_nop 0
    buffer_load_dwordx4 v6, s[4:7], s32 offen offset:0 sc1 lds
    buffer_load_dwordx4 v7, s[4:7], s32 offen offset:1024 sc1 lds
    buffer_load_dwordx4 v8, s[4:7], s32 offen offset:2048 sc1 lds
    buffer_load_dwordx4 v9, s[4:7], s32 offen offset:3072 sc1 lds
    s_add_u32 m0, s34, 4096
    s_nop 0
    buffer_load_dwordx4 v10, s[4:7], s32 offen offset:0 sc1 lds
    buffer_load_dwordx4 v11, s[4:7], s32 offen offset:1024 sc1 lds
    buffer_load_dwordx4 v12, s[4:7], s32 offen offset:2048 sc1 lds
    buffer_load_dwordx4 v13, s[4:7], s32 offen offset:3072 sc1 lds
    s_add_u32 m0, s34, 8192
    s_nop 0
    buffer_load_dwordx4 v14, s[4:7], s32 offen offset:0 sc1 lds
    s_waitcnt vmcnt(0)
    s_branch L_up_0
L_up_done:
    s_endpgm
L_down:
    s_lshl_b32 s40, s20, 10
    s_add_u32 s28, s24, 2
    s_mul_i32 s39, s28, 1179648
    s_add_u32 s39, s39, 243269632
    s_mul_i32 s33, s21, 36864
    s_add_u32 s33, s33, s39
    v_lshlrev_b32 v10, 4, v0
    v_mov_b32 v16, 1
    v_mov_b32 v17, 1
    v_mov_b32 v18, 1
    v_mov_b32 v19, 1
    s_mul_i32 s60, s20, 9216
    s_add_u32 s60, s60, s33
    s_add_u32 s28, s60, 0
    buffer_store_dwordx4 v[16:19], v10, s[4:7], s28 offen
    s_add_u32 s28, s60, 1024
    buffer_store_dwordx4 v[16:19], v10, s[4:7], s28 offen
    s_add_u32 s28, s60, 2048
    buffer_store_dwordx4 v[16:19], v10, s[4:7], s28 offen
    s_add_u32 s28, s60, 3072
    buffer_store_dwordx4 v[16:19], v10, s[4:7], s28 offen
    s_add_u32 s28, s60, 4096
    buffer_store_dwordx4 v[16:19], v10, s[4:7], s28 offen
    s_add_u32 s28, s60, 5120
    buffer_store_dwordx4 v[16:19], v10, s[4:7], s28 offen
    s_add_u32 s28, s60, 6144
    buffer_store_dwordx4 v[16:19], v10, s[4:7], s28 offen
    s_add_u32 s28, s60, 7168
    buffer_store_dwordx4 v[16:19], v10, s[4:7], s28 offen
    s_add_u32 s28, s60, 8192
    buffer_store_dwordx4 v[16:19], v10, s[4:7], s28 offen
    s_add_u32 s28, s60, 589824
    buffer_store_dwordx4 v[16:19], v10, s[4:7], s28 offen
    s_add_u32 s28, s60, 590848
    buffer_store_dwordx4 v[16:19], v10, s[4:7], s28 offen
    s_add_u32 s28, s60, 591872
    buffer_store_dwordx4 v[16:19], v10, s[4:7], s28 offen
    s_add_u32 s28, s60, 592896
    buffer_store_dwordx4 v[16:19], v10, s[4:7], s28 offen
    s_add_u32 s28, s60, 593920
    buffer_store_dwordx4 v[16:19], v10, s[4:7], s28 offen
    s_add_u32 s28, s60, 594944
    buffer_store_dwordx4 v[16:19], v10, s[4:7], s28 offen
    s_add_u32 s28, s60, 595968
    buffer_store_dwordx4 v[16:19], v10, s[4:7], s28 offen
    s_add_u32 s28, s60, 596992
    buffer_store_dwordx4 v[16:19], v10, s[4:7], s28 offen
    s_add_u32 s28, s60, 598016
    buffer_store_dwordx4 v[16:19], v10, s[4:7], s28 offen
    s_waitcnt vmcnt(0)
    s_barrier
    s_cmp_lg_u32 s20, 0
    s_cbranch_scc1 L_arr_47
    s_mov_b64 exec, 1
    v_mov_b32 v2, 1
    buffer_atomic_add v2, off, s[16:19], 0 offset:16 sc1
    s_mov_b64 exec, -1
L_arr_47:
    s_mov_b32 s23, 32768
    s_mov_b32 s29, 1
L_spin_49:
    s_sub_u32 s23, s23, 1
    s_cbranch_scc1 L_abort
    s_sleep 2
    s_sleep 4
    buffer_load_dword v2, off, s[16:19], 0 offset:16 sc1
    s_waitcnt vmcnt(0)
    v_cmp_gt_u32 vcc, 256, v2
    s_nop 3
    s_cbranch_vccnz L_spin_49
    s_lshl_b32 s60, s24, 9
    s_add_u32 s60, s60, 114688
    s_mov_b32 s23, 32768
    s_mov_b32 s29, 30
L_spin_50:
    s_sub_u32 s23, s23, 1
    s_cbranch_scc1 L_abort
    s_sleep 2
    s_sleep 16
    buffer_load_dword v2, off, s[4:7], s60 sc1
    s_waitcnt vmcnt(0)
    v_cmp_eq_u32 vcc, 0, v2
    s_nop 3
    s_cbranch_vccnz L_spin_50
L_hold_48:
    s_mul_i32 s61, s21, 331776
    s_lshl_b32 s28, s20, 3
    v_add_u32 v42, 0, v0
    v_mul_u32_u24 v40, 911, v42
    v_lshrrev_b32 v40, 16, v40
    v_mul_u32_u24 v41, 72, v40
    v_sub_u32 v42, v42, v41
    v_add_u32 v40, s28, v40
    v_lshrrev_b32 v24, 1, v40
    v_and_b32 v24, 1, v24
    v_lshlrev_b32 v24, 1, v24
    v_lshrrev_b32 v41, 3, v40
    v_and_b32 v41, 1, v41
    v_lshl_or_b32 v24, v41, 2, v24
    v_xor_b32 v24, v24, v42
    v_lshlrev_b32 v24, 4, v24
    v_mul_u32_u24 v40, 1152, v40
    v_add_u32 v24, v24, v40
    v_add_u32 v42, 64, v0
    v_mul_u32_u24 v40, 911, v42
    v_lshrrev_b32 v40, 16, v40
    v_mul_u32_u24 v41, 72, v40
    v_sub_u32 v42, v42, v41
    v_add_u32 v40, s28, v40
    v_lshrrev_b32 v25, 1, v40
    v_and_b32 v25, 1, v25
    v_lshlrev_b32 v25, 1, v25
    v_lshrrev_b32 v41, 3, v40
    v_and_b32 v41, 1, v41
    v_lshl_or_b32 v25, v41, 2, v25
    v_xor_b32 v25, v25, v42
    v_lshlrev_b32 v25, 4, v25
    v_mul_u32_u24 v40, 1152, v40
    v_add_u32 v25, v25, v40
    v_add_u32 v42, 128, v0
    v_mul_u32_u24 v40, 911, v42
    v_lshrrev_b32 v40, 16, v40
    v_mul_u32_u24 v41, 72, v40
    v_sub_u32 v42, v42, v41
    v_add_u32 v40, s28, v40
    v_lshrrev_b32 v26, 1, v40
    v_and_b32 v26, 1, v26
    v_lshlrev_b32 v26, 1, v26
    v_lshrrev_b32 v41, 3, v40
    v_and_b32 v41, 1, v41
    v_lshl_or_b32 v26, v41, 2, v26
    v_xor_b32 v26, v26, v42
    v_lshlrev_b32 v26, 4, v26
    v_mul_u32_u24 v40, 1152, v40
    v_add_u32 v26, v26, v40
    v_add_u32 v42, 192, v0
    v_mul_u32_u24 v40, 911, v42
    v_lshrrev_b32 v40, 16, v40
    v_mul_u32_u24 v41, 72, v40
    v_sub_u32 v42, v42, v41
    v_add_u32 v40, s28, v40
    v_lshrrev_b32 v27, 1, v40
    v_and_b32 v27, 1, v27
    v_lshlrev_b32 v27, 1, v27
    v_lshrrev_b32 v41, 3, v40
    v_and_b32 v41, 1, v41
    v_lshl_or_b32 v27, v41, 2, v27
    v_xor_b32 v27, v27, v42
    v_lshlrev_b32 v27, 4, v27
    v_mul_u32_u24 v40, 1152, v40
    v_add_u32 v27, v27, v40
    v_add_u32 v42, 256, v0
    v_mul_u32_u24 v40, 911, v42
    v_lshrrev_b32 v40, 16, v40
    v_mul_u32_u24 v41, 72, v40
    v_sub_u32 v42, v42, v41
    v_add_u32 v40, s28, v40
    v_lshrrev_b32 v28, 1, v40
    v_and_b32 v28, 1, v28
    v_lshlrev_b32 v28, 1, v28
    v_lshrrev_b32 v41, 3, v40
    v_and_b32 v41, 1, v41
    v_lshl_or_b32 v28, v41, 2, v28
    v_xor_b32 v28, v28, v42
    v_lshlrev_b32 v28, 4, v28
    v_mul_u32_u24 v40, 1152, v40
    v_add_u32 v28, v28, v40
    v_add_u32 v42, 320, v0
    v_mul_u32_u24 v40, 911, v42
    v_lshrrev_b32 v40, 16, v40
    v_mul_u32_u24 v41, 72, v40
    v_sub_u32 v42, v42, v41
    v_add_u32 v40, s28, v40
    v_lshrrev_b32 v29, 1, v40
    v_and_b32 v29, 1, v29
    v_lshlrev_b32 v29, 1, v29
    v_lshrrev_b32 v41, 3, v40
    v_and_b32 v41, 1, v41
    v_lshl_or_b32 v29, v41, 2, v29
    v_xor_b32 v29, v29, v42
    v_lshlrev_b32 v29, 4, v29
    v_mul_u32_u24 v40, 1152, v40
    v_add_u32 v29, v29, v40
    v_add_u32 v42, 384, v0
    v_mul_u32_u24 v40, 911, v42
    v_lshrrev_b32 v40, 16, v40
    v_mul_u32_u24 v41, 72, v40
    v_sub_u32 v42, v42, v41
    v_add_u32 v40, s28, v40
    v_lshrrev_b32 v30, 1, v40
    v_and_b32 v30, 1, v30
    v_lshlrev_b32 v30, 1, v30
    v_lshrrev_b32 v41, 3, v40
    v_and_b32 v41, 1, v41
    v_lshl_or_b32 v30, v41, 2, v30
    v_xor_b32 v30, v30, v42
    v_lshlrev_b32 v30, 4, v30
    v_mul_u32_u24 v40, 1152, v40
    v_add_u32 v30, v30, v40
    v_add_u32 v42, 448, v0
    v_mul_u32_u24 v40, 911, v42
    v_lshrrev_b32 v40, 16, v40
    v_mul_u32_u24 v41, 72, v40
    v_sub_u32 v42, v42, v41
    v_add_u32 v40, s28, v40
    v_lshrrev_b32 v31, 1, v40
    v_and_b32 v31, 1, v31
    v_lshlrev_b32 v31, 1, v31
    v_lshrrev_b32 v41, 3, v40
    v_and_b32 v41, 1, v41
    v_lshl_or_b32 v31, v41, 2, v31
    v_xor_b32 v31, v31, v42
    v_lshlrev_b32 v31, 4, v31
    v_mul_u32_u24 v40, 1152, v40
    v_add_u32 v31, v31, v40
    v_add_u32 v42, 512, v0
    v_mul_u32_u24 v40, 911, v42
    v_lshrrev_b32 v40, 16, v40
    v_mul_u32_u24 v41, 72, v40
    v_sub_u32 v42, v42, v41
    v_add_u32 v40, s28, v40
    v_lshrrev_b32 v32, 1, v40
    v_and_b32 v32, 1, v32
    v_lshlrev_b32 v32, 1, v32
    v_lshrrev_b32 v41, 3, v40
    v_and_b32 v41, 1, v41
    v_lshl_or_b32 v32, v41, 2, v32
    v_xor_b32 v32, v32, v42
    v_lshlrev_b32 v32, 4, v32
    v_mul_u32_u24 v40, 1152, v40
    v_add_u32 v32, v32, v40
    s_mul_i32 s62, s20, 18
    v_lshrrev_b32 v40, 2, v0
    v_and_b32 v40, 3, v40
    v_lshrrev_b32 v41, 4, v0
    v_and_b32 v41, 3, v41
    v_lshl_or_b32 v40, v41, 3, v40
    v_lshrrev_b32 v33, 1, v40
    v_and_b32 v33, 1, v33
    v_lshlrev_b32 v33, 1, v33
    v_lshrrev_b32 v41, 3, v40
    v_and_b32 v41, 1, v41
    v_lshl_or_b32 v33, v41, 2, v33
    v_bfe_u32 v41, v0, 1, 1
    v_add_u32 v41, s62, v41
    v_xor_b32 v33, v33, v41
    v_lshlrev_b32 v33, 4, v33
    v_mul_u32_u24 v40, 1152, v40
    v_add_u32 v33, v33, v40
    v_and_b32 v41, 1, v0
    v_lshlrev_b32 v41, 3, v41
    v_add_u32 v33, v33, v41
    v_lshrrev_b32 v40, 2, v0
    v_and_b32 v40, 3, v40
    v_lshrrev_b32 v41, 4, v0
    v_and_b32 v41, 3, v41
    v_lshl_or_b32 v40, v41, 3, v40
    v_lshrrev_b32 v34, 1, v40
    v_and_b32 v34, 1, v34
    v_lshlrev_b32 v34, 1, v34
    v_lshrrev_b32 v41, 3, v40
    v_and_b32 v41, 1, v41
    v_lshl_or_b32 v34, v41, 2, v34
    v_bfe_u32 v41, v0, 1, 1
    v_add_u32 v41, s62, v41
    v_add_u32 v41, 2, v41
    v_xor_b32 v34, v34, v41
    v_lshlrev_b32 v34, 4, v34
    v_mul_u32_u24 v40, 1152, v40
    v_add_u32 v34, v34, v40
    v_and_b32 v41, 1, v0
    v_lshlrev_b32 v41, 3, v41
    v_add_u32 v34, v34, v41
    v_lshrrev_b32 v40, 2, v0
    v_and_b32 v40, 3, v40
    v_lshrrev_b32 v41, 4, v0
    v_and_b32 v41, 3, v41
    v_lshl_or_b32 v40, v41, 3, v40
    v_lshrrev_b32 v35, 1, v40
    v_and_b32 v35, 1, v35
    v_lshlrev_b32 v35, 1, v35
    v_lshrrev_b32 v41, 3, v40
    v_and_b32 v41, 1, v41
    v_lshl_or_b32 v35, v41, 2, v35
    v_bfe_u32 v41, v0, 1, 1
    v_add_u32 v41, s62, v41
    v_add_u32 v41, 4, v41
    v_xor_b32 v35, v35, v41
    v_lshlrev_b32 v35, 4, v35
    v_mul_u32_u24 v40, 1152, v40
    v_add_u32 v35, v35, v40
    v_and_b32 v41, 1, v0
    v_lshlrev_b32 v41, 3, v41
    v_add_u32 v35, v35, v41
    v_lshrrev_b32 v40, 2, v0
    v_and_b32 v40, 3, v40
    v_lshrrev_b32 v41, 4, v0
    v_and_b32 v41, 3, v41
    v_lshl_or_b32 v40, v41, 3, v40
    v_lshrrev_b32 v36, 1, v40
    v_and_b32 v36, 1, v36
    v_lshlrev_b32 v36, 1, v36
    v_lshrrev_b32 v41, 3, v40
    v_and_b32 v41, 1, v41
    v_lshl_or_b32 v36, v41, 2, v36
    v_bfe_u32 v41, v0, 1, 1
    v_add_u32 v41, s62, v41
    v_add_u32 v41, 6, v41
    v_xor_b32 v36, v36, v41
    v_lshlrev_b32 v36, 4, v36
    v_mul_u32_u24 v40, 1152, v40
    v_add_u32 v36, v36, v40
    v_and_b32 v41, 1, v0
    v_lshlrev_b32 v41, 3, v41
    v_add_u32 v36, v36, v41
    s_mul_i32 s60, s20, 9216
    s_load_dwordx2 s[8:9], s[0:1], 80
    s_mov_b32 s10, 5308416
    s_mov_b32 s11, 0x20000
    s_waitcnt lgkmcnt(0)
    s_add_u32 m0, s60, 0
    s_add_u32 s28, s61, 0
    buffer_load_dwordx4 v24, s[8:11], s28 offen lds
    s_add_u32 m0, s60, 1024
    s_add_u32 s28, s61, 0
    buffer_load_dwordx4 v25, s[8:11], s28 offen lds
    s_add_u32 m0, s60, 2048
    s_add_u32 s28, s61, 0
    buffer_load_dwordx4 v26, s[8:11], s28 offen lds
    s_add_u32 m0, s60, 3072
    s_add_u32 s28, s61, 0
    buffer_load_dwordx4 v27, s[8:11], s28 offen lds
    s_add_u32 m0, s60, 4096
    s_add_u32 s28, s61, 0
    buffer_load_dwordx4 v28, s[8:11], s28 offen lds
    s_add_u32 m0, s60, 5120
    s_add_u32 s28, s61, 0
    buffer_load_dwordx4 v29, s[8:11], s28 offen lds
    s_add_u32 m0, s60, 6144
    s_add_u32 s28, s61, 0
    buffer_load_dwordx4 v30, s[8:11], s28 offen lds
    s_add_u32 m0, s60, 7168
    s_add_u32 s28, s61, 0
    buffer_load_dwordx4 v31, s[8:11], s28 offen lds
    s_add_u32 m0, s60, 8192
    s_add_u32 s28, s61, 0
    buffer_load_dwordx4 v32, s[8:11], s28 offen lds
    s_add_u32 m0, s60, 36864
    s_add_u32 s28, s61, 36864
    buffer_load_dwordx4 v24, s[8:11], s28 offen lds
    s_add_u32 m0, s60, 37888
    s_add_u32 s28, s61, 36864
    buffer_load_dwordx4 v25, s[8:11], s28 offen lds
    s_add_u32 m0, s60, 38912
    s_add_u32 s28, s61, 36864
    buffer_load_dwordx4 v26, s[8:11], s28 offen lds
    s_add_u32 m0, s60, 39936
    s_add_u32 s28, s61, 36864
    buffer_load_dwordx4 v27, s[8:11], s28 offen lds
    s_add_u32 m0, s60, 40960
    s_add_u32 s28, s61, 36864
    buffer_load_dwordx4 v28, s[8:11], s28 offen lds
    s_add_u32 m0, s60, 41984
    s_add_u32 s28, s61, 36864
    buffer_load_dwordx4 v29, s[8:11], s28 offen lds
    s_add_u32 m0, s60, 43008
    s_add_u32 s28, s61, 36864
    buffer_load_dwordx4 v30, s[8:11], s28 offen lds
    s_add_u32 m0, s60, 44032
    s_add_u32 s28, s61, 36864
    buffer_load_dwordx4 v31, s[8:11], s28 offen lds
    s_add_u32 m0, s60, 45056
    s_add_u32 s28, s61, 36864
    buffer_load_dwordx4 v32, s[8:11], s28 offen lds
    s_add_u32 m0, s60, 73728
    s_add_u32 s28, s61, 73728
    buffer_load_dwordx4 v24, s[8:11], s28 offen lds
    s_add_u32 m0, s60, 74752
    s_add_u32 s28, s61, 73728
    buffer_load_dwordx4 v25, s[8:11], s28 offen lds
    s_add_u32 m0, s60, 75776
    s_add_u32 s28, s61, 73728
    buffer_load_dwordx4 v26, s[8:11], s28 offen lds
    s_add_u32 m0, s60, 76800
    s_add_u32 s28, s61, 73728
    buffer_load_dwordx4 v27, s[8:11], s28 offen lds
    s_add_u32 m0, s60, 77824
    s_add_u32 s28, s61, 73728
    buffer_load_dwordx4 v28, s[8:11], s28 offen lds
    s_add_u32 m0, s60, 78848
    s_add_u32 s28, s61, 73728
    buffer_load_dwordx4 v29, s[8:11], s28 offen lds
    s_add_u32 m0, s60, 79872
    s_add_u32 s28, s61, 73728
    buffer_load_dwordx4 v30, s[8:11], s28 offen lds
    s_add_u32 m0, s60, 80896
    s_add_u32 s28, s61, 73728
    buffer_load_dwordx4 v31, s[8:11], s28 offen lds
    s_add_u32 m0, s60, 81920
    s_add_u32 s28, s61, 73728
    buffer_load_dwordx4 v32, s[8:11], s28 offen lds
    s_add_u32 m0, s60, 110592
    s_add_u32 s28, s61, 110592
    buffer_load_dwordx4 v24, s[8:11], s28 offen lds
    s_add_u32 m0, s60, 111616
    s_add_u32 s28, s61, 110592
    buffer_load_dwordx4 v25, s[8:11], s28 offen lds
    s_add_u32 m0, s60, 112640
    s_add_u32 s28, s61, 110592
    buffer_load_dwordx4 v26, s[8:11], s28 offen lds
    s_add_u32 m0, s60, 113664
    s_add_u32 s28, s61, 110592
    buffer_load_dwordx4 v27, s[8:11], s28 offen lds
    s_add_u32 m0, s60, 114688
    s_add_u32 s28, s61, 110592
    buffer_load_dwordx4 v28, s[8:11], s28 offen lds
    s_add_u32 m0, s60, 115712
    s_add_u32 s28, s61, 110592
    buffer_load_dwordx4 v29, s[8:11], s28 offen lds
    s_add_u32 m0, s60, 116736
    s_add_u32 s28, s61, 110592
    buffer_load_dwordx4 v30, s[8:11], s28 offen lds
    s_add_u32 m0, s60, 117760
    s_add_u32 s28, s61, 110592
    buffer_load_dwordx4 v31, s[8:11], s28 offen lds
    s_add_u32 m0, s60, 118784
    s_add_u32 s28, s61, 110592
    buffer_load_dwordx4 v32, s[8:11], s28 offen lds
    s_waitcnt vmcnt(18)
    s_barrier
    ds_read_b64_tr_b16 v[188:189], v33 offset:0
    ds_read_b64_tr_b16 v[190:191], v33 offset:4608
    ds_read_b64_tr_b16 v[224:225], v34 offset:0
    ds_read_b64_tr_b16 v[226:227], v34 offset:4608
    ds_read_b64_tr_b16 a[4:5], v35 offset:0
    ds_read_b64_tr_b16 a[6:7], v35 offset:4608
    ds_read_b64_tr_b16 a[40:41], v36 offset:0
    ds_read_b64_tr_b16 a[42:43], v36 offset:4608
    ds_read_b64_tr_b16 a[76:77], v33 offset:128
    ds_read_b64_tr_b16 a[78:79], v33 offset:4736
    ds_read_b64_tr_b16 a[112:113], v34 offset:128
    ds_read_b64_tr_b16 a[114:115], v34 offset:4736
    ds_read_b64_tr_b16 a[148:149], v35 offset:128
    ds_read_b64_tr_b16 a[150:151], v35 offset:4736
    ds_read_b64_tr_b16 a[184:185], v36 offset:128
    ds_read_b64_tr_b16 a[186:187], v36 offset:4736
    ds_read_b64_tr_b16 a[220:221], v33 offset:256
    ds_read_b64_tr_b16 a[222:223], v33 offset:4864
    ds_read_b64_tr_b16 v[192:193], v33 offset:36864
    ds_read_b64_tr_b16 v[194:195], v33 offset:41472
    ds_read_b64_tr_b16 v[228:229], v34 offset:36864
    ds_read_b64_tr_b16 v[230:231], v34 offset:41472
    ds_read_b64_tr_b16 a[8:9], v35 offset:36864
    ds_read_b64_tr_b16 a[10:11], v35 offset:41472
    ds_read_b64_tr_b16 a[44:45], v36 offset:36864
    ds_read_b64_tr_b16 a[46:47], v36 offset:41472
    ds_read_b64_tr_b16 a[80:81], v33 offset:36992
    ds_read_b64_tr_b16 a[82:83], v33 offset:41600
    ds_read_b64_tr_b16 a[116:117], v34 offset:36992
    ds_read_b64_tr_b16 a[118:119], v34 offset:41600
    ds_read_b64_tr_b16 a[152:153], v35 offset:36992
    ds_read_b64_tr_b16 a[154:155], v35 offset:41600
    ds_read_b64_tr_b16 a[188:189], v36 offset:36992
    ds_read_b64_tr_b16 a[190:191], v36 offset:41600
    ds_read_b64_tr_b16 a[224:225], v33 offset:37120
    ds_read_b64_tr_b16 a[226:227], v33 offset:41728
    s_waitcnt lgkmcnt(0)
    s_barrier
    s_add_u32 m0, s60, 0
    s_add_u32 s28, s61, 147456
    buffer_load_dwordx4 v24, s[8:11], s28 offen lds
    s_add_u32 m0, s60, 1024
    s_add_u32 s28, s61, 147456
    buffer_load_dwordx4 v25, s[8:11], s28 offen lds
    s_add_u32 m0, s60, 2048
    s_add_u32 s28, s61, 147456
    buffer_load_dwordx4 v26, s[8:11], s28 offen lds
    s_add_u32 m0, s60, 3072
    s_add_u32 s28, s61, 147456
    buffer_load_dwordx4 v27, s[8:11], s28 offen lds
    s_add_u32 m0, s60, 4096
    s_add_u32 s28, s61, 147456
    buffer_load_dwordx4 v28, s[8:11], s28 offen lds
    s_add_u32 m0, s60, 5120
    s_add_u32 s28, s61, 147456
    buffer_load_dwordx4 v29, s[8:11], s28 offen lds
    s_add_u32 m0, s60, 6144
    s_add_u32 s28, s61, 147456
    buffer_load_dwordx4 v30, s[8:11], s28 offen lds
    s_add_u32 m0, s60, 7168
    s_add_u32 s28, s61, 147456
    buffer_load_dwordx4 v31, s[8:11], s28 offen lds
    s_add_u32 m0, s60, 8192
    s_add_u32 s28, s61, 147456
    buffer_load_dwordx4 v32, s[8:11], s28 offen lds
    s_add_u32 m0, s60, 36864
    s_add_u32 s28, s61, 184320
    buffer_load_dwordx4 v24, s[8:11], s28 offen lds
    s_add_u32 m0, s60, 37888
    s_add_u32 s28, s61, 184320
    buffer_load_dwordx4 v25, s[8:11], s28 offen lds
    s_add_u32 m0, s60, 38912
    s_add_u32 s28, s61, 184320
    buffer_load_dwordx4 v26, s[8:11], s28 offen lds
    s_add_u32 m0, s60, 39936
    s_add_u32 s28, s61, 184320
    buffer_load_dwordx4 v27, s[8:11], s28 offen lds
    s_add_u32 m0, s60, 40960
    s_add_u32 s28, s61, 184320
    buffer_load_dwordx4 v28, s[8:11], s28 offen lds
    s_add_u32 m0, s60, 41984
    s_add_u32 s28, s61, 184320
    buffer_load_dwordx4 v29, s[8:11], s28 offen lds
    s_add_u32 m0, s60, 43008
    s_add_u32 s28, s61, 184320
    buffer_load_dwordx4 v30, s[8:11], s28 offen lds
    s_add_u32 m0, s60, 44032
    s_add_u32 s28, s61, 184320
    buffer_load_dwordx4 v31, s[8:11], s28 offen lds
    s_add_u32 m0, s60, 45056
    s_add_u32 s28, s61, 184320
    buffer_load_dwordx4 v32, s[8:11], s28 offen lds
    s_waitcnt vmcnt(18)
    s_barrier
    v_add_u32 v37, 65536, v33
    ds_read_b64_tr_b16 v[196:197], v37 offset:8192
    ds_read_b64_tr_b16 v[198:199], v37 offset:12800
    v_add_u32 v37, 65536, v34
    ds_read_b64_tr_b16 v[232:233], v37 offset:8192
    ds_read_b64_tr_b16 v[234:235], v37 offset:12800
    v_add_u32 v37, 65536, v35
    ds_read_b64_tr_b16 a[12:13], v37 offset:8192
    ds_read_b64_tr_b16 a[14:15], v37 offset:12800
    v_add_u32 v37, 65536, v36
    ds_read_b64_tr_b16 a[48:49], v37 offset:8192
    ds_read_b64_tr_b16 a[50:51], v37 offset:12800
    v_add_u32 v37, 65536, v33
    ds_read_b64_tr_b16 a[84:85], v37 offset:8320
    ds_read_b64_tr_b16 a[86:87], v37 offset:12928
    v_add_u32 v37, 65536, v34
    ds_read_b64_tr_b16 a[120:121], v37 offset:8320
    ds_read_b64_tr_b16 a[122:123], v37 offset:12928
    v_add_u32 v37, 65536, v35
    ds_read_b64_tr_b16 a[156:157], v37 offset:8320
    ds_read_b64_tr_b16 a[158:159], v37 offset:12928
    v_add_u32 v37, 65536, v36
    ds_read_b64_tr_b16 a[192:193], v37 offset:8320
    ds_read_b64_tr_b16 a[194:195], v37 offset:12928
    v_add_u32 v37, 65536, v33
    ds_read_b64_tr_b16 a[228:229], v37 offset:8448
    ds_read_b64_tr_b16 a[230:231], v37 offset:13056
    ds_read_b64_tr_b16 v[200:201], v37 offset:45056
    ds_read_b64_tr_b16 v[202:203], v37 offset:49664
    v_add_u32 v37, 98304, v34
    ds_read_b64_tr_b16 v[236:237], v37 offset:12288
    ds_read_b64_tr_b16 v[238:239], v37 offset:16896
    v_add_u32 v37, 98304, v35
    ds_read_b64_tr_b16 a[16:17], v37 offset:12288
    ds_read_b64_tr_b16 a[18:19], v37 offset:16896
    v_add_u32 v37, 98304, v36
    ds_read_b64_tr_b16 a[52:53], v37 offset:12288
    ds_read_b64_tr_b16 a[54:55], v37 offset:16896
    v_add_u32 v37, 98304, v33
    ds_read_b64_tr_b16 a[88:89], v37 offset:12416
    ds_read_b64_tr_b16 a[90:91], v37 offset:17024
    v_add_u32 v37, 98304, v34
    ds_read_b64_tr_b16 a[124:125], v37 offset:12416
    ds_read_b64_tr_b16 a[126:127], v37 offset:17024
    v_add_u32 v37, 98304, v35
    ds_read_b64_tr_b16 a[160:161], v37 offset:12416
    ds_read_b64_tr_b16 a[162:163], v37 offset:17024
    v_add_u32 v37, 98304, v36
    ds_read_b64_tr_b16 a[196:197], v37 offset:12416
    ds_read_b64_tr_b16 a[198:199], v37 offset:17024
    v_add_u32 v37, 98304, v33
    ds_read_b64_tr_b16 a[232:233], v37 offset:12544
    ds_read_b64_tr_b16 a[234:235], v37 offset:17152
    s_waitcnt lgkmcnt(0)
    s_barrier
    s_add_u32 m0, s60, 73728
    s_add_u32 s28, s61, 221184
    buffer_load_dwordx4 v24, s[8:11], s28 offen lds
    s_add_u32 m0, s60, 74752
    s_add_u32 s28, s61, 221184
    buffer_load_dwordx4 v25, s[8:11], s28 offen lds
    s_add_u32 m0, s60, 75776
    s_add_u32 s28, s61, 221184
    buffer_load_dwordx4 v26, s[8:11], s28 offen lds
    s_add_u32 m0, s60, 76800
    s_add_u32 s28, s61, 221184
    buffer_load_dwordx4 v27, s[8:11], s28 offen lds
    s_add_u32 m0, s60, 77824
    s_add_u32 s28, s61, 221184
    buffer_load_dwordx4 v28, s[8:11], s28 offen lds
    s_add_u32 m0, s60, 78848
    s_add_u32 s28, s61, 221184
    buffer_load_dwordx4 v29, s[8:11], s28 offen lds
    s_add_u32 m0, s60, 79872
    s_add_u32 s28, s61, 221184
    buffer_load_dwordx4 v30, s[8:11], s28 offen lds
    s_add_u32 m0, s60, 80896
    s_add_u32 s28, s61, 221184
    buffer_load_dwordx4 v31, s[8:11], s28 offen lds
    s_add_u32 m0, s60, 81920
    s_add_u32 s28, s61, 221184
    buffer_load_dwordx4 v32, s[8:11], s28 offen lds
    s_add_u32 m0, s60, 110592
    s_add_u32 s28, s61, 258048
    buffer_load_dwordx4 v24, s[8:11], s28 offen lds
    s_add_u32 m0, s60, 111616
    s_add_u32 s28, s61, 258048
    buffer_load_dwordx4 v25, s[8:11], s28 offen lds
    s_add_u32 m0, s60, 112640
    s_add_u32 s28, s61, 258048
    buffer_load_dwordx4 v26, s[8:11], s28 offen lds
    s_add_u32 m0, s60, 113664
    s_add_u32 s28, s61, 258048
    buffer_load_dwordx4 v27, s[8:11], s28 offen lds
    s_add_u32 m0, s60, 114688
    s_add_u32 s28, s61, 258048
    buffer_load_dwordx4 v28, s[8:11], s28 offen lds
    s_add_u32 m0, s60, 115712
    s_add_u32 s28, s61, 258048
    buffer_load_dwordx4 v29, s[8:11], s28 offen lds
    s_add_u32 m0, s60, 116736
    s_add_u32 s28, s61, 258048
    buffer_load_dwordx4 v30, s[8:11], s28 offen lds
    s_add_u32 m0, s60, 117760
    s_add_u32 s28, s61, 258048
    buffer_load_dwordx4 v31, s[8:11], s28 offen lds
    s_add_u32 m0, s60, 118784
    s_add_u32 s28, s61, 258048
    buffer_load_dwordx4 v32, s[8:11], s28 offen lds
    s_waitcnt vmcnt(18)
    s_barrier
    ds_read_b64_tr_b16 v[204:205], v33 offset:0
    ds_read_b64_tr_b16 v[206:207], v33 offset:4608
    ds_read_b64_tr_b16 v[240:241], v34 offset:0
    ds_read_b64_tr_b16 v[242:243], v34 offset:4608
    ds_read_b64_tr_b16 a[20:21], v35 offset:0
    ds_read_b64_tr_b16 a[22:23], v35 offset:4608
    ds_read_b64_tr_b16 a[56:57], v36 offset:0
    ds_read_b64_tr_b16 a[58:59], v36 offset:4608
    ds_read_b64_tr_b16 a[92:93], v33 offset:128
    ds_read_b64_tr_b16 a[94:95], v33 offset:4736
    ds_read_b64_tr_b16 a[128:129], v34 offset:128
    ds_read_b64_tr_b16 a[130:131], v34 offset:4736
    ds_read_b64_tr_b16 a[164:165], v35 offset:128
    ds_read_b64_tr_b16 a[166:167], v35 offset:4736
    ds_read_b64_tr_b16 a[200:201], v36 offset:128
    ds_read_b64_tr_b16 a[202:203], v36 offset:4736
    ds_read_b64_tr_b16 a[236:237], v33 offset:256
    ds_read_b64_tr_b16 a[238:239], v33 offset:4864
    ds_read_b64_tr_b16 v[208:209], v33 offset:36864
    ds_read_b64_tr_b16 v[210:211], v33 offset:41472
    ds_read_b64_tr_b16 v[244:245], v34 offset:36864
    ds_read_b64_tr_b16 v[246:247], v34 offset:41472
    ds_read_b64_tr_b16 a[24:25], v35 offset:36864
    ds_read_b64_tr_b16 a[26:27], v35 offset:41472
    ds_read_b64_tr_b16 a[60:61], v36 offset:36864
    ds_read_b64_tr_b16 a[62:63], v36 offset:41472
    ds_read_b64_tr_b16 a[96:97], v33 offset:36992
    ds_read_b64_tr_b16 a[98:99], v33 offset:41600
    ds_read_b64_tr_b16 a[132:133], v34 offset:36992
    ds_read_b64_tr_b16 a[134:135], v34 offset:41600
    ds_read_b64_tr_b16 a[168:169], v35 offset:36992
    ds_read_b64_tr_b16 a[170:171], v35 offset:41600
    ds_read_b64_tr_b16 a[204:205], v36 offset:36992
    ds_read_b64_tr_b16 a[206:207], v36 offset:41600
    ds_read_b64_tr_b16 a[240:241], v33 offset:37120
    ds_read_b64_tr_b16 a[242:243], v33 offset:41728
    s_waitcnt lgkmcnt(0)
    s_barrier
    s_add_u32 m0, s60, 0
    s_add_u32 s28, s61, 294912
    buffer_load_dwordx4 v24, s[8:11], s28 offen lds
    s_add_u32 m0, s60, 1024
    s_add_u32 s28, s61, 294912
    buffer_load_dwordx4 v25, s[8:11], s28 offen lds
    s_add_u32 m0, s60, 2048
    s_add_u32 s28, s61, 294912
    buffer_load_dwordx4 v26, s[8:11], s28 offen lds
    s_add_u32 m0, s60, 3072
    s_add_u32 s28, s61, 294912
    buffer_load_dwordx4 v27, s[8:11], s28 offen lds
    s_add_u32 m0, s60, 4096
    s_add_u32 s28, s61, 294912
    buffer_load_dwordx4 v28, s[8:11], s28 offen lds
    s_add_u32 m0, s60, 5120
    s_add_u32 s28, s61, 294912
    buffer_load_dwordx4 v29, s[8:11], s28 offen lds
    s_add_u32 m0, s60, 6144
    s_add_u32 s28, s61, 294912
    buffer_load_dwordx4 v30, s[8:11], s28 offen lds
    s_add_u32 m0, s60, 7168
    s_add_u32 s28, s61, 294912
    buffer_load_dwordx4 v31, s[8:11], s28 offen lds
    s_add_u32 m0, s60, 8192
    s_add_u32 s28, s61, 294912
    buffer_load_dwordx4 v32, s[8:11], s28 offen lds
    s_waitcnt vmcnt(9)
    s_barrier
    v_add_u32 v37, 65536, v33
    ds_read_b64_tr_b16 v[212:213], v37 offset:8192
    ds_read_b64_tr_b16 v[214:215], v37 offset:12800
    v_add_u32 v37, 65536, v34
    ds_read_b64_tr_b16 v[248:249], v37 offset:8192
    ds_read_b64_tr_b16 v[250:251], v37 offset:12800
    v_add_u32 v37, 65536, v35
    ds_read_b64_tr_b16 a[28:29], v37 offset:8192
    ds_read_b64_tr_b16 a[30:31], v37 offset:12800
    v_add_u32 v37, 65536, v36
    ds_read_b64_tr_b16 a[64:65], v37 offset:8192
    ds_read_b64_tr_b16 a[66:67], v37 offset:12800
    v_add_u32 v37, 65536, v33
    ds_read_b64_tr_b16 a[100:101], v37 offset:8320
    ds_read_b64_tr_b16 a[102:103], v37 offset:12928
    v_add_u32 v37, 65536, v34
    ds_read_b64_tr_b16 a[136:137], v37 offset:8320
    ds_read_b64_tr_b16 a[138:139], v37 offset:12928
    v_add_u32 v37, 65536, v35
    ds_read_b64_tr_b16 a[172:173], v37 offset:8320
    ds_read_b64_tr_b16 a[174:175], v37 offset:12928
    v_add_u32 v37, 65536, v36
    ds_read_b64_tr_b16 a[208:209], v37 offset:8320
    ds_read_b64_tr_b16 a[210:211], v37 offset:12928
    v_add_u32 v37, 65536, v33
    ds_read_b64_tr_b16 a[244:245], v37 offset:8448
    ds_read_b64_tr_b16 a[246:247], v37 offset:13056
    ds_read_b64_tr_b16 v[216:217], v37 offset:45056
    ds_read_b64_tr_b16 v[218:219], v37 offset:49664
    v_add_u32 v37, 98304, v34
    ds_read_b64_tr_b16 v[252:253], v37 offset:12288
    ds_read_b64_tr_b16 v[254:255], v37 offset:16896
    v_add_u32 v37, 98304, v35
    ds_read_b64_tr_b16 a[32:33], v37 offset:12288
    ds_read_b64_tr_b16 a[34:35], v37 offset:16896
    v_add_u32 v37, 98304, v36
    ds_read_b64_tr_b16 a[68:69], v37 offset:12288
    ds_read_b64_tr_b16 a[70:71], v37 offset:16896
    v_add_u32 v37, 98304, v33
    ds_read_b64_tr_b16 a[104:105], v37 offset:12416
    ds_read_b64_tr_b16 a[106:107], v37 offset:17024
    v_add_u32 v37, 98304, v34
    ds_read_b64_tr_b16 a[140:141], v37 offset:12416
    ds_read_b64_tr_b16 a[142:143], v37 offset:17024
    v_add_u32 v37, 98304, v35
    ds_read_b64_tr_b16 a[176:177], v37 offset:12416
    ds_read_b64_tr_b16 a[178:179], v37 offset:17024
    v_add_u32 v37, 98304, v36
    ds_read_b64_tr_b16 a[212:213], v37 offset:12416
    ds_read_b64_tr_b16 a[214:215], v37 offset:17024
    v_add_u32 v37, 98304, v33
    ds_read_b64_tr_b16 a[248:249], v37 offset:12544
    ds_read_b64_tr_b16 a[250:251], v37 offset:17152
    s_waitcnt lgkmcnt(0)
    s_barrier
    s_waitcnt vmcnt(0)
    s_barrier
    ds_read_b64_tr_b16 v[220:221], v33 offset:0
    ds_read_b64_tr_b16 v[222:223], v33 offset:4608
    ds_read_b64_tr_b16 a[0:1], v34 offset:0
    ds_read_b64_tr_b16 a[2:3], v34 offset:4608
    ds_read_b64_tr_b16 a[36:37], v35 offset:0
    ds_read_b64_tr_b16 a[38:39], v35 offset:4608
    ds_read_b64_tr_b16 a[72:73], v36 offset:0
    ds_read_b64_tr_b16 a[74:75], v36 offset:4608
    ds_read_b64_tr_b16 a[108:109], v33 offset:128
    ds_read_b64_tr_b16 a[110:111], v33 offset:4736
    ds_read_b64_tr_b16 a[144:145], v34 offset:128
    ds_read_b64_tr_b16 a[146:147], v34 offset:4736
    ds_read_b64_tr_b16 a[180:181], v35 offset:128
    ds_read_b64_tr_b16 a[182:183], v35 offset:4736
    ds_read_b64_tr_b16 a[216:217], v36 offset:128
    ds_read_b64_tr_b16 a[218:219], v36 offset:4736
    ds_read_b64_tr_b16 a[252:253], v33 offset:256
    ds_read_b64_tr_b16 a[254:255], v33 offset:4864
    s_waitcnt lgkmcnt(0)
    s_barrier
    v_min_u32 v9, 5, v0
    v_lshlrev_b32 v9, 9, v9
    v_and_b32 v40, 1, v0
    v_lshlrev_b32 v40, 4, v40
    v_mov_b32 v41, 0x3f80
    v_lshlrev_b32 v41, v40, v41
    v_bfe_u32 v40, v0, 1, 2
    v_cmp_eq_u32 vcc, 0, v40
    s_nop 1
    v_cndmask_b32 v16, 0, v41, vcc
    v_cmp_eq_u32 vcc, 1, v40
    s_nop 1
    v_cndmask_b32 v17, 0, v41, vcc
    v_cmp_eq_u32 vcc, 2, v40
    s_nop 1
    v_cndmask_b32 v18, 0, v41, vcc
    v_cmp_eq_u32 vcc, 3, v40
    s_nop 1
    v_cndmask_b32 v19, 0, v41, vcc
    v_lshrrev_b32 v40, 4, v0
    v_and_b32 v41, 15, v0
    v_mul_u32_u24 v42, 73728, v40
    v_lshl_add_u32 v1, v41, 4, v42
    v_lshl_add_u32 v2, v41, 2, v42
    s_mul_i32 s60, s20, 576
    s_add_u32 s61, s60, 16384
    v_lshrrev_b32 v5, 0, v0
    v_and_b32 v5, 15, v5
    v_lshlrev_b32 v5, 2, v5
    v_lshrrev_b32 v42, 4, v0
    v_and_b32 v42, 1, v42
    v_lshl_or_b32 v5, v42, 7, v5
    v_add_u32 v5, s61, v5
    v_lshrrev_b32 v6, 0, v0
    v_and_b32 v6, 3, v6
    v_lshlrev_b32 v6, 4, v6
    v_lshrrev_b32 v42, 4, v0
    v_and_b32 v42, 1, v42
    v_lshl_or_b32 v6, v42, 3, v6
    v_add_u32 v6, s61, v6
    v_mul_u32_u24 v42, 2304, v40
    v_lshl_add_u32 v3, v41, 4, v42
    v_lshrrev_b32 v41, 2, v0
    v_and_b32 v41, 3, v41
    v_lshlrev_b32 v41, 2, v41
    v_lshrrev_b32 v42, 4, v0
    v_and_b32 v42, 3, v42
    v_lshl_or_b32 v41, v42, 0, v41
    v_mul_u32_u24 v4, 2304, v41
    v_and_b32 v41, 3, v0
    v_lshl_add_u32 v4, v41, 4, v4
    s_lshr_b32 s61, s20, 1
    s_mul_i32 s62, s61, 2304
    s_add_u32 s62, s62, 16384
    v_lshlrev_b32 v7, 5, v0
    v_add_u32 v7, s62, v7
    v_lshlrev_b32 v8, 1, v0
    s_mul_i32 s32, s21, 2304
    s_mul_i32 s61, s61, 1152
    s_add_u32 s34, s32, s61
    s_add_u32 s32, s32, s60
    s_add_u32 s32, s32, s39
    s_add_u32 s33, s33, s60
    s_lshl_b32 s36, s21, 11
    s_lshl_b32 s28, s20, 9
    s_add_u32 s36, s36, s28
    s_add_u32 s28, s33, 589824
    s_xor_b32 s41, s28, s33
    s_add_u32 s28, s32, 589824
    s_xor_b32 s53, s28, s32
    s_bitcmp0_b32 s20, 0
    s_cselect_b32 s58, -1, 0
    s_cselect_b32 s59, 1.0, 0
    s_mov_b64 s[56:57], 1
    s_add_u32 s28, s62, 2048
    v_lshl_add_u32 v11, v8, 1, s28
    s_lshl_b32 s28, s20, 2
    s_add_u32 s28, s28, 22528
    v_mov_b32 v12, s28
    v_mov_b32 v13, 22528
    s_mov_b32 s44, 18432
    s_mov_b32 s30, 0
    s_mov_b32 s42, 0
    s_mov_b64 s[54:55], 0
    v_lshlrev_b32 v0, 4, v0
    v_add_u32 v15, 4096, v0
    s_load_dwordx2 s[8:9], s[0:1], 104
    s_mov_b32 s10, 0
    s_mov_b32 s11, 0x20000
    s_waitcnt lgkmcnt(0)
    s_add_u32 s64, s33, 9216
    s_add_u32 s65, s33, 18432
    s_add_u32 s66, s33, 27648
    v_add_u32 v14, 32768, v0
    s_mul_i32 s60, s24, 2359296
    s_lshl_b32 s61, s24, 8
    s_load_dwordx2 s[12:13], s[0:1], 88
    s_mov_b32 s14, 2359296
    s_mov_b32 s15, 0x20000
    s_waitcnt lgkmcnt(0)
    s_bitcmp1_b32 s20, 0
    s_cselect_b32 s35, 1073741824, s34
    s_mov_b64 s[56:57], 0
    s_cmp_eq_u32 s24, 1
    s_cbranch_scc1 L_down_o
    s_load_dwordx2 s[12:13], s[0:1], 104
    s_mov_b32 s14, 268435456
    s_mov_b32 s15, 0x20000
    s_waitcnt lgkmcnt(0)
    s_mov_b64 s[56:57], 1
    s_mov_b32 s35, s34
    s_bitcmp1_b32 s20, 0
    s_mov_b32 s28, 16777216
    s_cselect_b32 s28, 3407872, s28
    s_add_u32 s35, s35, s28
L_down_o:
    s_add_u32 s34, s34, s60
    s_add_u32 s34, s34, 11534336
    s_add_u32 s36, s36, 256
    s_cmp_eq_u32 s24, 1
    s_cselect_b32 s36, 1073741824, s36
    s_mul_i32 s37, s21, 3072
    s_add_u32 s37, s37, s61
    s_add_u32 s37, s37, 262144
    s_mul_i32 s38, s24, 18874368
    s_mul_i32 s28, s21, 9216
    s_add_u32 s38, s38, s28
    s_add_u32 s38, s38, 52428800
    s_lshr_b32 s28, s20, 1
    s_mul_i32 s43, s28, 9216
    s_mul_i32 s28, s28, 147456
    s_add_u32 s38, s38, s28
    s_and_b32 s28, s20, 1
    s_lshl_b32 s28, s28, 12
    s_add_u32 s43, s43, s28
    s_add_u32 s43, s43, 32768
    s_add_u32 s38, s38, s28
    s_mov_b32 s23, 32768
    s_mov_b32 s29, 1
L_spin_51:
    s_sub_u32 s23, s23, 1
    s_cbranch_scc1 L_abort
    s_sleep 2
    s_sleep 4
    buffer_load_dword v40, off, s[16:19], 0 offset:16 sc1
    s_waitcnt vmcnt(0)
    v_cmp_gt_u32 vcc, 256, v40
    s_nop 3
    s_cbranch_vccnz L_spin_51
    s_mov_b32 s23, 32768
    s_mov_b32 s29, 9
L_spin_52:
    s_sub_u32 s23, s23, 1
    s_cbranch_scc1 L_abort
    s_sleep 2
    buffer_load_dword v10, v9, s[4:7], s37 offen offset:0 sc1
    s_waitcnt vmcnt(0)
    v_cmp_eq_u32 vcc, 0, v10
    s_cbranch_vccnz L_spin_52
    s_mov_b32 m0, s43
    s_nop 0
    buffer_load_dwordx4 v0, s[4:7], s38 offen offset:0 sc1 lds
    buffer_load_dwordx4 v0, s[4:7], s38 offen offset:1024 sc1 lds
    buffer_load_dwordx4 v0, s[4:7], s38 offen offset:2048 sc1 lds
    buffer_load_dwordx4 v0, s[4:7], s38 offen offset:3072 sc1 lds
    s_add_u32 m0, s43, 4096
    s_nop 0
    buffer_load_dwordx4 v15, s[4:7], s38 offen sc1 lds
    s_waitcnt vmcnt(0)
    s_barrier
    ds_read_b128 v[20:23], v14 offset:0
    ds_read_b128 v[56:59], v14 offset:9216
    ds_read_b128 v[24:27], v14 offset:1024
    ds_read_b128 v[60:63], v14 offset:10240
    ds_read_b128 v[28:31], v14 offset:2048
    ds_read_b128 v[64:67], v14 offset:11264
    ds_read_b128 v[32:35], v14 offset:3072
    ds_read_b128 v[68:71], v14 offset:12288
    s_waitcnt lgkmcnt(6)
    v_mfma_f32_16x16x32_bf16 v[92:95], v[20:23], v[188:191], 0
    ds_read_b128 v[36:39], v14 offset:4096
    s_lshr_b32 s31, s30, 1
    v_mfma_f32_16x16x32_bf16 v[96:99], v[56:59], v[188:191], 0
    ds_read_b128 v[72:75], v14 offset:13312
    s_waitcnt lgkmcnt(6)
    v_mfma_f32_16x16x32_bf16 v[92:95], v[24:27], v[192:195], v[92:95]
    ds_read_b128 v[40:43], v14 offset:5120
    s_add_u32 s61, s32, 36864
    v_mfma_f32_16x16x32_bf16 v[96:99], v[60:63], v[192:195], v[96:99]
    ds_read_b128 v[76:79], v14 offset:14336
    s_waitcnt lgkmcnt(6)
    v_mfma_f32_16x16x32_bf16 v[92:95], v[28:31], v[196:199], v[92:95]
    ds_read_b128 v[44:47], v14 offset:6144
    s_add_u32 s62, s32, 294912
    v_mfma_f32_16x16x32_bf16 v[96:99], v[64:67], v[196:199], v[96:99]
    ds_read_b128 v[80:83], v14 offset:15360
    s_waitcnt lgkmcnt(6)
    v_mfma_f32_16x16x32_bf16 v[92:95], v[32:35], v[200:203], v[92:95]
    ds_read_b128 v[48:51], v14 offset:7168
    s_add_u32 s63, s32, 331776
    v_mfma_f32_16x16x32_bf16 v[96:99], v[68:71], v[200:203], v[96:99]
    ds_read_b128 v[84:87], v14 offset:16384
    s_waitcnt lgkmcnt(6)
    v_mfma_f32_16x16x32_bf16 v[92:95], v[36:39], v[204:207], v[92:95]
    ds_read_b128 v[52:55], v14 offset:8192
    s_add_u32 s37, s37, 4
    v_mfma_f32_16x16x32_bf16 v[96:99], v[72:75], v[204:207], v[96:99]
    ds_read_b128 v[88:91], v14 offset:17408
    s_waitcnt lgkmcnt(6)
    v_mfma_f32_16x16x32_bf16 v[92:95], v[40:43], v[208:211], v[92:95]
    s_add_u32 s38, s38, 294912
    s_add_u32 s43, s43, s44
    v_mfma_f32_16x16x32_bf16 v[96:99], v[76:79], v[208:211], v[96:99]
    s_waitcnt lgkmcnt(4)
    s_cmp_eq_u32 s30, 63
    s_cselect_b32 s47, 0, s6
    v_mfma_f32_16x16x32_bf16 v[92:95], v[44:47], v[212:215], v[92:95]
    v_mfma_f32_16x16x32_bf16 v[96:99], v[80:83], v[212:215], v[96:99]
    s_waitcnt lgkmcnt(2)
    v_mfma_f32_16x16x32_bf16 v[92:95], v[48:51], v[216:219], v[92:95]
    v_mfma_f32_16x16x32_bf16 v[96:99], v[84:87], v[216:219], v[96:99]
    s_waitcnt lgkmcnt(1)
    v_mfma_f32_16x16x32_bf16 v[92:95], v[52:55], v[220:223], v[92:95]
    s_waitcnt lgkmcnt(0)
    v_mfma_f32_16x16x32_bf16 v[96:99], v[88:91], v[220:223], v[96:99]
    v_mfma_f32_16x16x32_bf16 v[100:103], v[20:23], v[224:227], 0
    v_mfma_f32_16x16x32_bf16 v[104:107], v[56:59], v[224:227], 0
    v_mfma_f32_16x16x32_bf16 v[100:103], v[24:27], v[228:231], v[100:103]
    v_mfma_f32_16x16x32_bf16 v[104:107], v[60:63], v[228:231], v[104:107]
    v_mfma_f32_16x16x32_bf16 v[100:103], v[28:31], v[232:235], v[100:103]
    s_nop 0
    v_cvt_pk_bf16_f32 v108, v92, v93
    v_mfma_f32_16x16x32_bf16 v[104:107], v[64:67], v[232:235], v[104:107]
    v_bfi_b32 v108, 1, s31, v108
    v_mfma_f32_16x16x32_bf16 v[100:103], v[32:35], v[236:239], v[100:103]
    v_cvt_pk_bf16_f32 v112, v94, v95
    v_mfma_f32_16x16x32_bf16 v[104:107], v[68:71], v[236:239], v[104:107]
    v_bfi_b32 v112, 1, s31, v112
    v_mfma_f32_16x16x32_bf16 v[100:103], v[36:39], v[240:243], v[100:103]
    v_cvt_pk_bf16_f32 v116, v96, v97
    v_mfma_f32_16x16x32_bf16 v[104:107], v[72:75], v[240:243], v[104:107]
    v_bfi_b32 v116, 1, s31, v116
    v_mfma_f32_16x16x32_bf16 v[100:103], v[40:43], v[244:247], v[100:103]
    v_cvt_pk_bf16_f32 v120, v98, v99
    v_mfma_f32_16x16x32_bf16 v[104:107], v[76:79], v[244:247], v[104:107]
    v_bfi_b32 v120, 1, s31, v120
    v_mfma_f32_16x16x32_bf16 v[100:103], v[44:47], v[248:251], v[100:103]
    v_mfma_f32_16x16x32_bf16 v[104:107], v[80:83], v[248:251], v[104:107]
    v_mfma_f32_16x16x32_bf16 v[100:103], v[48:51], v[252:255], v[100:103]
    v_mfma_f32_16x16x32_bf16 v[104:107], v[84:87], v[252:255], v[104:107]
    v_mfma_f32_16x16x32_bf16 v[100:103], v[52:55], a[0:3], v[100:103]
    v_mfma_f32_16x16x32_bf16 v[104:107], v[88:91], a[0:3], v[104:107]
    v_mfma_f32_16x16x32_bf16 v[92:95], v[20:23], a[4:7], 0
    v_mfma_f32_16x16x32_bf16 v[96:99], v[56:59], a[4:7], 0
    v_mfma_f32_16x16x32_bf16 v[92:95], v[24:27], a[8:11], v[92:95]
    v_mfma_f32_16x16x32_bf16 v[96:99], v[60:63], a[8:11], v[96:99]
    v_mfma_f32_16x16x32_bf16 v[92:95], v[28:31], a[12:15], v[92:95]
    s_nop 1
    v_cvt_pk_bf16_f32 v109, v100, v101
    v_mfma_f32_16x16x32_bf16 v[96:99], v[64:67], a[12:15], v[96:99]
    v_cvt_pk_bf16_f32 v113, v102, v103
    v_mfma_f32_16x16x32_bf16 v[92:95], v[32:35], a[16:19], v[92:95]
    v_cvt_pk_bf16_f32 v117, v104, v105
    v_mfma_f32_16x16x32_bf16 v[96:99], v[68:71], a[16:19], v[96:99]
    v_cvt_pk_bf16_f32 v121, v106, v107
    v_mfma_f32_16x16x32_bf16 v[92:95], v[36:39], a[20:23], v[92:95]
    v_mfma_f32_16x16x32_bf16 v[96:99], v[72:75], a[20:23], v[96:99]
    v_mfma_f32_16x16x32_bf16 v[92:95], v[40:43], a[24:27], v[92:95]
    v_mfma_f32_16x16x32_bf16 v[96:99], v[76:79], a[24:27], v[96:99]
    v_mfma_f32_16x16x32_bf16 v[92:95], v[44:47], a[28:31], v[92:95]
    v_mfma_f32_16x16x32_bf16 v[96:99], v[80:83], a[28:31], v[96:99]
    v_mfma_f32_16x16x32_bf16 v[92:95], v[48:51], a[32:35], v[92:95]
    v_mfma_f32_16x16x32_bf16 v[96:99], v[84:87], a[32:35], v[96:99]
    v_mfma_f32_16x16x32_bf16 v[92:95], v[52:55], a[36:39], v[92:95]
    v_mfma_f32_16x16x32_bf16 v[96:99], v[88:91], a[36:39], v[96:99]
    v_mfma_f32_16x16x32_bf16 v[100:103], v[20:23], a[40:43], 0
    v_mfma_f32_16x16x32_bf16 v[104:107], v[56:59], a[40:43], 0
    buffer_load_dword v10, v9, s[4:7], s37 offen offset:0 sc1
    v_mfma_f32_16x16x32_bf16 v[100:103], v[24:27], a[44:47], v[100:103]
    v_mfma_f32_16x16x32_bf16 v[104:107], v[60:63], a[44:47], v[104:107]
    v_mfma_f32_16x16x32_bf16 v[100:103], v[28:31], a[48:51], v[100:103]
    s_nop 0
    v_cvt_pk_bf16_f32 v110, v92, v93
    v_mfma_f32_16x16x32_bf16 v[104:107], v[64:67], a[48:51], v[104:107]
    v_cvt_pk_bf16_f32 v114, v94, v95
    v_mfma_f32_16x16x32_bf16 v[100:103], v[32:35], a[52:55], v[100:103]
    v_cvt_pk_bf16_f32 v118, v96, v97
    v_mfma_f32_16x16x32_bf16 v[104:107], v[68:71], a[52:55], v[104:107]
    v_cvt_pk_bf16_f32 v122, v98, v99
    v_mfma_f32_16x16x32_bf16 v[100:103], v[36:39], a[56:59], v[100:103]
    v_mfma_f32_16x16x32_bf16 v[104:107], v[72:75], a[56:59], v[104:107]
    v_mfma_f32_16x16x32_bf16 v[100:103], v[40:43], a[60:63], v[100:103]
    v_mfma_f32_16x16x32_bf16 v[104:107], v[76:79], a[60:63], v[104:107]
    v_mfma_f32_16x16x32_bf16 v[100:103], v[44:47], a[64:67], v[100:103]
    v_mfma_f32_16x16x32_bf16 v[104:107], v[80:83], a[64:67], v[104:107]
    v_mfma_f32_16x16x32_bf16 v[100:103], v[48:51], a[68:71], v[100:103]
    v_mfma_f32_16x16x32_bf16 v[104:107], v[84:87], a[68:71], v[104:107]
    v_mfma_f32_16x16x32_bf16 v[100:103], v[52:55], a[72:75], v[100:103]
    v_mfma_f32_16x16x32_bf16 v[104:107], v[88:91], a[72:75], v[104:107]
    v_mfma_f32_16x16x32_bf16 v[92:95], v[20:23], a[76:79], 0
    v_mfma_f32_16x16x32_bf16 v[96:99], v[56:59], a[76:79], 0
    v_mfma_f32_16x16x32_bf16 v[92:95], v[24:27], a[80:83], v[92:95]
    v_mfma_f32_16x16x32_bf16 v[96:99], v[60:63], a[80:83], v[96:99]
    v_mfma_f32_16x16x32_bf16 v[92:95], v[28:31], a[84:87], v[92:95]
    s_nop 1
    v_cvt_pk_bf16_f32 v111, v100, v101
    v_mfma_f32_16x16x32_bf16 v[96:99], v[64:67], a[84:87], v[96:99]
    buffer_store_dwordx4 v[108:111], v1, s[4:7], s32 offen offset:0
    v_mfma_f32_16x16x32_bf16 v[92:95], v[32:35], a[88:91], v[92:95]
    v_mfma_f32_16x16x32_bf16 v[96:99], v[68:71], a[88:91], v[96:99]
    v_cvt_pk_bf16_f32 v115, v102, v103
    v_mfma_f32_16x16x32_bf16 v[92:95], v[36:39], a[92:95], v[92:95]
    buffer_store_dwordx4 v[112:115], v1, s[4:7], s61 offen offset:0
    v_mfma_f32_16x16x32_bf16 v[96:99], v[72:75], a[92:95], v[96:99]
    v_mfma_f32_16x16x32_bf16 v[92:95], v[40:43], a[96:99], v[92:95]
    v_cvt_pk_bf16_f32 v119, v104, v105
    v_mfma_f32_16x16x32_bf16 v[96:99], v[76:79], a[96:99], v[96:99]
    buffer_store_dwordx4 v[116:119], v1, s[4:7], s62 offen offset:0
    v_mfma_f32_16x16x32_bf16 v[92:95], v[44:47], a[100:103], v[92:95]
    v_mfma_f32_16x16x32_bf16 v[96:99], v[80:83], a[100:103], v[96:99]
    v_cvt_pk_bf16_f32 v123, v106, v107
    v_mfma_f32_16x16x32_bf16 v[92:95], v[48:51], a[104:107], v[92:95]
    buffer_store_dwordx4 v[120:123], v1, s[4:7], s63 offen offset:0
    v_mfma_f32_16x16x32_bf16 v[96:99], v[84:87], a[104:107], v[96:99]
    v_mfma_f32_16x16x32_bf16 v[92:95], v[52:55], a[108:111], v[92:95]
    v_mfma_f32_16x16x32_bf16 v[96:99], v[88:91], a[108:111], v[96:99]
    s_waitcnt vmcnt(4)
    v_cmp_eq_u32 vcc, 0, v10
    s_nop 0
    s_cmp_eq_u64 vcc, 0
    s_cselect_b32 s10, s47, 0
    v_mfma_f32_16x16x32_bf16 v[100:103], v[20:23], a[112:115], 0
    s_mov_b32 m0, s43
    v_mfma_f32_16x16x32_bf16 v[104:107], v[56:59], a[112:115], 0
    buffer_load_dwordx4 v0, s[8:11], s38 offen offset:0 sc1 lds
    v_mfma_f32_16x16x32_bf16 v[100:103], v[24:27], a[116:119], v[100:103]
    v_mfma_f32_16x16x32_bf16 v[104:107], v[60:63], a[116:119], v[104:107]
    v_mfma_f32_16x16x32_bf16 v[100:103], v[28:31], a[120:123], v[100:103]
    buffer_load_dwordx4 v0, s[8:11], s38 offen offset:1024 sc1 lds
    v_mfma_f32_16x16x32_bf16 v[104:107], v[64:67], a[120:123], v[104:107]
    v_cvt_pk_bf16_f32 v108, v92, v93
    v_mfma_f32_16x16x32_bf16 v[100:103], v[32:35], a[124:127], v[100:103]
    v_bfi_b32 v108, 1, s31, v108
    v_mfma_f32_16x16x32_bf16 v[104:107], v[68:71], a[124:127], v[104:107]
    buffer_load_dwordx4 v0, s[8:11], s38 offen offset:2048 sc1 lds
    v_mfma_f32_16x16x32_bf16 v[100:103], v[36:39], a[128:131], v[100:103]
    v_cvt_pk_bf16_f32 v112, v94, v95
    v_mfma_f32_16x16x32_bf16 v[104:107], v[72:75], a[128:131], v[104:107]
    v_bfi_b32 v112, 1, s31, v112
    v_mfma_f32_16x16x32_bf16 v[100:103], v[40:43], a[132:135], v[100:103]
    buffer_load_dwordx4 v0, s[8:11], s38 offen offset:3072 sc1 lds
    v_mfma_f32_16x16x32_bf16 v[104:107], v[76:79], a[132:135], v[104:107]
    v_cvt_pk_bf16_f32 v116, v96, v97
    v_mfma_f32_16x16x32_bf16 v[100:103], v[44:47], a[136:139], v[100:103]
    s_add_u32 m0, s43, 4096
    v_mfma_f32_16x16x32_bf16 v[104:107], v[80:83], a[136:139], v[104:107]
    buffer_load_dwordx4 v15, s[8:11], s38 offen sc1 lds
    v_mfma_f32_16x16x32_bf16 v[100:103], v[48:51], a[140:143], v[100:103]
    v_bfi_b32 v116, 1, s31, v116
    v_mfma_f32_16x16x32_bf16 v[104:107], v[84:87], a[140:143], v[104:107]
    v_cvt_pk_bf16_f32 v120, v98, v99
    v_mfma_f32_16x16x32_bf16 v[100:103], v[52:55], a[144:147], v[100:103]
    v_bfi_b32 v120, 1, s31, v120
    v_mfma_f32_16x16x32_bf16 v[104:107], v[88:91], a[144:147], v[104:107]
    v_mfma_f32_16x16x32_bf16 v[92:95], v[20:23], a[148:151], 0
    v_mfma_f32_16x16x32_bf16 v[96:99], v[56:59], a[148:151], 0
    v_mfma_f32_16x16x32_bf16 v[92:95], v[24:27], a[152:155], v[92:95]
    v_mfma_f32_16x16x32_bf16 v[96:99], v[60:63], a[152:155], v[96:99]
    v_mfma_f32_16x16x32_bf16 v[92:95], v[28:31], a[156:159], v[92:95]
    s_nop 0
    v_cvt_pk_bf16_f32 v109, v100, v101
    v_mfma_f32_16x16x32_bf16 v[96:99], v[64:67], a[156:159], v[96:99]
    v_cvt_pk_bf16_f32 v113, v102, v103
    v_mfma_f32_16x16x32_bf16 v[92:95], v[32:35], a[160:163], v[92:95]
    v_cvt_pk_bf16_f32 v117, v104, v105
    v_mfma_f32_16x16x32_bf16 v[96:99], v[68:71], a[160:163], v[96:99]
    v_cvt_pk_bf16_f32 v121, v106, v107
    v_mfma_f32_16x16x32_bf16 v[92:95], v[36:39], a[164:167], v[92:95]
    v_mfma_f32_16x16x32_bf16 v[96:99], v[72:75], a[164:167], v[96:99]
    v_mfma_f32_16x16x32_bf16 v[92:95], v[40:43], a[168:171], v[92:95]
    v_mfma_f32_16x16x32_bf16 v[96:99], v[76:79], a[168:171], v[96:99]
    v_mfma_f32_16x16x32_bf16 v[92:95], v[44:47], a[172:175], v[92:95]
    v_mfma_f32_16x16x32_bf16 v[96:99], v[80:83], a[172:175], v[96:99]
    v_mfma_f32_16x16x32_bf16 v[92:95], v[48:51], a[176:179], v[92:95]
    v_mfma_f32_16x16x32_bf16 v[96:99], v[84:87], a[176:179], v[96:99]
    v_mfma_f32_16x16x32_bf16 v[92:95], v[52:55], a[180:183], v[92:95]
    v_mfma_f32_16x16x32_bf16 v[96:99], v[88:91], a[180:183], v[96:99]
    v_mfma_f32_16x16x32_bf16 v[100:103], v[20:23], a[184:187], 0
    v_mfma_f32_16x16x32_bf16 v[104:107], v[56:59], a[184:187], 0
    buffer_load_dwordx4 v[180:183], v0, s[4:7], s34 offen sc1
    buffer_load_ushort v184, v8, s[4:7], s34 offen offset:1024 sc1
    v_mfma_f32_16x16x32_bf16 v[100:103], v[24:27], a[188:191], v[100:103]
    v_mfma_f32_16x16x32_bf16 v[104:107], v[60:63], a[188:191], v[104:107]
    v_mfma_f32_16x16x32_bf16 v[100:103], v[28:31], a[192:195], v[100:103]
    v_cvt_pk_bf16_f32 v110, v92, v93
    v_mfma_f32_16x16x32_bf16 v[104:107], v[64:67], a[192:195], v[104:107]
    v_cvt_pk_bf16_f32 v114, v94, v95
    v_mfma_f32_16x16x32_bf16 v[100:103], v[32:35], a[196:199], v[100:103]
    v_cvt_pk_bf16_f32 v118, v96, v97
    v_mfma_f32_16x16x32_bf16 v[104:107], v[68:71], a[196:199], v[104:107]
    v_cvt_pk_bf16_f32 v122, v98, v99
    v_mfma_f32_16x16x32_bf16 v[100:103], v[36:39], a[200:203], v[100:103]
    v_mfma_f32_16x16x32_bf16 v[104:107], v[72:75], a[200:203], v[104:107]
    v_mfma_f32_16x16x32_bf16 v[100:103], v[40:43], a[204:207], v[100:103]
    v_mfma_f32_16x16x32_bf16 v[104:107], v[76:79], a[204:207], v[104:107]
    v_mfma_f32_16x16x32_bf16 v[100:103], v[44:47], a[208:211], v[100:103]
    v_mfma_f32_16x16x32_bf16 v[104:107], v[80:83], a[208:211], v[104:107]
    v_mfma_f32_16x16x32_bf16 v[100:103], v[48:51], a[212:215], v[100:103]
    v_mfma_f32_16x16x32_bf16 v[104:107], v[84:87], a[212:215], v[104:107]
    v_mfma_f32_16x16x32_bf16 v[100:103], v[52:55], a[216:219], v[100:103]
    v_mfma_f32_16x16x32_bf16 v[104:107], v[88:91], a[216:219], v[104:107]
    v_mfma_f32_16x16x32_bf16 v[92:95], v[20:23], a[220:223], 0
    v_mfma_f32_16x16x32_bf16 v[96:99], v[56:59], a[220:223], 0
    v_mfma_f32_16x16x32_bf16 v[92:95], v[24:27], a[224:227], v[92:95]
    v_mfma_f32_16x16x32_bf16 v[96:99], v[60:63], a[224:227], v[96:99]
    v_mfma_f32_16x16x32_bf16 v[92:95], v[28:31], a[228:231], v[92:95]
    s_nop 1
    v_cvt_pk_bf16_f32 v111, v100, v101
    v_mfma_f32_16x16x32_bf16 v[96:99], v[64:67], a[228:231], v[96:99]
    buffer_store_dwordx4 v[108:111], v1, s[4:7], s32 offen offset:256
    v_mfma_f32_16x16x32_bf16 v[92:95], v[32:35], a[232:235], v[92:95]
    v_mfma_f32_16x16x32_bf16 v[96:99], v[68:71], a[232:235], v[96:99]
    v_cvt_pk_bf16_f32 v115, v102, v103
    v_mfma_f32_16x16x32_bf16 v[92:95], v[36:39], a[236:239], v[92:95]
    buffer_store_dwordx4 v[112:115], v1, s[4:7], s61 offen offset:256
    v_mfma_f32_16x16x32_bf16 v[96:99], v[72:75], a[236:239], v[96:99]
    v_mfma_f32_16x16x32_bf16 v[92:95], v[40:43], a[240:243], v[92:95]
    v_cvt_pk_bf16_f32 v119, v104, v105
    v_mfma_f32_16x16x32_bf16 v[96:99], v[76:79], a[240:243], v[96:99]
    buffer_store_dwordx4 v[116:119], v1, s[4:7], s62 offen offset:256
    v_mfma_f32_16x16x32_bf16 v[92:95], v[44:47], a[244:247], v[92:95]
    v_mfma_f32_16x16x32_bf16 v[96:99], v[80:83], a[244:247], v[96:99]
    v_cvt_pk_bf16_f32 v123, v106, v107
    v_mfma_f32_16x16x32_bf16 v[92:95], v[48:51], a[248:251], v[92:95]
    buffer_store_dwordx4 v[120:123], v1, s[4:7], s63 offen offset:256
    v_mfma_f32_16x16x32_bf16 v[96:99], v[84:87], a[248:251], v[96:99]
    v_mfma_f32_16x16x32_bf16 v[92:95], v[52:55], a[252:255], v[92:95]
    v_mfma_f32_16x16x32_bf16 v[96:99], v[88:91], a[252:255], v[96:99]
    s_mov_b32 s51, s31
    s_mov_b32 s67, s32
    s_mov_b32 s23, 32768
    s_xor_b32 s32, s32, s53
    s_nop 2
    s_branch L_down_end
L_down_carry:
    s_barrier
    ds_read_b128 v[20:23], v14 offset:0
    ds_read_b128 v[56:59], v14 offset:9216
    ds_read_b128 v[24:27], v14 offset:1024
    ds_read_b128 v[60:63], v14 offset:10240
    ds_read_b128 v[28:31], v14 offset:2048
    ds_read_b128 v[64:67], v14 offset:11264
    ds_read_b128 v[32:35], v14 offset:3072
    ds_read_b128 v[68:71], v14 offset:12288
    s_cmp_eq_u32 s10, 0
    s_cbranch_scc1 L_kt_53
    v_cvt_pk_bf16_f32 v124, v92, v93
    v_bfi_b32 v124, 1, s51, v124
    buffer_store_dword v124, v2, s[4:7], s67 offen offset:512
    v_cvt_pk_bf16_f32 v125, v94, v95
    v_bfi_b32 v125, 1, s51, v125
    buffer_store_dword v125, v2, s[4:7], s61 offen offset:512
    v_cvt_pk_bf16_f32 v126, v96, v97
    v_bfi_b32 v126, 1, s51, v126
    buffer_store_dword v126, v2, s[4:7], s62 offen offset:512
    v_cvt_pk_bf16_f32 v127, v98, v99
    v_bfi_b32 v127, 1, s51, v127
    buffer_store_dword v127, v2, s[4:7], s63 offen offset:512
L_kt_53:
    s_nop 1
    s_waitcnt lgkmcnt(6)
    v_mfma_f32_16x16x32_bf16 v[92:95], v[20:23], v[188:191], 0
    ds_read_b128 v[36:39], v14 offset:4096
    s_lshr_b32 s31, s30, 1
    v_mfma_f32_16x16x32_bf16 v[96:99], v[56:59], v[188:191], 0
    ds_read_b128 v[72:75], v14 offset:13312
    s_waitcnt lgkmcnt(6)
    v_mfma_f32_16x16x32_bf16 v[92:95], v[24:27], v[192:195], v[92:95]
    ds_read_b128 v[40:43], v14 offset:5120
    s_add_u32 s61, s32, 36864
    v_mfma_f32_16x16x32_bf16 v[96:99], v[60:63], v[192:195], v[96:99]
    ds_read_b128 v[76:79], v14 offset:14336
    s_waitcnt lgkmcnt(6)
    buffer_load_dwordx4 v[128:131], v3, s[4:7], s33 offen offset:0 sc1
    v_mfma_f32_16x16x32_bf16 v[92:95], v[28:31], v[196:199], v[92:95]
    ds_read_b128 v[44:47], v14 offset:6144
    s_add_u32 s62, s32, 294912
    v_mfma_f32_16x16x32_bf16 v[96:99], v[64:67], v[196:199], v[96:99]
    ds_read_b128 v[80:83], v14 offset:15360
    s_waitcnt lgkmcnt(6)
    v_mfma_f32_16x16x32_bf16 v[92:95], v[32:35], v[200:203], v[92:95]
    ds_read_b128 v[48:51], v14 offset:7168
    s_add_u32 s63, s32, 331776
    v_mfma_f32_16x16x32_bf16 v[96:99], v[68:71], v[200:203], v[96:99]
    ds_read_b128 v[84:87], v14 offset:16384
    s_waitcnt lgkmcnt(6)
    buffer_load_dwordx4 v[132:135], v3, s[4:7], s64 offen offset:0 sc1
    v_mfma_f32_16x16x32_bf16 v[92:95], v[36:39], v[204:207], v[92:95]
    ds_read_b128 v[52:55], v14 offset:8192
    s_add_u32 s37, s37, 4
    v_mfma_f32_16x16x32_bf16 v[96:99], v[72:75], v[204:207], v[96:99]
    ds_read_b128 v[88:91], v14 offset:17408
    s_waitcnt lgkmcnt(6)
    v_mfma_f32_16x16x32_bf16 v[92:95], v[40:43], v[208:211], v[92:95]
    s_add_u32 s38, s38, 294912
    s_add_u32 s43, s43, s44
    v_mfma_f32_16x16x32_bf16 v[96:99], v[76:79], v[208:211], v[96:99]
    s_waitcnt lgkmcnt(4)
    buffer_load_dwordx4 v[136:139], v3, s[4:7], s65 offen offset:0 sc1
    v_mfma_f32_16x16x32_bf16 v[92:95], v[44:47], v[212:215], v[92:95]
    s_cmp_eq_u32 s30, 63
    s_cselect_b32 s47, 0, s6
    v_mfma_f32_16x16x32_bf16 v[96:99], v[80:83], v[212:215], v[96:99]
    s_waitcnt lgkmcnt(2)
    v_mfma_f32_16x16x32_bf16 v[92:95], v[48:51], v[216:219], v[92:95]
    v_mfma_f32_16x16x32_bf16 v[96:99], v[84:87], v[216:219], v[96:99]
    s_waitcnt lgkmcnt(1)
    buffer_load_dwordx4 v[140:143], v3, s[4:7], s66 offen offset:0 sc1
    v_mfma_f32_16x16x32_bf16 v[92:95], v[52:55], v[220:223], v[92:95]
    s_waitcnt lgkmcnt(0)
    v_mfma_f32_16x16x32_bf16 v[96:99], v[88:91], v[220:223], v[96:99]
    v_mfma_f32_16x16x32_bf16 v[100:103], v[20:23], v[224:227], 0
    v_mfma_f32_16x16x32_bf16 v[104:107], v[56:59], v[224:227], 0
    buffer_load_dwordx4 v[144:147], v3, s[4:7], s33 offen offset:256 sc1
    v_mfma_f32_16x16x32_bf16 v[100:103], v[24:27], v[228:231], v[100:103]
    v_mfma_f32_16x16x32_bf16 v[104:107], v[60:63], v[228:231], v[104:107]
    v_mfma_f32_16x16x32_bf16 v[100:103], v[28:31], v[232:235], v[100:103]
    v_cvt_pk_bf16_f32 v108, v92, v93
    v_mfma_f32_16x16x32_bf16 v[104:107], v[64:67], v[232:235], v[104:107]
    buffer_load_dwordx4 v[148:151], v3, s[4:7], s64 offen offset:256 sc1
    v_mfma_f32_16x16x32_bf16 v[100:103], v[32:35], v[236:239], v[100:103]
    v_bfi_b32 v108, 1, s31, v108
    v_mfma_f32_16x16x32_bf16 v[104:107], v[68:71], v[236:239], v[104:107]
    v_cvt_pk_bf16_f32 v112, v94, v95
    v_mfma_f32_16x16x32_bf16 v[100:103], v[36:39], v[240:243], v[100:103]
    v_bfi_b32 v112, 1, s31, v112
    v_mfma_f32_16x16x32_bf16 v[104:107], v[72:75], v[240:243], v[104:107]
    buffer_load_dwordx4 v[152:155], v3, s[4:7], s65 offen offset:256 sc1
    v_mfma_f32_16x16x32_bf16 v[100:103], v[40:43], v[244:247], v[100:103]
    v_cvt_pk_bf16_f32 v116, v96, v97
    v_mfma_f32_16x16x32_bf16 v[104:107], v[76:79], v[244:247], v[104:107]
L_rsc_55:
    s_waitcnt vmcnt(3)
    v_mfma_f32_16x16x32_bf16 v[164:167], v[16:19], v[128:131], 0
    v_bitop3_b32 v176, v128, v132, s51 bitop3:0x7e
    v_bitop3_b32 v177, v136, v140, s51 bitop3:0x7e
    v_mfma_f32_16x16x32_bf16 v[164:167], v[16:19], v[132:135], v[164:167]
    v_bitop3_b32 v176, v176, v177, 1 bitop3:0xa8
    v_cmp_ne_u32 vcc, 0, v176
    v_mfma_f32_16x16x32_bf16 v[164:167], v[16:19], v[136:139], v[164:167]
    v_mfma_f32_16x16x32_bf16 v[164:167], v[16:19], v[140:143], v[164:167]
    s_cbranch_vccnz L_rsr_54
    v_mfma_f32_16x16x32_bf16 v[100:103], v[44:47], v[248:251], v[100:103]
    v_bfi_b32 v116, 1, s31, v116
    v_mfma_f32_16x16x32_bf16 v[104:107], v[80:83], v[248:251], v[104:107]
    buffer_load_dwordx4 v[156:159], v3, s[4:7], s66 offen offset:256 sc1
    v_mfma_f32_16x16x32_bf16 v[100:103], v[48:51], v[252:255], v[100:103]
    v_cvt_pk_bf16_f32 v120, v98, v99
    v_mfma_f32_16x16x32_bf16 v[104:107], v[84:87], v[252:255], v[104:107]
    v_bfi_b32 v120, 1, s31, v120
    ds_write_b32 v5, v164 offset:0
    v_mfma_f32_16x16x32_bf16 v[100:103], v[52:55], a[0:3], v[100:103]
    ds_write_b32 v5, v165 offset:2304
    ds_write_b32 v5, v166 offset:64
    v_mfma_f32_16x16x32_bf16 v[104:107], v[88:91], a[0:3], v[104:107]
    ds_write_b32 v5, v167 offset:2368
    buffer_load_dwordx4 v[160:163], v4, s[4:7], s33 offen offset:512 sc1
    v_mfma_f32_16x16x32_bf16 v[92:95], v[20:23], a[4:7], 0
    v_mfma_f32_16x16x32_bf16 v[96:99], v[56:59], a[4:7], 0
    v_mfma_f32_16x16x32_bf16 v[92:95], v[24:27], a[8:11], v[92:95]
    v_mfma_f32_16x16x32_bf16 v[96:99], v[60:63], a[8:11], v[96:99]
    v_mfma_f32_16x16x32_bf16 v[92:95], v[28:31], a[12:15], v[92:95]
    v_cvt_pk_bf16_f32 v109, v100, v101
    v_mfma_f32_16x16x32_bf16 v[96:99], v[64:67], a[12:15], v[96:99]
    v_cvt_pk_bf16_f32 v113, v102, v103
    v_mfma_f32_16x16x32_bf16 v[92:95], v[32:35], a[16:19], v[92:95]
    v_cvt_pk_bf16_f32 v117, v104, v105
    v_mfma_f32_16x16x32_bf16 v[96:99], v[68:71], a[16:19], v[96:99]
    v_cvt_pk_bf16_f32 v121, v106, v107
    v_mfma_f32_16x16x32_bf16 v[92:95], v[36:39], a[20:23], v[92:95]
    v_mfma_f32_16x16x32_bf16 v[96:99], v[72:75], a[20:23], v[96:99]
    v_mfma_f32_16x16x32_bf16 v[92:95], v[40:43], a[24:27], v[92:95]
L_rsc_57:
    s_waitcnt vmcnt(0)
    v_mfma_f32_16x16x32_bf16 v[168:171], v[16:19], v[144:147], 0
    v_bitop3_b32 v176, v144, v148, s51 bitop3:0x7e
    v_bitop3_b32 v177, v152, v156, s51 bitop3:0x7e
    v_mfma_f32_16x16x32_bf16 v[168:171], v[16:19], v[148:151], v[168:171]
    v_bitop3_b32 v178, v160, v161, s51 bitop3:0x7e
    v_bitop3_b32 v179, v162, v163, s51 bitop3:0x7e
    v_mfma_f32_16x16x32_bf16 v[168:171], v[16:19], v[152:155], v[168:171]
    v_or3_b32 v177, v177, v178, v179
    v_bitop3_b32 v176, v176, v177, 1 bitop3:0xa8
    v_mfma_f32_16x16x32_bf16 v[168:171], v[16:19], v[156:159], v[168:171]
    v_cmp_ne_u32 vcc, 0, v176
    v_mfma_f32_16x16x32_bf16 v[172:175], v[16:19], v[160:163], 0
    s_cbranch_vccnz L_rsr_56
    v_mfma_f32_16x16x32_bf16 v[96:99], v[76:79], a[24:27], v[96:99]
    v_mfma_f32_16x16x32_bf16 v[92:95], v[44:47], a[28:31], v[92:95]
    s_nop 2
    ds_write_b32 v5, v168 offset:256
    v_mfma_f32_16x16x32_bf16 v[96:99], v[80:83], a[28:31], v[96:99]
    ds_write_b32 v5, v169 offset:2560
    ds_write_b32 v5, v170 offset:320
    ds_write_b32 v5, v171 offset:2624
    v_mfma_f32_16x16x32_bf16 v[92:95], v[48:51], a[32:35], v[92:95]
    v_add_f32_dpp v172, v172, v172 row_ror:4 row_mask:0xf bank_mask:0xf
    v_add_f32_dpp v173, v173, v173 row_ror:4 row_mask:0xf bank_mask:0xf
    v_add_f32_dpp v174, v174, v174 row_ror:4 row_mask:0xf bank_mask:0xf
    v_mfma_f32_16x16x32_bf16 v[96:99], v[84:87], a[32:35], v[96:99]
    v_add_f32_dpp v175, v175, v175 row_ror:4 row_mask:0xf bank_mask:0xf
    v_add_f32_dpp v172, v172, v172 row_ror:8 row_mask:0xf bank_mask:0xf
    v_add_f32_dpp v173, v173, v173 row_ror:8 row_mask:0xf bank_mask:0xf
    v_mfma_f32_16x16x32_bf16 v[92:95], v[52:55], a[36:39], v[92:95]
    v_add_f32_dpp v174, v174, v174 row_ror:8 row_mask:0xf bank_mask:0xf
    v_add_f32_dpp v175, v175, v175 row_ror:8 row_mask:0xf bank_mask:0xf
    ds_write_b32 v6, v172 offset:512
    v_mfma_f32_16x16x32_bf16 v[96:99], v[88:91], a[36:39], v[96:99]
    ds_write_b32 v6, v173 offset:2816
    ds_write_b32 v6, v174 offset:516
    ds_write_b32 v6, v175 offset:2820
    v_mfma_f32_16x16x32_bf16 v[100:103], v[20:23], a[40:43], 0
    v_mfma_f32_16x16x32_bf16 v[104:107], v[56:59], a[40:43], 0
    buffer_load_dword v10, v9, s[4:7], s37 offen offset:0 sc1
    v_mfma_f32_16x16x32_bf16 v[100:103], v[24:27], a[44:47], v[100:103]
    s_waitcnt lgkmcnt(0)
    s_barrier
    v_mfma_f32_16x16x32_bf16 v[104:107], v[60:63], a[44:47], v[104:107]
    ds_read_b128 v[154:157], v7
    ds_read_b128 v[158:161], v7 offset:16
    ds_read_b32 v162, v11
    v_mfma_f32_16x16x32_bf16 v[100:103], v[28:31], a[48:51], v[100:103]
    v_cvt_pk_bf16_f32 v110, v92, v93
    v_lshlrev_b32 v144, 16, v180
    v_and_b32 v145, 0xffff0000, v180
    v_mfma_f32_16x16x32_bf16 v[104:107], v[64:67], a[48:51], v[104:107]
    v_cvt_pk_bf16_f32 v114, v94, v95
    v_lshlrev_b32 v146, 16, v181
    v_and_b32 v147, 0xffff0000, v181
    v_mfma_f32_16x16x32_bf16 v[100:103], v[32:35], a[52:55], v[100:103]
    v_cvt_pk_bf16_f32 v118, v96, v97
    v_lshlrev_b32 v148, 16, v182
    v_and_b32 v149, 0xffff0000, v182
    v_mfma_f32_16x16x32_bf16 v[104:107], v[68:71], a[52:55], v[104:107]
    v_cvt_pk_bf16_f32 v122, v98, v99
    v_lshlrev_b32 v150, 16, v183
    v_and_b32 v151, 0xffff0000, v183
    v_mfma_f32_16x16x32_bf16 v[100:103], v[36:39], a[56:59], v[100:103]
    v_lshlrev_b32 v152, 16, v184
    s_waitcnt lgkmcnt(2)
    v_add_f32 v154, v154, v144
    v_mfma_f32_16x16x32_bf16 v[104:107], v[72:75], a[56:59], v[104:107]
    v_add_f32 v155, v155, v145
    v_add_f32 v156, v156, v146
    v_add_f32 v157, v157, v147
    v_mfma_f32_16x16x32_bf16 v[100:103], v[40:43], a[60:63], v[100:103]
    s_waitcnt lgkmcnt(1)
    v_add_f32 v158, v158, v148
    v_add_f32 v159, v159, v149
    v_mfma_f32_16x16x32_bf16 v[104:107], v[76:79], a[60:63], v[104:107]
    v_add_f32 v160, v160, v150
    v_add_f32 v161, v161, v151
    s_waitcnt lgkmcnt(0)
    v_add_f32 v162, v162, v152
    v_mfma_f32_16x16x32_bf16 v[100:103], v[44:47], a[64:67], v[100:103]
    v_add_f32 v176, v154, v155
    v_mul_f32 v177, v154, v154
    v_fmac_f32 v177, v155, v155
    v_mfma_f32_16x16x32_bf16 v[104:107], v[80:83], a[64:67], v[104:107]
    v_add_f32 v176, v176, v156
    v_fmac_f32 v177, v156, v156
    v_add_f32 v176, v176, v157
    v_mfma_f32_16x16x32_bf16 v[100:103], v[48:51], a[68:71], v[100:103]
    v_fmac_f32 v177, v157, v157
    v_add_f32 v176, v176, v158
    v_fmac_f32 v177, v158, v158
    v_mfma_f32_16x16x32_bf16 v[104:107], v[84:87], a[68:71], v[104:107]
    v_add_f32 v176, v176, v159
    v_fmac_f32 v177, v159, v159
    v_add_f32 v176, v176, v160
    v_mfma_f32_16x16x32_bf16 v[100:103], v[52:55], a[72:75], v[100:103]
    v_fmac_f32 v177, v160, v160
    v_add_f32 v176, v176, v161
    v_fmac_f32 v177, v161, v161
    v_mfma_f32_16x16x32_bf16 v[104:107], v[88:91], a[72:75], v[104:107]
    v_add_f32 v176, v176, v162
    v_fmac_f32 v177, v162, v162
    s_nop 0
    v_add_f32_dpp v176, v176, v176 quad_perm:[1,0,3,2] row_mask:0xf bank_mask:0xf
    v_mfma_f32_16x16x32_bf16 v[92:95], v[20:23], a[76:79], 0
    v_add_f32_dpp v177, v177, v177 quad_perm:[1,0,3,2] row_mask:0xf bank_mask:0xf
    v_add_f32_dpp v176, v176, v176 quad_perm:[2,3,0,1] row_mask:0xf bank_mask:0xf
    s_nop 0
    v_add_f32_dpp v177, v177, v177 quad_perm:[2,3,0,1] row_mask:0xf bank_mask:0xf
    v_mfma_f32_16x16x32_bf16 v[96:99], v[56:59], a[76:79], 0
    v_add_f32_dpp v176, v176, v176 row_half_mirror row_mask:0xf bank_mask:0xf
    v_add_f32_dpp v177, v177, v177 row_half_mirror row_mask:0xf bank_mask:0xf
    s_nop 0
    v_add_f32_dpp v176, v176, v176 row_mirror row_mask:0xf bank_mask:0xf
    v_mfma_f32_16x16x32_bf16 v[92:95], v[24:27], a[80:83], v[92:95]
    v_add_f32_dpp v177, v177, v177 row_mirror row_mask:0xf bank_mask:0xf
    v_mov_b32 v179, 0x3727c5ac
    s_nop 0
    v_permlane16_swap_b32 v176, v177
    v_mfma_f32_16x16x32_bf16 v[96:99], v[60:63], a[80:83], v[96:99]
    v_add_f32 v176, v176, v177
    v_mov_b32 v178, v176
    s_add_u32 s34, s34, 36864
    v_mfma_f32_16x16x32_bf16 v[92:95], v[28:31], a[84:87], v[92:95]
    v_cvt_pk_bf16_f32 v111, v100, v101
    v_permlane32_swap_b32 v176, v178
    v_add_f32 v176, v176, v178
    v_mfma_f32_16x16x32_bf16 v[96:99], v[64:67], a[84:87], v[96:99]
    buffer_store_dwordx4 v[108:111], v1, s[4:7], s32 offen offset:0
    v_mfma_f32_16x16x32_bf16 v[92:95], v[32:35], a[88:91], v[92:95]
    v_mul_f32 v176, 0x3ae38e39, v176
    s_nop 0
    v_readlane_b32 s60, v176, 0
    v_mfma_f32_16x16x32_bf16 v[96:99], v[68:71], a[88:91], v[96:99]
    v_cvt_pk_bf16_f32 v115, v102, v103
    v_readlane_b32 s28, v176, 16
    s_nop 1
    v_add_f32 v179, s28, v179
    v_mfma_f32_16x16x32_bf16 v[92:95], v[36:39], a[92:95], v[92:95]
    buffer_store_dwordx4 v[112:115], v1, s[4:7], s61 offen offset:0
    v_mfma_f32_16x16x32_bf16 v[96:99], v[72:75], a[92:95], v[96:99]
    v_fma_f32 v179, -v176, s60, v179
    v_rsq_f32 v179, v179
    v_mfma_f32_16x16x32_bf16 v[92:95], v[40:43], a[96:99], v[92:95]
    v_cvt_pk_bf16_f32 v119, v104, v105
    s_andn2_b32 s60, s60, s58
    v_readlane_b32 s28, v179, 0
    v_mfma_f32_16x16x32_bf16 v[96:99], v[76:79], a[96:99], v[96:99]
    buffer_store_dwordx4 v[116:119], v1, s[4:7], s62 offen offset:0
    v_mfma_f32_16x16x32_bf16 v[92:95], v[44:47], a[100:103], v[92:95]
    s_andn2_b32 s28, s28, s58
    s_or_b32 s28, s28, s59
    v_mov_b32 v178, s28
    v_mfma_f32_16x16x32_bf16 v[96:99], v[80:83], a[100:103], v[96:99]
    v_cvt_pk_bf16_f32 v123, v106, v107
    v_mul_f32 v179, s60, v178
    v_fma_f32 v154, v154, v178, -v179
    v_mfma_f32_16x16x32_bf16 v[92:95], v[48:51], a[104:107], v[92:95]
    buffer_store_dwordx4 v[120:123], v1, s[4:7], s63 offen offset:0
    v_mfma_f32_16x16x32_bf16 v[96:99], v[84:87], a[104:107], v[96:99]
    v_fma_f32 v155, v155, v178, -v179
    v_fma_f32 v156, v156, v178, -v179
    v_fma_f32 v157, v157, v178, -v179
    v_mfma_f32_16x16x32_bf16 v[92:95], v[52:55], a[108:111], v[92:95]
    v_fma_f32 v158, v158, v178, -v179
    v_fma_f32 v159, v159, v178, -v179
    v_fma_f32 v160, v160, v178, -v179
    v_mfma_f32_16x16x32_bf16 v[96:99], v[88:91], a[108:111], v[96:99]
    s_waitcnt vmcnt(4)
    v_cmp_eq_u32 vcc, 0, v10
    s_nop 0
    s_cmp_eq_u64 vcc, 0
    s_cselect_b32 s10, s47, 0
    v_mfma_f32_16x16x32_bf16 v[100:103], v[20:23], a[112:115], 0
    s_mov_b32 m0, s43
    v_fma_f32 v161, v161, v178, -v179
    v_fma_f32 v162, v162, v178, -v179
    v_mfma_f32_16x16x32_bf16 v[104:107], v[56:59], a[112:115], 0
    buffer_load_dwordx4 v0, s[8:11], s38 offen offset:0 sc1 lds
    v_mfma_f32_16x16x32_bf16 v[100:103], v[24:27], a[116:119], v[100:103]
    v_cvt_pk_bf16_f32 v144, v154, v155
    v_cvt_pk_bf16_f32 v145, v156, v157
    v_cvt_pk_bf16_f32 v146, v158, v159
    v_mfma_f32_16x16x32_bf16 v[104:107], v[60:63], a[116:119], v[104:107]
    v_cvt_pk_bf16_f32 v147, v160, v161
    v_cvt_pk_bf16_f32 v148, v162, 0
    buffer_store_dwordx4 v[144:147], v0, s[12:15], s35 offen sc1
    v_mfma_f32_16x16x32_bf16 v[100:103], v[28:31], a[120:123], v[100:103]
    buffer_load_dwordx4 v0, s[8:11], s38 offen offset:1024 sc1 lds
    v_mfma_f32_16x16x32_bf16 v[104:107], v[64:67], a[120:123], v[104:107]
    v_cvt_pk_bf16_f32 v108, v92, v93
    buffer_store_short v148, v8, s[12:15], s35 offen offset:1024 sc1
    v_mfma_f32_16x16x32_bf16 v[100:103], v[32:35], a[124:127], v[100:103]
    v_bfi_b32 v108, 1, s31, v108
    s_add_u32 s35, s35, 36864
    s_xor_b32 s33, s33, s41
    v_mfma_f32_16x16x32_bf16 v[104:107], v[68:71], a[124:127], v[104:107]
    buffer_load_dwordx4 v0, s[8:11], s38 offen offset:2048 sc1 lds
    v_mfma_f32_16x16x32_bf16 v[100:103], v[36:39], a[128:131], v[100:103]
    v_cvt_pk_bf16_f32 v112, v94, v95
    s_add_u32 s64, s33, 9216
    s_add_u32 s65, s33, 18432
    v_mfma_f32_16x16x32_bf16 v[104:107], v[72:75], a[128:131], v[104:107]
    v_bfi_b32 v112, 1, s31, v112
    s_add_u32 s66, s33, 27648
    v_mfma_f32_16x16x32_bf16 v[100:103], v[40:43], a[132:135], v[100:103]
    buffer_load_dwordx4 v0, s[8:11], s38 offen offset:3072 sc1 lds
    v_mfma_f32_16x16x32_bf16 v[104:107], v[76:79], a[132:135], v[104:107]
    v_cvt_pk_bf16_f32 v116, v96, v97
    v_mfma_f32_16x16x32_bf16 v[100:103], v[44:47], a[136:139], v[100:103]
    s_add_u32 m0, s43, 4096
    v_mfma_f32_16x16x32_bf16 v[104:107], v[80:83], a[136:139], v[104:107]
    buffer_load_dwordx4 v15, s[8:11], s38 offen sc1 lds
    v_mfma_f32_16x16x32_bf16 v[100:103], v[48:51], a[140:143], v[100:103]
    v_bfi_b32 v116, 1, s31, v116
    v_mfma_f32_16x16x32_bf16 v[104:107], v[84:87], a[140:143], v[104:107]
    v_cvt_pk_bf16_f32 v120, v98, v99
    v_mfma_f32_16x16x32_bf16 v[100:103], v[52:55], a[144:147], v[100:103]
    v_bfi_b32 v120, 1, s31, v120
    v_mfma_f32_16x16x32_bf16 v[104:107], v[88:91], a[144:147], v[104:107]
    v_mfma_f32_16x16x32_bf16 v[92:95], v[20:23], a[148:151], 0
    v_mfma_f32_16x16x32_bf16 v[96:99], v[56:59], a[148:151], 0
    v_mfma_f32_16x16x32_bf16 v[92:95], v[24:27], a[152:155], v[92:95]
    v_mfma_f32_16x16x32_bf16 v[96:99], v[60:63], a[152:155], v[96:99]
    v_mfma_f32_16x16x32_bf16 v[92:95], v[28:31], a[156:159], v[92:95]
    s_nop 0
    v_cvt_pk_bf16_f32 v109, v100, v101
    v_mfma_f32_16x16x32_bf16 v[96:99], v[64:67], a[156:159], v[96:99]
    v_cvt_pk_bf16_f32 v113, v102, v103
    v_mfma_f32_16x16x32_bf16 v[92:95], v[32:35], a[160:163], v[92:95]
    v_cvt_pk_bf16_f32 v117, v104, v105
    v_mfma_f32_16x16x32_bf16 v[96:99], v[68:71], a[160:163], v[96:99]
    v_cvt_pk_bf16_f32 v121, v106, v107
    v_mfma_f32_16x16x32_bf16 v[92:95], v[36:39], a[164:167], v[92:95]
    v_mfma_f32_16x16x32_bf16 v[96:99], v[72:75], a[164:167], v[96:99]
    v_mfma_f32_16x16x32_bf16 v[92:95], v[40:43], a[168:171], v[92:95]
    v_mfma_f32_16x16x32_bf16 v[96:99], v[76:79], a[168:171], v[96:99]
    v_mfma_f32_16x16x32_bf16 v[92:95], v[44:47], a[172:175], v[92:95]
    v_mfma_f32_16x16x32_bf16 v[96:99], v[80:83], a[172:175], v[96:99]
    v_mfma_f32_16x16x32_bf16 v[92:95], v[48:51], a[176:179], v[92:95]
    v_mfma_f32_16x16x32_bf16 v[96:99], v[84:87], a[176:179], v[96:99]
    v_mfma_f32_16x16x32_bf16 v[92:95], v[52:55], a[180:183], v[92:95]
    v_mfma_f32_16x16x32_bf16 v[96:99], v[88:91], a[180:183], v[96:99]
    v_mfma_f32_16x16x32_bf16 v[100:103], v[20:23], a[184:187], 0
    v_mfma_f32_16x16x32_bf16 v[104:107], v[56:59], a[184:187], 0
    buffer_load_dwordx4 v[180:183], v0, s[4:7], s34 offen sc1
    buffer_load_ushort v184, v8, s[4:7], s34 offen offset:1024 sc1
    v_mfma_f32_16x16x32_bf16 v[100:103], v[24:27], a[188:191], v[100:103]
    v_mfma_f32_16x16x32_bf16 v[104:107], v[60:63], a[188:191], v[104:107]
    v_mfma_f32_16x16x32_bf16 v[100:103], v[28:31], a[192:195], v[100:103]
    v_cvt_pk_bf16_f32 v110, v92, v93
    v_mfma_f32_16x16x32_bf16 v[104:107], v[64:67], a[192:195], v[104:107]
    v_cvt_pk_bf16_f32 v114, v94, v95
    v_mfma_f32_16x16x32_bf16 v[100:103], v[32:35], a[196:199], v[100:103]
    v_cvt_pk_bf16_f32 v118, v96, v97
    v_mfma_f32_16x16x32_bf16 v[104:107], v[68:71], a[196:199], v[104:107]
    v_cvt_pk_bf16_f32 v122, v98, v99
    v_mfma_f32_16x16x32_bf16 v[100:103], v[36:39], a[200:203], v[100:103]
    v_mfma_f32_16x16x32_bf16 v[104:107], v[72:75], a[200:203], v[104:107]
    v_mfma_f32_16x16x32_bf16 v[100:103], v[40:43], a[204:207], v[100:103]
    v_mfma_f32_16x16x32_bf16 v[104:107], v[76:79], a[204:207], v[104:107]
    v_mfma_f32_16x16x32_bf16 v[100:103], v[44:47], a[208:211], v[100:103]
    v_mfma_f32_16x16x32_bf16 v[104:107], v[80:83], a[208:211], v[104:107]
    v_mfma_f32_16x16x32_bf16 v[100:103], v[48:51], a[212:215], v[100:103]
    v_mfma_f32_16x16x32_bf16 v[104:107], v[84:87], a[212:215], v[104:107]
    v_mfma_f32_16x16x32_bf16 v[100:103], v[52:55], a[216:219], v[100:103]
    v_mfma_f32_16x16x32_bf16 v[104:107], v[88:91], a[216:219], v[104:107]
    v_mfma_f32_16x16x32_bf16 v[92:95], v[20:23], a[220:223], 0
    v_mfma_f32_16x16x32_bf16 v[96:99], v[56:59], a[220:223], 0
    v_mfma_f32_16x16x32_bf16 v[92:95], v[24:27], a[224:227], v[92:95]
    v_mfma_f32_16x16x32_bf16 v[96:99], v[60:63], a[224:227], v[96:99]
    v_mfma_f32_16x16x32_bf16 v[92:95], v[28:31], a[228:231], v[92:95]
    s_nop 1
    v_cvt_pk_bf16_f32 v111, v100, v101
    v_mfma_f32_16x16x32_bf16 v[96:99], v[64:67], a[228:231], v[96:99]
    buffer_store_dwordx4 v[108:111], v1, s[4:7], s32 offen offset:256
    v_mfma_f32_16x16x32_bf16 v[92:95], v[32:35], a[232:235], v[92:95]
    s_waitcnt vmcnt(6)
    s_mov_b64 exec, 1
    buffer_store_dword v7, off, s[4:7], s36 sc1
    s_mov_b64 exec, -1
    s_add_u32 s36, s36, 4
    v_mfma_f32_16x16x32_bf16 v[96:99], v[68:71], a[232:235], v[96:99]
    v_mfma_f32_16x16x32_bf16 v[92:95], v[36:39], a[236:239], v[92:95]
    v_cvt_pk_bf16_f32 v115, v102, v103
    v_mfma_f32_16x16x32_bf16 v[96:99], v[72:75], a[236:239], v[96:99]
    buffer_store_dwordx4 v[112:115], v1, s[4:7], s61 offen offset:256
    v_mfma_f32_16x16x32_bf16 v[92:95], v[40:43], a[240:243], v[92:95]
    v_mfma_f32_16x16x32_bf16 v[96:99], v[76:79], a[240:243], v[96:99]
    v_cvt_pk_bf16_f32 v119, v104, v105
    v_mfma_f32_16x16x32_bf16 v[92:95], v[44:47], a[244:247], v[92:95]
    buffer_store_dwordx4 v[116:119], v1, s[4:7], s62 offen offset:256
    v_mfma_f32_16x16x32_bf16 v[96:99], v[80:83], a[244:247], v[96:99]
    v_mfma_f32_16x16x32_bf16 v[92:95], v[48:51], a[248:251], v[92:95]
    v_cvt_pk_bf16_f32 v123, v106, v107
    v_mfma_f32_16x16x32_bf16 v[96:99], v[84:87], a[248:251], v[96:99]
    buffer_store_dwordx4 v[120:123], v1, s[4:7], s63 offen offset:256
    v_mfma_f32_16x16x32_bf16 v[92:95], v[52:55], a[252:255], v[92:95]
    v_mfma_f32_16x16x32_bf16 v[96:99], v[88:91], a[252:255], v[96:99]
    s_mov_b32 s51, s31
    s_mov_b32 s67, s32
    s_mov_b32 s23, 32768
    s_xor_b32 s32, s32, s53
L_down_end:
    v_add_u32 v14, s44, v14
    s_sub_u32 s44, 0, s44
    s_waitcnt vmcnt(6)
    s_add_u32 s30, s30, 1
    s_cmp_lg_u32 s10, 0
    s_cbranch_scc1 L_down_carry
    v_cvt_pk_bf16_f32 v124, v92, v93
    v_bfi_b32 v124, 1, s51, v124
    buffer_store_dword v124, v2, s[4:7], s67 offen offset:512
    v_cvt_pk_bf16_f32 v125, v94, v95
    v_bfi_b32 v125, 1, s51, v125
    buffer_store_dword v125, v2, s[4:7], s61 offen offset:512
    v_cvt_pk_bf16_f32 v126, v96, v97
    v_bfi_b32 v126, 1, s51, v126
    buffer_store_dword v126, v2, s[4:7], s62 offen offset:512
    v_cvt_pk_bf16_f32 v127, v98, v99
    v_bfi_b32 v127, 1, s51, v127
    buffer_store_dword v127, v2, s[4:7], s63 offen offset:512
    s_cmp_eq_u32 s30, 64
    s_cbranch_scc1 L_down_last
    s_mov_b32 s23, 32768
    s_mov_b32 s29, 9
L_spin_58:
    s_sub_u32 s23, s23, 1
    s_cbranch_scc1 L_abort
    s_sleep 2
    buffer_load_dword v10, v9, s[4:7], s37 offen offset:0 sc1
    s_waitcnt vmcnt(0)
    v_cmp_eq_u32 vcc, 0, v10
    s_cbranch_vccnz L_spin_58
    s_mov_b32 m0, s43
    s_nop 0
    buffer_load_dwordx4 v0, s[4:7], s38 offen offset:0 sc1 lds
    buffer_load_dwordx4 v0, s[4:7], s38 offen offset:1024 sc1 lds
    buffer_load_dwordx4 v0, s[4:7], s38 offen offset:2048 sc1 lds
    buffer_load_dwordx4 v0, s[4:7], s38 offen offset:3072 sc1 lds
    s_add_u32 m0, s43, 4096
    s_nop 0
    buffer_load_dwordx4 v15, s[4:7], s38 offen sc1 lds
    s_waitcnt vmcnt(0)
    s_branch L_down_carry
L_down_last:
    s_barrier
    buffer_load_dwordx4 v[128:131], v3, s[4:7], s33 offen offset:0 sc1
    buffer_load_dwordx4 v[132:135], v3, s[4:7], s64 offen offset:0 sc1
    buffer_load_dwordx4 v[136:139], v3, s[4:7], s65 offen offset:0 sc1
    buffer_load_dwordx4 v[140:143], v3, s[4:7], s66 offen offset:0 sc1
L_rsc_60:
    s_waitcnt vmcnt(0)
    v_mfma_f32_16x16x32_bf16 v[164:167], v[16:19], v[128:131], 0
    v_bitop3_b32 v176, v128, v132, s51 bitop3:0x7e
    v_bitop3_b32 v177, v136, v140, s51 bitop3:0x7e
    v_mfma_f32_16x16x32_bf16 v[164:167], v[16:19], v[132:135], v[164:167]
    v_bitop3_b32 v176, v176, v177, 1 bitop3:0xa8
    v_cmp_ne_u32 vcc, 0, v176
    v_mfma_f32_16x16x32_bf16 v[164:167], v[16:19], v[136:139], v[164:167]
    v_mfma_f32_16x16x32_bf16 v[164:167], v[16:19], v[140:143], v[164:167]
    s_cbranch_vccnz L_rsr_59
    buffer_load_dwordx4 v[144:147], v3, s[4:7], s33 offen offset:256 sc1
    buffer_load_dwordx4 v[148:151], v3, s[4:7], s64 offen offset:256 sc1
    buffer_load_dwordx4 v[152:155], v3, s[4:7], s65 offen offset:256 sc1
    buffer_load_dwordx4 v[156:159], v3, s[4:7], s66 offen offset:256 sc1
    buffer_load_dwordx4 v[160:163], v4, s[4:7], s33 offen offset:512 sc1
    s_nop 1
    ds_write_b32 v5, v164 offset:0
    ds_write_b32 v5, v165 offset:2304
    ds_write_b32 v5, v166 offset:64
    ds_write_b32 v5, v167 offset:2368
L_rsc_62:
    s_waitcnt vmcnt(0)
    v_mfma_f32_16x16x32_bf16 v[168:171], v[16:19], v[144:147], 0
    v_bitop3_b32 v176, v144, v148, s51 bitop3:0x7e
    v_bitop3_b32 v177, v152, v156, s51 bitop3:0x7e
    v_mfma_f32_16x16x32_bf16 v[168:171], v[16:19], v[148:151], v[168:171]
    v_bitop3_b32 v178, v160, v161, s51 bitop3:0x7e
    v_bitop3_b32 v179, v162, v163, s51 bitop3:0x7e
    v_mfma_f32_16x16x32_bf16 v[168:171], v[16:19], v[152:155], v[168:171]
    v_or3_b32 v177, v177, v178, v179
    v_bitop3_b32 v176, v176, v177, 1 bitop3:0xa8
    v_mfma_f32_16x16x32_bf16 v[168:171], v[16:19], v[156:159], v[168:171]
    v_cmp_ne_u32 vcc, 0, v176
    v_mfma_f32_16x16x32_bf16 v[172:175], v[16:19], v[160:163], 0
    s_cbranch_vccnz L_rsr_61
    s_nop 4
    ds_write_b32 v5, v168 offset:256
    ds_write_b32 v5, v169 offset:2560
    ds_write_b32 v5, v170 offset:320
    ds_write_b32 v5, v171 offset:2624
    v_add_f32_dpp v172, v172, v172 row_ror:4 row_mask:0xf bank_mask:0xf
    v_add_f32_dpp v173, v173, v173 row_ror:4 row_mask:0xf bank_mask:0xf
    v_add_f32_dpp v174, v174, v174 row_ror:4 row_mask:0xf bank_mask:0xf
    v_add_f32_dpp v175, v175, v175 row_ror:4 row_mask:0xf bank_mask:0xf
    v_add_f32_dpp v172, v172, v172 row_ror:8 row_mask:0xf bank_mask:0xf
    v_add_f32_dpp v173, v173, v173 row_ror:8 row_mask:0xf bank_mask:0xf
    v_add_f32_dpp v174, v174, v174 row_ror:8 row_mask:0xf bank_mask:0xf
    v_add_f32_dpp v175, v175, v175 row_ror:8 row_mask:0xf bank_mask:0xf
    ds_write_b32 v6, v172 offset:512
    ds_write_b32 v6, v173 offset:2816
    ds_write_b32 v6, v174 offset:516
    ds_write_b32 v6, v175 offset:2820
    s_waitcnt lgkmcnt(0)
    s_barrier
    ds_read_b128 v[154:157], v7
    ds_read_b128 v[158:161], v7 offset:16
    ds_read_b32 v162, v11
    v_lshlrev_b32 v144, 16, v180
    v_and_b32 v145, 0xffff0000, v180
    v_lshlrev_b32 v146, 16, v181
    v_and_b32 v147, 0xffff0000, v181
    v_lshlrev_b32 v148, 16, v182
    v_and_b32 v149, 0xffff0000, v182
    v_lshlrev_b32 v150, 16, v183
    v_and_b32 v151, 0xffff0000, v183
    v_lshlrev_b32 v152, 16, v184
    s_waitcnt lgkmcnt(2)
    v_pk_add_f32 v[154:155], v[154:155], v[144:145]
    v_pk_add_f32 v[156:157], v[156:157], v[146:147]
    s_waitcnt lgkmcnt(1)
    v_pk_add_f32 v[158:159], v[158:159], v[148:149]
    v_pk_add_f32 v[160:161], v[160:161], v[150:151]
    s_waitcnt lgkmcnt(0)
    v_add_f32 v162, v162, v152
    v_pk_add_f32 v[144:145], v[154:155], v[156:157]
    v_pk_add_f32 v[146:147], v[158:159], v[160:161]
    v_pk_mul_f32 v[148:149], v[154:155], v[154:155]
    v_pk_add_f32 v[144:145], v[144:145], v[146:147]
    v_pk_fma_f32 v[148:149], v[156:157], v[156:157], v[148:149]
    v_pk_fma_f32 v[148:149], v[158:159], v[158:159], v[148:149]
    v_pk_fma_f32 v[148:149], v[160:161], v[160:161], v[148:149]
    v_add_f32 v176, v144, v145
    v_fma_f32 v177, v162, v162, v148
    v_add_f32 v176, v176, v162
    v_add_f32 v177, v177, v149
    s_nop 0
    v_add_f32_dpp v176, v176, v176 quad_perm:[1,0,3,2] row_mask:0xf bank_mask:0xf
    v_add_f32_dpp v177, v177, v177 quad_perm:[1,0,3,2] row_mask:0xf bank_mask:0xf
    s_nop 0
    v_add_f32_dpp v176, v176, v176 quad_perm:[2,3,0,1] row_mask:0xf bank_mask:0xf
    v_add_f32_dpp v177, v177, v177 quad_perm:[2,3,0,1] row_mask:0xf bank_mask:0xf
    s_nop 0
    v_add_f32_dpp v176, v176, v176 row_half_mirror row_mask:0xf bank_mask:0xf
    v_add_f32_dpp v177, v177, v177 row_half_mirror row_mask:0xf bank_mask:0xf
    s_nop 0
    v_add_f32_dpp v176, v176, v176 row_mirror row_mask:0xf bank_mask:0xf
    v_add_f32_dpp v177, v177, v177 row_mirror row_mask:0xf bank_mask:0xf
    v_mov_b32 v179, 0x3727c5ac
    s_nop 0
    v_permlane16_swap_b32 v176, v177
    v_add_f32 v176, v176, v177
    v_mov_b32 v178, v176
    s_add_u32 s34, s34, 36864
    s_nop 0
    v_permlane32_swap_b32 v176, v178
    v_add_f32 v176, v176, v178
    v_mul_f32 v176, 0x3ae38e39, v176
    s_nop 0
    v_readlane_b32 s60, v176, 0
    v_readlane_b32 s28, v176, 16
    s_nop 1
    v_add_f32 v179, s28, v179
    v_fma_f32 v179, -v176, s60, v179
    v_rsq_f32 v179, v179
    s_andn2_b32 s60, s60, s58
    v_readlane_b32 s28, v179, 0
    s_nop 0
    s_andn2_b32 s28, s28, s58
    s_or_b32 s28, s28, s59
    v_mov_b32 v178, s28
    v_mul_f32 v179, s60, v178
    v_pk_fma_f32 v[154:155], v[154:155], v[178:179], v[178:179] op_sel:[0,0,1] op_sel_hi:[1,0,1] neg_lo:[0,0,1] neg_hi:[0,0,1]
    v_pk_fma_f32 v[156:157], v[156:157], v[178:179], v[178:179] op_sel:[0,0,1] op_sel_hi:[1,0,1] neg_lo:[0,0,1] neg_hi:[0,0,1]
    v_pk_fma_f32 v[158:159], v[158:159], v[178:179], v[178:179] op_sel:[0,0,1] op_sel_hi:[1,0,1] neg_lo:[0,0,1] neg_hi:[0,0,1]
    v_pk_fma_f32 v[160:161], v[160:161], v[178:179], v[178:179] op_sel:[0,0,1] op_sel_hi:[1,0,1] neg_lo:[0,0,1] neg_hi:[0,0,1]
    v_fma_f32 v162, v162, v178, -v179
    v_cvt_pk_bf16_f32 v144, v154, v155
    v_cvt_pk_bf16_f32 v145, v156, v157
    v_cvt_pk_bf16_f32 v146, v158, v159
    v_cvt_pk_bf16_f32 v147, v160, v161
    v_cvt_pk_bf16_f32 v148, v162, 0
    buffer_store_dwordx4 v[144:147], v0, s[12:15], s35 offen sc1
    buffer_store_short v148, v8, s[12:15], s35 offen offset:1024 sc1
    s_add_u32 s35, s35, 36864
    s_waitcnt vmcnt(0)
    s_mov_b64 exec, 1
    buffer_store_dword v7, off, s[4:7], s36 sc1
    s_mov_b64 exec, -1
    s_add_u32 s36, s36, 4
    s_endpgm
L_rsr_54:
    s_mov_b32 s29, 10
    s_sub_u32 s23, s23, 1
    s_cbranch_scc1 L_abort
    s_nop 7
    buffer_load_dwordx4 v[128:131], v3, s[4:7], s33 offen offset:0 sc1
    buffer_load_dwordx4 v[132:135], v3, s[4:7], s64 offen offset:0 sc1
    buffer_load_dwordx4 v[136:139], v3, s[4:7], s65 offen offset:0 sc1
    buffer_load_dwordx4 v[140:143], v3, s[4:7], s66 offen offset:0 sc1
    s_waitcnt vmcnt(0)
    s_branch L_rsc_55
L_rsr_56:
    s_mov_b32 s29, 10
    s_sub_u32 s23, s23, 1
    s_cbranch_scc1 L_abort
    s_nop 7
    buffer_load_dwordx4 v[144:147], v3, s[4:7], s33 offen offset:256 sc1
    buffer_load_dwordx4 v[148:151], v3, s[4:7], s64 offen offset:256 sc1
    buffer_load_dwordx4 v[152:155], v3, s[4:7], s65 offen offset:256 sc1
    buffer_load_dwordx4 v[156:159], v3, s[4:7], s66 offen offset:256 sc1
    buffer_load_dwordx4 v[160:163], v4, s[4:7], s33 offen offset:512 sc1
    s_waitcnt vmcnt(0)
    s_branch L_rsc_57
L_rsr_59:
    s_mov_b32 s29, 10
    s_sub_u32 s23, s23, 1
    s_cbranch_scc1 L_abort
    s_nop 7
    buffer_load_dwordx4 v[128:131], v3, s[4:7], s33 offen offset:0 sc1
    buffer_load_dwordx4 v[132:135], v3, s[4:7], s64 offen offset:0 sc1
    buffer_load_dwordx4 v[136:139], v3, s[4:7], s65 offen offset:0 sc1
    buffer_load_dwordx4 v[140:143], v3, s[4:7], s66 offen offset:0 sc1
    s_waitcnt vmcnt(0)
    s_branch L_rsc_60
L_rsr_61:
    s_mov_b32 s29, 10
    s_sub_u32 s23, s23, 1
    s_cbranch_scc1 L_abort
    s_nop 7
    buffer_load_dwordx4 v[144:147], v3, s[4:7], s33 offen offset:256 sc1
    buffer_load_dwordx4 v[148:151], v3, s[4:7], s64 offen offset:256 sc1
    buffer_load_dwordx4 v[152:155], v3, s[4:7], s65 offen offset:256 sc1
    buffer_load_dwordx4 v[156:159], v3, s[4:7], s66 offen offset:256 sc1
    buffer_load_dwordx4 v[160:163], v4, s[4:7], s33 offen offset:512 sc1
    s_waitcnt vmcnt(0)
    s_branch L_rsc_62
.section .rodata,"a"
.p2align 6
.amdhsa_kernel interleave_layers__memory_aug_recurrent_mem_tr__glu_gated_geglu__prompt_kernel
  .amdhsa_next_free_vgpr 512
  .amdhsa_next_free_sgpr 102
  .amdhsa_accum_offset 256
  .amdhsa_group_segment_fixed_size 0
  .amdhsa_kernarg_size 112
  .amdhsa_user_sgpr_count 2
  .amdhsa_user_sgpr_kernarg_segment_ptr 1
  .amdhsa_system_sgpr_workgroup_id_x 1
  .amdhsa_float_denorm_mode_32 3
.end_amdhsa_kernel
```
